```python
import torch

def _softmax(x, axis=-1):
    return torch.softmax(x, dim=axis)
def _gelu(x):
    return torch.nn.functional.gelu(x, approximate="tanh")
def _silu(x):
    return torch.nn.functional.silu(x)
def _sigmoid(x):
    return torch.sigmoid(x)
def _layernorm(x, axis=-1, eps=1e-5):
    m = x.mean(dim=axis, keepdim=True)
    v = x.var(dim=axis, keepdim=True, unbiased=False)
    return (x - m) / torch.sqrt(v + eps)
def _scatter_add(tgt, idx, src, axis=0):
    return tgt.clone().index_add_(axis, idx, src)
def _segment_sum(src, seg, n):
    out = torch.zeros((n,) + src.shape[1:], dtype=src.dtype)
    return out.index_add_(0, seg, src)
def _pad(x, pw):
    flat = tuple(v for pair in reversed(pw) for v in pair)
    return torch.nn.functional.pad(x, flat)

kernel_name = 'recurrent_scan__sliding_local_dilated__dense_activation_silu__prompt'

def setup_inputs():

    _w = (lambda a: (lambda t: t.to(torch.bfloat16) if t.is_floating_point() else t)(torch.as_tensor(a)))
    def _A_setup():
        B, S, D = 1, 2048, 576
        return {
            "x": _w((lambda *s: torch.randn(*s, dtype=torch.bfloat16) * 0.05)(B, S, D)),
            "wqkv": _w((lambda *s: torch.randn(*s, dtype=torch.bfloat16) * 0.2)(D, 3 * D)),
            "wo": _w((lambda *s: torch.randn(*s, dtype=torch.bfloat16) * 0.2)(D, D)),
        }
    _A_in = _A_setup()

    def _B_setup():
        B, S, D, F = 1, 2048, 576, 4608
        return {
            "x": _w((lambda *s: torch.randn(*s, dtype=torch.bfloat16) * 0.05)(B, S, D)),
            "w1": _w((lambda *s: torch.randn(*s, dtype=torch.bfloat16) * 1.6)(D, F) * (D ** -0.5)),
            "w2": _w((lambda *s: torch.randn(*s, dtype=torch.bfloat16) * 0.1)(F, D) * (F ** -0.5)),
        }
    _B_in = _B_setup()

    return {
        "A_x": _A_in["x"],
        "A_wqkv": _A_in["wqkv"],
        "A_wo": _A_in["wo"],
        "B_x": _B_in["x"],
        "B_w1": _B_in["w1"],
        "B_w2": _B_in["w2"],
    }

def reference(A_x, A_wqkv, A_wo, B_x, B_w1, B_w2):
    def _A_ref(x, wqkv, wo):
        B, S, D = x.shape
        H = 32; Dh = D // H
        W, dil = 8, 2
        qkv = (lambda x, *d: x.permute(*d))((x @ wqkv).reshape(B, S, 3, H, Dh), 2, 0, 3, 1, 4)
        q, k, v = qkv[0], qkv[1], qkv[2]
        scale = Dh ** -0.5
        pos = torch.arange(S)
        off = torch.arange(W) * dil
        idx = pos[:, None] - off[None, :]
        mask = idx >= 0
        idx_c = torch.where(mask, idx, 0).reshape(-1)
        kg = k[:, :, idx_c, :].reshape(B, H, S, W, Dh)
        vg = v[:, :, idx_c, :].reshape(B, H, S, W, Dh)
        logits = torch.einsum("bhsd,bhswd->bhsw", q, kg) * scale
        logits = torch.where(mask[None, None, :, :], logits, -1e9)
        attn = _softmax(logits, axis=-1)
        o = torch.einsum("bhsw,bhswd->bhsd", attn, vg)
        return (lambda x, *d: x.permute(*d))(o, 0, 2, 1, 3).reshape(B, S, D) @ wo

    def _B_ref(x, w1, w2):
        h = torch.einsum("bsd,df->bsf", x, w1)
        h = _silu(h)
        out = torch.einsum("bsf,fd->bsd", h, w2)
        return out

    x = A_x
    xn = _layernorm(x, axis=-1)
    s = _A_ref(xn, A_wqkv, A_wo)
    g = _silu(_B_ref(xn, B_w1, B_w2))
    return x + s * g
```

```asm
; @launch kernel=recurrent_scan__sliding_local_dilated__dense_activation_silu__prompt_kernel grid=(256,1,1) block=(256,1,1) lds=163840
; @launch kernel=fin_kernel grid=(240,1,1) block=(256,1,1) lds=163840
.amdgcn_target "amdgcn-amd-amdhsa--gfx950"
.text
.globl recurrent_scan__sliding_local_dilated__dense_activation_silu__prompt_kernel
.p2align 8
.type recurrent_scan__sliding_local_dilated__dense_activation_silu__prompt_kernel,@function
recurrent_scan__sliding_local_dilated__dense_activation_silu__prompt_kernel:
 s_cmp_ge_u32 s2, 256
 s_cbranch_scc1 L_exit
 s_load_dwordx4 s[4:7], s[0:1], 0
 s_load_dwordx4 s[8:11], s[0:1], 32
 s_load_dwordx2 s[36:37], s[0:1], 64
 s_load_dwordx2 s[24:25], s[0:1], 16
 v_lshrrev_b32 v1, 6, v0
 s_nop 0
 v_readfirstlane_b32 s28, v1
 v_and_b32 v1, 63, v0
 s_getpc_b64 s[44:45]
L_pc:
 s_lshr_b32 s46, s2, 3
 s_lshl_b32 s46, s46, 5
 v_lshrrev_b32 v2, 3, v0
 v_add_u32 v2, s46, v2
 v_lshlrev_b32 v2, 7, v2
 v_min_u32 v2, L_allend-L_pc-4, v2
 global_load_dword v111, v2, s[44:45]
 s_cmp_lt_u32 s2, 48
 s_cbranch_scc1 L_qkv
L_ffn:
 s_sub_u32 s31, s2, 48
 s_lshr_b32 s40, s31, 3
 s_cmp_ge_u32 s40, 13
 s_cselect_b32 s41, 1, 0
 s_cselect_b32 s35, 13, 0
 s_sub_u32 s29, s40, s35
 s_and_b32 s31, s2, 1
 s_mul_i32 s31, s31, 13
 s_add_u32 s29, s29, s31
 s_and_b32 s31, s2, 6
 s_add_u32 s30, s41, s31
 s_mul_i32 s38, s29, 92160
 v_lshrrev_b32 v14, 3, v1
 v_mul_u32_u24 v14, 1152, v14
 v_and_b32 v13, 7, v1
 v_lshl_add_u32 v15, v13, 4, v14
 v_xor_b32 v22, 48, v15
 v_add_u32 v22, 9216, v22
 s_lshr_b32 s31, s28, 1
 s_mul_i32 s31, s31, 3
 v_and_b32 v13, 15, v1
 v_xor_b32 v13, s31, v13
 v_lshlrev_b32 v13, 4, v13
 v_lshrrev_b32 v14, 4, v1
 v_mul_u32_u24 v14, 1152, v14
 v_add_u32 v16, v13, v14
 s_mov_b32 vcc_lo, 0x00ff00ff
 s_mov_b32 vcc_hi, 0x00ff00ff
 s_mul_i32 s43, s28, 18432
 s_add_u32 s43, s43, s38
 v_bfrev_b32 v13, 1
 v_cndmask_b32 v17, v13, v16, vcc
 s_mul_i32 s44, s28, 4608
 s_add_u32 s44, s44, s38
 s_add_u32 s44, s44, 73728
 s_waitcnt lgkmcnt(0)
 s_mov_b32 s12, s4
 s_and_b32 s13, s5, 0xffff
 s_mov_b32 s14, 2359296
 s_mov_b32 s15, 0x20000
 buffer_load_dwordx4 v[152:155], v15, s[12:15], s43 offen offset:0
 buffer_load_dwordx4 v[156:159], v15, s[12:15], s43 offen offset:128
 buffer_load_dwordx4 v[160:163], v15, s[12:15], s43 offen offset:256
 buffer_load_dwordx4 v[164:167], v15, s[12:15], s43 offen offset:384
 buffer_load_dwordx4 v[168:171], v15, s[12:15], s43 offen offset:512
 buffer_load_dwordx4 v[172:175], v15, s[12:15], s43 offen offset:640
 buffer_load_dwordx4 v[176:179], v15, s[12:15], s43 offen offset:768
 buffer_load_dwordx4 v[180:183], v15, s[12:15], s43 offen offset:896
 buffer_load_dwordx4 v[184:187], v15, s[12:15], s43 offen offset:1024
 buffer_load_dwordx4 v[188:191], v22, s[12:15], s43 offen offset:0
 s_branch L_ffn2
L_qkv:
 s_and_b32 s31, s2, 1
 s_mul_i32 s31, s31, 12
 s_bfe_u32 s35, s2, 0x10002
 s_mul_i32 s35, s35, 6
 s_add_u32 s31, s31, s35
 s_lshr_b32 s35, s2, 3
 s_add_u32 s31, s31, s35
 s_lshr_b32 s29, s31, 1
 s_and_b32 s31, s31, 1
 s_bfe_u32 s30, s2, 0x10001
 s_mul_i32 s52, s29, 176
 s_add_u32 s52, s52, s31
 s_mul_i32 s38, s52, 1152
 s_sub_u32 s38, s38, 18432
 v_lshrrev_b32 v14, 3, v1
 v_mul_u32_u24 v14, 2304, v14
 v_and_b32 v13, 7, v1
 v_lshl_add_u32 v15, v13, 4, v14
 v_xor_b32 v22, 48, v15
 s_mul_i32 s31, s28, 36864
 s_add_u32 s31, s31, s38
 v_add_u32 v15, s31, v15
 s_add_u32 s45, s31, 18432
 v_min_u32 v15, 0x7fffff00, v15
 s_and_b32 s40, s28, 1
 s_lshr_b32 s41, s28, 1
 s_mul_i32 s31, s41, 3
 v_and_b32 v13, 7, v1
 v_xor_b32 v13, s31, v13
 v_lshlrev_b32 v13, 4, v13
 v_lshrrev_b32 v14, 3, v1
 v_mul_u32_u24 v14, 2304, v14
 v_add_u32 v18, v13, v14
 s_lshl_b32 s44, s40, 1
 s_add_u32 s44, s44, s41
 s_mul_i32 s44, s44, 18432
 s_add_u32 s44, s44, s38
 s_add_u32 s44, s44, 147456
 s_waitcnt lgkmcnt(0)
 s_mov_b32 s12, s4
 s_and_b32 s13, s5, 0xffff
 s_mov_b32 s14, 2359296
 s_mov_b32 s15, 0x20000
 s_mov_b32 s94, s45
 buffer_load_dwordx4 v[148:151], v18, s[12:15], s44 offen offset:0
 buffer_load_dwordx4 v[152:155], v18, s[12:15], s44 offen offset:128
 buffer_load_dwordx4 v[156:159], v18, s[12:15], s44 offen offset:256
 buffer_load_dwordx4 v[160:163], v18, s[12:15], s44 offen offset:384
 buffer_load_dwordx4 v[164:167], v18, s[12:15], s44 offen offset:512
 buffer_load_dwordx4 v[168:171], v18, s[12:15], s44 offen offset:640
 buffer_load_dwordx4 v[172:175], v18, s[12:15], s44 offen offset:768
 buffer_load_dwordx4 v[176:179], v18, s[12:15], s44 offen offset:896
 buffer_load_dwordx4 v[180:183], v18, s[12:15], s44 offen offset:1024
 buffer_load_dwordx4 v[184:187], v15, s[12:15], 0 offen offset:0
 s_branch L_qkv2
L_ffn2:
 s_mov_b32 s16, s8
 s_and_b32 s17, s9, 0xffff
 s_mov_b32 s18, 5308416
 s_mov_b32 s19, 0x20000
 s_and_b32 s31, s28, 1
 s_lshl_b32 s31, s31, 1
 v_bfe_u32 v13, v1, 4, 1
 v_or_b32 v13, s31, v13
 v_bfe_u32 v14, v1, 1, 2
 v_xor_b32 v13, v13, v14
 v_lshlrev_b32 v13, 5, v13
 v_and_b32 v14, 1, v1
 v_lshl_add_u32 v12, v14, 4, v13
 s_lshl_b32 s31, s28, 3
 v_lshrrev_b32 v13, 3, v1
 v_add_u32 v13, s31, v13
 s_mov_b32 s31, 9216
 v_mul_lo_u32 v13, v13, s31
 v_add_u32 v9, v13, v12
 v_add_u32 v10, 293888, v9
 v_add_u32 v11, 587776, v9
 s_add_u32 s31, s29, s30
 s_mul_i32 s46, s31, 57
 s_lshr_b32 s46, s46, 9
 s_mul_i32 s46, s46, 9
 s_sub_u32 s46, s31, s46
 s_mul_i32 s51, s30, 1152
 s_add_u32 s47, s51, 1152
 s_lshl_b32 s49, s46, 7
 s_add_u32 s32, s51, s49
 s_mul_i32 s42, s28, 3072
 s_mov_b32 s20, s10
 s_and_b32 s21, s11, 0xffff
 s_mov_b32 s22, 5308416
 s_mov_b32 s23, 0x20000
 s_mov_b32 s8, s24
 s_and_b32 s9, s25, 0xffff
 s_mov_b32 s10, 663552
 s_mov_b32 s11, 0x20000
 s_mov_b32 s24, s36
 s_and_b32 s25, s37, 0xffff
 s_mov_b32 s26, 19234816
 s_mov_b32 s27, 0x20000
 s_mov_b32 s52, s6
 s_and_b32 s53, s7, 0xffff
 s_mov_b32 s54, 1990656
 s_mov_b32 s55, 0x20000
 s_lshl_b32 s31, s28, 3
 v_lshrrev_b32 v13, 3, v1
 v_add_u32 v13, s31, v13
 s_mov_b32 s31, 1152
 v_mul_lo_u32 v13, v13, s31
 v_add_u32 v12, v13, v12
 v_bfe_u32 v13, v1, 3, 2
 v_xor_b32 v13, s28, v13
 v_lshlrev_b32 v13, 5, v13
 v_lshrrev_b32 v14, 4, v1
 v_mul_u32_u24 v14, 3072, v14
 v_add_u32 v13, v13, v14
 v_bfe_u32 v14, v1, 2, 2
 v_lshl_add_u32 v13, v14, 7, v13
 v_and_b32 v14, 3, v1
 v_lshl_add_u32 v2, v14, 3, v13
 v_add_u32 v3, 36864, v2
 v_bfe_u32 v13, v1, 3, 1
 v_mul_u32_u24 v13, 3, v13
 v_lshrrev_b32 v14, 4, v1
 v_xor_b32 v13, v13, v14
 v_lshlrev_b32 v13, 4, v13
 v_and_b32 v14, 15, v1
 v_lshl_add_u32 v4, v14, 6, v13
 v_add_u32 v4, 63488, v4
 v_add_u32 v5, 61440, v4
 v_lshlrev_b32 v26, 4, v1
 v_lshlrev_b32 v27, 3, v1
 v_add_u32 v6, 73728, v26
 v_add_u32 v7, 61440, v6
 s_lshl_b32 s31, s28, 10
 s_add_u32 s31, s31, 63488
 v_bfe_u32 v13, v1, 2, 1
 v_mul_u32_u24 v13, 5120, v13
 v_lshrrev_b32 v14, 3, v1
 v_lshl_add_u32 v13, v14, 6, v13
 v_and_b32 v14, 3, v1
 v_lshl_add_u32 v13, v14, 4, v13
 v_add_u32 v20, s31, v13
 v_add_u32 v21, 61440, v20
 v_bfe_u32 v13, v1, 2, 2
 v_mul_u32_u24 v13, 5120, v13
 v_lshrrev_b32 v14, 4, v1
 v_lshl_add_u32 v13, v14, 6, v13
 v_and_b32 v14, 3, v1
 v_lshl_add_u32 v13, v14, 4, v13
 s_lshl_b32 s31, s28, 8
 s_add_u32 s31, s31, 67584
 v_add_u32 v18, s31, v13
 v_add_u32 v19, 81920, v18
 v_mov_b32 v14, 155648
 v_cndmask_b32 v19, v14, v19, vcc
 s_lshr_b32 s31, s28, 1
 s_mul_i32 s31, s31, 5120
 s_and_b32 s35, s28, 1
 s_lshl_b32 s35, s35, 9
 s_add_u32 s31, s31, s35
 s_add_u32 s31, s31, 73728
 v_and_b32 v13, 15, v1
 v_lshlrev_b32 v13, 4, v13
 v_lshrrev_b32 v14, 5, v1
 v_lshl_add_u32 v13, v14, 8, v13
 v_bfe_u32 v14, v1, 4, 1
 v_lshl_add_u32 v13, v14, 3, v13
 v_add_u32 v8, s31, v13
 s_mul_i32 s50, s29, 72
 s_add_u32 s50, s50, s30
 s_mul_i32 s50, s50, 10240
 s_mul_i32 s31, s28, 2560
 s_add_u32 s50, s50, s31
 s_add_u32 s48, s50, 737280
 s_mul_i32 s31, s46, 81920
 s_add_u32 s34, s50, s31
 s_lshl_b32 s31, s40, 1
 s_and_b32 s35, s28, 1
 s_add_u32 s31, s31, s35
 s_mul_i32 s31, s31, 34
 v_min_u32 v13, 33, v1
 v_add_u32 v13, s31, v13
 v_mul_u32_u24 v110, 1152, v13
 s_lshr_b32 s31, s28, 1
 s_lshl_b32 s31, s31, 7
 s_sub_u32 s35, 1024, s31
 s_bitcmp1_b32 s2, 1
 s_cselect_b32 s45, s35, s31
 s_cselect_b32 s41, -256, 0
 s_cselect_b32 s35, 0, 256
 s_add_u32 s41, s41, s35
 s_sub_u32 s31, s2, 48
 s_lshl_b32 s31, s31, 2
 s_add_u32 s31, s31, s28
 s_mul_i32 s45, s31, 2432
 v_min_u32 v110, 18, v1
 v_lshlrev_b32 v110, 7, v110
 s_mul_i32 s41, s31, 896
 v_min_u32 v142, 768, v110
 s_mul_i32 s39, s30, 663552
 s_mul_i32 s31, s46, 73728
 s_add_u32 s31, s39, s31
 s_add_u32 s35, s39, 663552
 s_add_u32 s84, s31, 2048
 s_add_u32 s31, s31, 36864
 s_add_u32 s85, s31, 1024
 s_add_u32 s31, s31, 36864
 s_cmp_eq_u32 s31, s35
 s_cselect_b32 s31, s39, s31
 s_add_u32 s86, s31, 0
 s_add_u32 s31, s31, 36864
 s_add_u32 s87, s31, 2048
 s_add_u32 s31, s31, 36864
 s_cmp_eq_u32 s31, s35
 s_cselect_b32 s31, s39, s31
 s_add_u32 s88, s31, 1024
 s_add_u32 s31, s31, 36864
 s_add_u32 s89, s31, 0
 s_add_u32 s31, s31, 36864
 s_cmp_eq_u32 s31, s35
 s_cselect_b32 s31, s39, s31
 s_add_u32 s90, s31, 2048
 s_add_u32 s31, s31, 36864
 s_add_u32 s91, s31, 1024
 s_add_u32 s31, s31, 36864
 s_cmp_eq_u32 s31, s35
 s_cselect_b32 s31, s39, s31
 s_add_u32 s92, s31, 0
 s_add_u32 s31, s31, 36864
 s_add_u32 s93, s31, 2048
 s_add_u32 s31, s31, 36864
 s_cmp_eq_u32 s31, s35
 s_cselect_b32 s31, s39, s31
 s_add_u32 s94, s31, 1024
 s_add_u32 s31, s31, 36864
 s_add_u32 s95, s31, 0
 s_add_u32 s31, s31, 36864
 s_cmp_eq_u32 s31, s35
 s_cselect_b32 s31, s39, s31
 s_add_u32 s96, s31, 2048
 s_add_u32 s31, s31, 36864
 s_add_u32 s97, s31, 1024
 s_add_u32 s31, s31, 36864
 s_cmp_eq_u32 s31, s35
 s_cselect_b32 s31, s39, s31
 s_add_u32 s98, s31, 0
 s_add_u32 s31, s31, 36864
 s_add_u32 s99, s31, 2048
 s_add_u32 s31, s31, 36864
 s_cmp_eq_u32 s31, s35
 s_cselect_b32 s31, s39, s31
 s_add_u32 s100, s31, 1024
 s_add_u32 s31, s31, 36864
 s_add_u32 s101, s31, 0
 s_sub_u32 s20, s20, 2048
 s_subb_u32 s21, s21, 0
 s_mov_b32 s22, 5310464
 s_mov_b32 s4, 0x3ae38e39
 s_mov_b32 s5, 0x3f803f80
 s_mov_b32 s33, -3
 buffer_load_dwordx4 v[192:195], v22, s[12:15], s43 offen offset:128
 s_waitcnt vmcnt(10)
 v_dot2_f32_bf16 v28, v152, v152, 0
 v_dot2_f32_bf16 v32, v152, s5, 0
 v_dot2_f32_bf16 v29, v153, v153, 0
 v_dot2_f32_bf16 v33, v153, s5, 0
 v_dot2_f32_bf16 v30, v154, v154, 0
 v_dot2_f32_bf16 v34, v154, s5, 0
 v_dot2_f32_bf16 v31, v155, v155, 0
 v_dot2_f32_bf16 v35, v155, s5, 0
 buffer_load_dwordx4 v[196:199], v22, s[12:15], s43 offen offset:256
 s_waitcnt vmcnt(10)
 v_dot2_f32_bf16 v28, v156, v156, v28
 v_dot2_f32_bf16 v32, v156, s5, v32
 v_dot2_f32_bf16 v29, v157, v157, v29
 v_dot2_f32_bf16 v33, v157, s5, v33
 v_dot2_f32_bf16 v30, v158, v158, v30
 v_dot2_f32_bf16 v34, v158, s5, v34
 v_dot2_f32_bf16 v31, v159, v159, v31
 v_dot2_f32_bf16 v35, v159, s5, v35
 buffer_load_dwordx4 v[200:203], v22, s[12:15], s43 offen offset:384
 s_waitcnt vmcnt(10)
 v_dot2_f32_bf16 v28, v160, v160, v28
 v_dot2_f32_bf16 v32, v160, s5, v32
 v_dot2_f32_bf16 v29, v161, v161, v29
 v_dot2_f32_bf16 v33, v161, s5, v33
 v_dot2_f32_bf16 v30, v162, v162, v30
 v_dot2_f32_bf16 v34, v162, s5, v34
 v_dot2_f32_bf16 v31, v163, v163, v31
 v_dot2_f32_bf16 v35, v163, s5, v35
 buffer_load_dwordx4 v[204:207], v22, s[12:15], s43 offen offset:512
 s_waitcnt vmcnt(10)
 v_dot2_f32_bf16 v28, v164, v164, v28
 v_dot2_f32_bf16 v32, v164, s5, v32
 v_dot2_f32_bf16 v29, v165, v165, v29
 v_dot2_f32_bf16 v33, v165, s5, v33
 v_dot2_f32_bf16 v30, v166, v166, v30
 v_dot2_f32_bf16 v34, v166, s5, v34
 v_dot2_f32_bf16 v31, v167, v167, v31
 v_dot2_f32_bf16 v35, v167, s5, v35
 buffer_load_dwordx4 v[208:211], v22, s[12:15], s43 offen offset:640
 s_waitcnt vmcnt(10)
 v_dot2_f32_bf16 v28, v168, v168, v28
 v_dot2_f32_bf16 v32, v168, s5, v32
 v_dot2_f32_bf16 v29, v169, v169, v29
 v_dot2_f32_bf16 v33, v169, s5, v33
 v_dot2_f32_bf16 v30, v170, v170, v30
 v_dot2_f32_bf16 v34, v170, s5, v34
 v_dot2_f32_bf16 v31, v171, v171, v31
 v_dot2_f32_bf16 v35, v171, s5, v35
 buffer_load_dwordx4 v[212:215], v22, s[12:15], s43 offen offset:768
 s_waitcnt vmcnt(10)
 v_dot2_f32_bf16 v28, v172, v172, v28
 v_dot2_f32_bf16 v32, v172, s5, v32
 v_dot2_f32_bf16 v29, v173, v173, v29
 v_dot2_f32_bf16 v33, v173, s5, v33
 v_dot2_f32_bf16 v30, v174, v174, v30
 v_dot2_f32_bf16 v34, v174, s5, v34
 v_dot2_f32_bf16 v31, v175, v175, v31
 v_dot2_f32_bf16 v35, v175, s5, v35
 buffer_load_dwordx4 v[216:219], v22, s[12:15], s43 offen offset:896
 s_waitcnt vmcnt(10)
 v_dot2_f32_bf16 v28, v176, v176, v28
 v_dot2_f32_bf16 v32, v176, s5, v32
 v_dot2_f32_bf16 v29, v177, v177, v29
 v_dot2_f32_bf16 v33, v177, s5, v33
 v_dot2_f32_bf16 v30, v178, v178, v30
 v_dot2_f32_bf16 v34, v178, s5, v34
 v_dot2_f32_bf16 v31, v179, v179, v31
 v_dot2_f32_bf16 v35, v179, s5, v35
 buffer_load_dwordx4 v[220:223], v22, s[12:15], s43 offen offset:1024
 s_waitcnt vmcnt(10)
 v_dot2_f32_bf16 v28, v180, v180, v28
 v_dot2_f32_bf16 v32, v180, s5, v32
 v_dot2_f32_bf16 v29, v181, v181, v29
 v_dot2_f32_bf16 v33, v181, s5, v33
 v_dot2_f32_bf16 v30, v182, v182, v30
 v_dot2_f32_bf16 v34, v182, s5, v34
 v_dot2_f32_bf16 v31, v183, v183, v31
 v_dot2_f32_bf16 v35, v183, s5, v35
 buffer_load_dwordx4 v[224:227], v16, s[12:15], s44 offen offset:0
 s_waitcnt vmcnt(10)
 v_dot2_f32_bf16 v28, v184, v184, v28
 v_dot2_f32_bf16 v32, v184, s5, v32
 v_dot2_f32_bf16 v29, v185, v185, v29
 v_dot2_f32_bf16 v33, v185, s5, v33
 v_dot2_f32_bf16 v30, v186, v186, v30
 v_dot2_f32_bf16 v34, v186, s5, v34
 v_dot2_f32_bf16 v31, v187, v187, v31
 v_dot2_f32_bf16 v35, v187, s5, v35
 buffer_load_dwordx4 v[228:231], v16, s[12:15], s44 offen offset:256
 v_add_f32 v28, v28, v29
 v_add_f32 v30, v30, v31
 v_add_f32 v32, v32, v33
 v_add_f32 v34, v34, v35
 v_add_f32 v28, v28, v30
 v_add_f32 v32, v32, v34
 s_nop 0
 v_add_f32_dpp v28, v28, v28 quad_perm:[1,0,3,2] row_mask:0xf bank_mask:0xf
 v_add_f32_dpp v32, v32, v32 quad_perm:[1,0,3,2] row_mask:0xf bank_mask:0xf
 s_nop 0
 v_add_f32_dpp v28, v28, v28 quad_perm:[2,3,0,1] row_mask:0xf bank_mask:0xf
 v_add_f32_dpp v32, v32, v32 quad_perm:[2,3,0,1] row_mask:0xf bank_mask:0xf
 s_nop 0
 v_add_f32_dpp v28, v28, v28 row_half_mirror row_mask:0xf bank_mask:0xf
 v_add_f32_dpp v32, v32, v32 row_half_mirror row_mask:0xf bank_mask:0xf
 v_mul_f32 v32, s4, v32
 v_mul_f32 v28, s4, v28
 v_fma_f32 v28, -v32, v32, v28
 v_max_f32 v28, 0, v28
 v_add_f32 v28, 0x3727c5ac, v28
 v_rsq_f32 v36, v28
 s_nop 0
 v_mul_f32 v36, 0xbfb8aa3b, v36
 v_mul_f32 v38, -v36, v32
 s_waitcnt vmcnt(10)
 v_dot2_f32_bf16 v40, v188, v188, 0
 v_dot2_f32_bf16 v44, v188, s5, 0
 v_dot2_f32_bf16 v41, v189, v189, 0
 v_dot2_f32_bf16 v45, v189, s5, 0
 v_dot2_f32_bf16 v42, v190, v190, 0
 v_dot2_f32_bf16 v46, v190, s5, 0
 v_dot2_f32_bf16 v43, v191, v191, 0
 v_dot2_f32_bf16 v47, v191, s5, 0
 buffer_load_dwordx4 v[232:235], v16, s[12:15], s44 offen offset:512
 v_lshlrev_b32 v112, 16, v152
 v_and_b32 v113, 0xffff0000, v152
 v_lshlrev_b32 v114, 16, v153
 v_and_b32 v115, 0xffff0000, v153
 v_lshlrev_b32 v116, 16, v154
 v_and_b32 v117, 0xffff0000, v154
 v_lshlrev_b32 v118, 16, v155
 v_and_b32 v119, 0xffff0000, v155
 v_pk_fma_f32 v[112:113], v[112:113], v[36:37], v[38:39] op_sel_hi:[1,0,0]
 v_pk_fma_f32 v[114:115], v[114:115], v[36:37], v[38:39] op_sel_hi:[1,0,0]
 v_pk_fma_f32 v[116:117], v[116:117], v[36:37], v[38:39] op_sel_hi:[1,0,0]
 v_pk_fma_f32 v[118:119], v[118:119], v[36:37], v[38:39] op_sel_hi:[1,0,0]
 v_cvt_pk_bf16_f32 v152, v112, v113
 v_cvt_pk_bf16_f32 v153, v114, v115
 v_cvt_pk_bf16_f32 v154, v116, v117
 v_cvt_pk_bf16_f32 v155, v118, v119
 ds_write_b128 v20, v[152:155] offset:0
 v_lshlrev_b32 v112, 16, v156
 v_and_b32 v113, 0xffff0000, v156
 v_lshlrev_b32 v114, 16, v157
 s_waitcnt vmcnt(10)
 v_dot2_f32_bf16 v40, v192, v192, v40
 v_dot2_f32_bf16 v44, v192, s5, v44
 v_dot2_f32_bf16 v41, v193, v193, v41
 v_dot2_f32_bf16 v45, v193, s5, v45
 v_dot2_f32_bf16 v42, v194, v194, v42
 v_dot2_f32_bf16 v46, v194, s5, v46
 v_dot2_f32_bf16 v43, v195, v195, v43
 v_dot2_f32_bf16 v47, v195, s5, v47
 buffer_load_dwordx4 v[236:239], v16, s[12:15], s44 offen offset:768
 v_and_b32 v115, 0xffff0000, v157
 v_lshlrev_b32 v116, 16, v158
 v_and_b32 v117, 0xffff0000, v158
 v_lshlrev_b32 v118, 16, v159
 v_and_b32 v119, 0xffff0000, v159
 v_pk_fma_f32 v[112:113], v[112:113], v[36:37], v[38:39] op_sel_hi:[1,0,0]
 v_pk_fma_f32 v[114:115], v[114:115], v[36:37], v[38:39] op_sel_hi:[1,0,0]
 v_pk_fma_f32 v[116:117], v[116:117], v[36:37], v[38:39] op_sel_hi:[1,0,0]
 v_pk_fma_f32 v[118:119], v[118:119], v[36:37], v[38:39] op_sel_hi:[1,0,0]
 v_cvt_pk_bf16_f32 v156, v112, v113
 v_cvt_pk_bf16_f32 v157, v114, v115
 v_cvt_pk_bf16_f32 v158, v116, v117
 v_cvt_pk_bf16_f32 v159, v118, v119
 ds_write_b128 v20, v[156:159] offset:10240
 v_lshlrev_b32 v112, 16, v160
 v_and_b32 v113, 0xffff0000, v160
 v_lshlrev_b32 v114, 16, v161
 v_and_b32 v115, 0xffff0000, v161
 v_lshlrev_b32 v116, 16, v162
 v_and_b32 v117, 0xffff0000, v162
 s_waitcnt vmcnt(10)
 v_dot2_f32_bf16 v40, v196, v196, v40
 v_dot2_f32_bf16 v44, v196, s5, v44
 v_dot2_f32_bf16 v41, v197, v197, v41
 v_dot2_f32_bf16 v45, v197, s5, v45
 v_dot2_f32_bf16 v42, v198, v198, v42
 v_dot2_f32_bf16 v46, v198, s5, v46
 v_dot2_f32_bf16 v43, v199, v199, v43
 v_dot2_f32_bf16 v47, v199, s5, v47
 buffer_load_dwordx4 v[240:243], v17, s[12:15], s44 offen offset:1024
 v_lshlrev_b32 v118, 16, v163
 v_and_b32 v119, 0xffff0000, v163
 v_pk_fma_f32 v[112:113], v[112:113], v[36:37], v[38:39] op_sel_hi:[1,0,0]
 v_pk_fma_f32 v[114:115], v[114:115], v[36:37], v[38:39] op_sel_hi:[1,0,0]
 v_pk_fma_f32 v[116:117], v[116:117], v[36:37], v[38:39] op_sel_hi:[1,0,0]
 v_pk_fma_f32 v[118:119], v[118:119], v[36:37], v[38:39] op_sel_hi:[1,0,0]
 v_cvt_pk_bf16_f32 v160, v112, v113
 v_cvt_pk_bf16_f32 v161, v114, v115
 v_cvt_pk_bf16_f32 v162, v116, v117
 v_cvt_pk_bf16_f32 v163, v118, v119
 ds_write_b128 v20, v[160:163] offset:20480
 v_lshlrev_b32 v112, 16, v164
 v_and_b32 v113, 0xffff0000, v164
 v_lshlrev_b32 v114, 16, v165
 v_and_b32 v115, 0xffff0000, v165
 v_lshlrev_b32 v116, 16, v166
 v_and_b32 v117, 0xffff0000, v166
 v_lshlrev_b32 v118, 16, v167
 v_and_b32 v119, 0xffff0000, v167
 v_pk_fma_f32 v[112:113], v[112:113], v[36:37], v[38:39] op_sel_hi:[1,0,0]
 s_waitcnt vmcnt(10)
 v_dot2_f32_bf16 v40, v200, v200, v40
 v_dot2_f32_bf16 v44, v200, s5, v44
 v_dot2_f32_bf16 v41, v201, v201, v41
 v_dot2_f32_bf16 v45, v201, s5, v45
 v_dot2_f32_bf16 v42, v202, v202, v42
 v_dot2_f32_bf16 v46, v202, s5, v46
 v_dot2_f32_bf16 v43, v203, v203, v43
 v_dot2_f32_bf16 v47, v203, s5, v47
 s_add_u32 m0, s42, 0
 s_nop 0
 buffer_load_dwordx4 v9, s[16:19], s32 offen lds
 v_pk_fma_f32 v[114:115], v[114:115], v[36:37], v[38:39] op_sel_hi:[1,0,0]
 v_pk_fma_f32 v[116:117], v[116:117], v[36:37], v[38:39] op_sel_hi:[1,0,0]
 v_pk_fma_f32 v[118:119], v[118:119], v[36:37], v[38:39] op_sel_hi:[1,0,0]
 v_cvt_pk_bf16_f32 v164, v112, v113
 v_cvt_pk_bf16_f32 v165, v114, v115
 v_cvt_pk_bf16_f32 v166, v116, v117
 v_cvt_pk_bf16_f32 v167, v118, v119
 ds_write_b128 v20, v[164:167] offset:30720
 v_lshlrev_b32 v112, 16, v168
 v_and_b32 v113, 0xffff0000, v168
 v_lshlrev_b32 v114, 16, v169
 v_and_b32 v115, 0xffff0000, v169
 v_lshlrev_b32 v116, 16, v170
 v_and_b32 v117, 0xffff0000, v170
 v_lshlrev_b32 v118, 16, v171
 v_and_b32 v119, 0xffff0000, v171
 v_pk_fma_f32 v[112:113], v[112:113], v[36:37], v[38:39] op_sel_hi:[1,0,0]
 v_pk_fma_f32 v[114:115], v[114:115], v[36:37], v[38:39] op_sel_hi:[1,0,0]
 v_pk_fma_f32 v[116:117], v[116:117], v[36:37], v[38:39] op_sel_hi:[1,0,0]
 v_pk_fma_f32 v[118:119], v[118:119], v[36:37], v[38:39] op_sel_hi:[1,0,0]
 s_waitcnt vmcnt(10)
 v_dot2_f32_bf16 v40, v204, v204, v40
 v_dot2_f32_bf16 v44, v204, s5, v44
 v_dot2_f32_bf16 v41, v205, v205, v41
 v_dot2_f32_bf16 v45, v205, s5, v45
 v_dot2_f32_bf16 v42, v206, v206, v42
 v_dot2_f32_bf16 v46, v206, s5, v46
 v_dot2_f32_bf16 v43, v207, v207, v43
 v_dot2_f32_bf16 v47, v207, s5, v47
 buffer_load_dwordx4 v10, s[16:19], s32 offen offset:1024 lds
 v_cvt_pk_bf16_f32 v168, v112, v113
 v_cvt_pk_bf16_f32 v169, v114, v115
 v_cvt_pk_bf16_f32 v170, v116, v117
 v_cvt_pk_bf16_f32 v171, v118, v119
 ds_write_b128 v20, v[168:171] offset:40960
 v_lshlrev_b32 v112, 16, v172
 v_and_b32 v113, 0xffff0000, v172
 v_lshlrev_b32 v114, 16, v173
 v_and_b32 v115, 0xffff0000, v173
 v_lshlrev_b32 v116, 16, v174
 v_and_b32 v117, 0xffff0000, v174
 v_lshlrev_b32 v118, 16, v175
 v_and_b32 v119, 0xffff0000, v175
 v_pk_fma_f32 v[112:113], v[112:113], v[36:37], v[38:39] op_sel_hi:[1,0,0]
 v_pk_fma_f32 v[114:115], v[114:115], v[36:37], v[38:39] op_sel_hi:[1,0,0]
 v_pk_fma_f32 v[116:117], v[116:117], v[36:37], v[38:39] op_sel_hi:[1,0,0]
 v_pk_fma_f32 v[118:119], v[118:119], v[36:37], v[38:39] op_sel_hi:[1,0,0]
 v_cvt_pk_bf16_f32 v172, v112, v113
 v_cvt_pk_bf16_f32 v173, v114, v115
 v_cvt_pk_bf16_f32 v174, v116, v117
 s_waitcnt vmcnt(10)
 v_dot2_f32_bf16 v40, v208, v208, v40
 v_dot2_f32_bf16 v44, v208, s5, v44
 v_dot2_f32_bf16 v41, v209, v209, v41
 v_dot2_f32_bf16 v45, v209, s5, v45
 v_dot2_f32_bf16 v42, v210, v210, v42
 v_dot2_f32_bf16 v46, v210, s5, v46
 v_dot2_f32_bf16 v43, v211, v211, v43
 v_dot2_f32_bf16 v47, v211, s5, v47
 buffer_load_dwordx4 v11, s[16:19], s32 offen offset:2048 lds
 v_cvt_pk_bf16_f32 v175, v118, v119
 ds_write_b128 v20, v[172:175] offset:51200
 v_lshlrev_b32 v112, 16, v176
 v_and_b32 v113, 0xffff0000, v176
 v_lshlrev_b32 v114, 16, v177
 v_and_b32 v115, 0xffff0000, v177
 v_lshlrev_b32 v116, 16, v178
 v_and_b32 v117, 0xffff0000, v178
 v_lshlrev_b32 v118, 16, v179
 v_and_b32 v119, 0xffff0000, v179
 v_pk_fma_f32 v[112:113], v[112:113], v[36:37], v[38:39] op_sel_hi:[1,0,0]
 v_pk_fma_f32 v[114:115], v[114:115], v[36:37], v[38:39] op_sel_hi:[1,0,0]
 v_pk_fma_f32 v[116:117], v[116:117], v[36:37], v[38:39] op_sel_hi:[1,0,0]
 v_pk_fma_f32 v[118:119], v[118:119], v[36:37], v[38:39] op_sel_hi:[1,0,0]
 v_cvt_pk_bf16_f32 v176, v112, v113
 v_cvt_pk_bf16_f32 v177, v114, v115
 v_cvt_pk_bf16_f32 v178, v116, v117
 v_cvt_pk_bf16_f32 v179, v118, v119
 ds_write_b128 v21, v[176:179] offset:0
 v_lshlrev_b32 v112, 16, v180
 s_waitcnt vmcnt(10)
 v_dot2_f32_bf16 v40, v212, v212, v40
 v_dot2_f32_bf16 v44, v212, s5, v44
 v_dot2_f32_bf16 v41, v213, v213, v41
 v_dot2_f32_bf16 v45, v213, s5, v45
 v_dot2_f32_bf16 v42, v214, v214, v42
 v_dot2_f32_bf16 v46, v214, s5, v46
 v_dot2_f32_bf16 v43, v215, v215, v43
 v_dot2_f32_bf16 v47, v215, s5, v47
 s_add_u32 m0, s42, 12288
 s_add_u32 s32, s32, 884736
 buffer_load_dwordx4 v9, s[16:19], s32 offen lds
 v_and_b32 v113, 0xffff0000, v180
 v_lshlrev_b32 v114, 16, v181
 v_and_b32 v115, 0xffff0000, v181
 v_lshlrev_b32 v116, 16, v182
 v_and_b32 v117, 0xffff0000, v182
 v_lshlrev_b32 v118, 16, v183
 v_and_b32 v119, 0xffff0000, v183
 v_pk_fma_f32 v[112:113], v[112:113], v[36:37], v[38:39] op_sel_hi:[1,0,0]
 v_pk_fma_f32 v[114:115], v[114:115], v[36:37], v[38:39] op_sel_hi:[1,0,0]
 v_pk_fma_f32 v[116:117], v[116:117], v[36:37], v[38:39] op_sel_hi:[1,0,0]
 v_pk_fma_f32 v[118:119], v[118:119], v[36:37], v[38:39] op_sel_hi:[1,0,0]
 v_cvt_pk_bf16_f32 v180, v112, v113
 v_cvt_pk_bf16_f32 v181, v114, v115
 v_cvt_pk_bf16_f32 v182, v116, v117
 v_cvt_pk_bf16_f32 v183, v118, v119
 ds_write_b128 v21, v[180:183] offset:10240
 v_lshlrev_b32 v112, 16, v184
 v_and_b32 v113, 0xffff0000, v184
 v_lshlrev_b32 v114, 16, v185
 v_and_b32 v115, 0xffff0000, v185
 s_waitcnt vmcnt(10)
 v_dot2_f32_bf16 v40, v216, v216, v40
 v_dot2_f32_bf16 v44, v216, s5, v44
 v_dot2_f32_bf16 v41, v217, v217, v41
 v_dot2_f32_bf16 v45, v217, s5, v45
 v_dot2_f32_bf16 v42, v218, v218, v42
 v_dot2_f32_bf16 v46, v218, s5, v46
 v_dot2_f32_bf16 v43, v219, v219, v43
 v_dot2_f32_bf16 v47, v219, s5, v47
 buffer_load_dwordx4 v10, s[16:19], s32 offen offset:1024 lds
 v_lshlrev_b32 v116, 16, v186
 v_and_b32 v117, 0xffff0000, v186
 v_lshlrev_b32 v118, 16, v187
 v_and_b32 v119, 0xffff0000, v187
 v_pk_fma_f32 v[112:113], v[112:113], v[36:37], v[38:39] op_sel_hi:[1,0,0]
 v_pk_fma_f32 v[114:115], v[114:115], v[36:37], v[38:39] op_sel_hi:[1,0,0]
 v_pk_fma_f32 v[116:117], v[116:117], v[36:37], v[38:39] op_sel_hi:[1,0,0]
 v_pk_fma_f32 v[118:119], v[118:119], v[36:37], v[38:39] op_sel_hi:[1,0,0]
 v_cvt_pk_bf16_f32 v184, v112, v113
 v_cvt_pk_bf16_f32 v185, v114, v115
 v_cvt_pk_bf16_f32 v186, v116, v117
 v_cvt_pk_bf16_f32 v187, v118, v119
 ds_write_b128 v21, v[184:187] offset:20480
 s_waitcnt vmcnt(10)
 v_dot2_f32_bf16 v40, v220, v220, v40
 v_dot2_f32_bf16 v44, v220, s5, v44
 v_dot2_f32_bf16 v41, v221, v221, v41
 v_dot2_f32_bf16 v45, v221, s5, v45
 v_dot2_f32_bf16 v42, v222, v222, v42
 v_dot2_f32_bf16 v46, v222, s5, v46
 v_dot2_f32_bf16 v43, v223, v223, v43
 v_dot2_f32_bf16 v47, v223, s5, v47
 buffer_load_dwordx4 v11, s[16:19], s32 offen offset:2048 lds
 v_add_f32 v40, v40, v41
 v_add_f32 v42, v42, v43
 v_add_f32 v44, v44, v45
 v_add_f32 v46, v46, v47
 v_add_f32 v40, v40, v42
 v_add_f32 v44, v44, v46
 s_nop 0
 v_add_f32_dpp v40, v40, v40 quad_perm:[1,0,3,2] row_mask:0xf bank_mask:0xf
 v_add_f32_dpp v44, v44, v44 quad_perm:[1,0,3,2] row_mask:0xf bank_mask:0xf
 s_nop 0
 v_add_f32_dpp v40, v40, v40 quad_perm:[2,3,0,1] row_mask:0xf bank_mask:0xf
 v_add_f32_dpp v44, v44, v44 quad_perm:[2,3,0,1] row_mask:0xf bank_mask:0xf
 s_nop 0
 v_add_f32_dpp v40, v40, v40 row_half_mirror row_mask:0xf bank_mask:0xf
 v_add_f32_dpp v44, v44, v44 row_half_mirror row_mask:0xf bank_mask:0xf
 v_mul_f32 v44, s4, v44
 v_mul_f32 v40, s4, v40
 v_fma_f32 v40, -v44, v44, v40
 v_max_f32 v40, 0, v40
 v_add_f32 v40, 0x3727c5ac, v40
 v_rsq_f32 v48, v40
 s_nop 0
 v_mul_f32 v48, 0xbfb8aa3b, v48
 v_mul_f32 v50, -v48, v44
 v_lshlrev_b32 v120, 16, v188
 v_and_b32 v121, 0xffff0000, v188
 v_lshlrev_b32 v122, 16, v189
 v_and_b32 v123, 0xffff0000, v189
 v_lshlrev_b32 v124, 16, v190
 v_and_b32 v125, 0xffff0000, v190
 v_lshlrev_b32 v126, 16, v191
 v_and_b32 v127, 0xffff0000, v191
 v_pk_fma_f32 v[120:121], v[120:121], v[48:49], v[50:51] op_sel_hi:[1,0,0]
 v_pk_fma_f32 v[122:123], v[122:123], v[48:49], v[50:51] op_sel_hi:[1,0,0]
 v_pk_fma_f32 v[124:125], v[124:125], v[48:49], v[50:51] op_sel_hi:[1,0,0]
 v_pk_fma_f32 v[126:127], v[126:127], v[48:49], v[50:51] op_sel_hi:[1,0,0]
 v_cvt_pk_bf16_f32 v188, v120, v121
 v_cvt_pk_bf16_f32 v189, v122, v123
 v_cvt_pk_bf16_f32 v190, v124, v125
 s_waitcnt vmcnt(10)
 v_dot2_f32_bf16 v52, v224, v224, 0
 v_dot2_f32_bf16 v56, v224, s5, 0
 v_dot2_f32_bf16 v53, v225, v225, 0
 v_dot2_f32_bf16 v57, v225, s5, 0
 v_dot2_f32_bf16 v54, v226, v226, 0
 v_dot2_f32_bf16 v58, v226, s5, 0
 v_dot2_f32_bf16 v55, v227, v227, 0
 v_dot2_f32_bf16 v59, v227, s5, 0
 s_add_u32 m0, s42, 24576
 s_add_u32 s32, s32, 884736
 buffer_load_dwordx4 v9, s[16:19], s32 offen lds
 v_cvt_pk_bf16_f32 v191, v126, v127
 ds_write_b128 v20, v[188:191] offset:512
 v_lshlrev_b32 v120, 16, v192
 v_and_b32 v121, 0xffff0000, v192
 v_lshlrev_b32 v122, 16, v193
 v_and_b32 v123, 0xffff0000, v193
 v_lshlrev_b32 v124, 16, v194
 v_and_b32 v125, 0xffff0000, v194
 v_lshlrev_b32 v126, 16, v195
 v_and_b32 v127, 0xffff0000, v195
 v_pk_fma_f32 v[120:121], v[120:121], v[48:49], v[50:51] op_sel_hi:[1,0,0]
 v_pk_fma_f32 v[122:123], v[122:123], v[48:49], v[50:51] op_sel_hi:[1,0,0]
 v_pk_fma_f32 v[124:125], v[124:125], v[48:49], v[50:51] op_sel_hi:[1,0,0]
 v_pk_fma_f32 v[126:127], v[126:127], v[48:49], v[50:51] op_sel_hi:[1,0,0]
 v_cvt_pk_bf16_f32 v192, v120, v121
 v_cvt_pk_bf16_f32 v193, v122, v123
 v_cvt_pk_bf16_f32 v194, v124, v125
 v_cvt_pk_bf16_f32 v195, v126, v127
 ds_write_b128 v20, v[192:195] offset:10752
 v_lshlrev_b32 v120, 16, v196
 v_and_b32 v121, 0xffff0000, v196
 v_lshlrev_b32 v122, 16, v197
 v_and_b32 v123, 0xffff0000, v197
 v_lshlrev_b32 v124, 16, v198
 v_and_b32 v125, 0xffff0000, v198
 v_lshlrev_b32 v126, 16, v199
 v_and_b32 v127, 0xffff0000, v199
 v_pk_fma_f32 v[120:121], v[120:121], v[48:49], v[50:51] op_sel_hi:[1,0,0]
 v_pk_fma_f32 v[122:123], v[122:123], v[48:49], v[50:51] op_sel_hi:[1,0,0]
 v_pk_fma_f32 v[124:125], v[124:125], v[48:49], v[50:51] op_sel_hi:[1,0,0]
 v_pk_fma_f32 v[126:127], v[126:127], v[48:49], v[50:51] op_sel_hi:[1,0,0]
 v_cvt_pk_bf16_f32 v196, v120, v121
 v_cvt_pk_bf16_f32 v197, v122, v123
 v_cvt_pk_bf16_f32 v198, v124, v125
 v_cvt_pk_bf16_f32 v199, v126, v127
 s_waitcnt vmcnt(10)
 v_dot2_f32_bf16 v52, v228, v228, v52
 v_dot2_f32_bf16 v56, v228, s5, v56
 v_dot2_f32_bf16 v53, v229, v229, v53
 v_dot2_f32_bf16 v57, v229, s5, v57
 v_dot2_f32_bf16 v54, v230, v230, v54
 v_dot2_f32_bf16 v58, v230, s5, v58
 v_dot2_f32_bf16 v55, v231, v231, v55
 v_dot2_f32_bf16 v59, v231, s5, v59
 buffer_load_dwordx4 v10, s[16:19], s32 offen offset:1024 lds
 ds_write_b128 v20, v[196:199] offset:20992
 v_lshlrev_b32 v120, 16, v200
 v_and_b32 v121, 0xffff0000, v200
 v_lshlrev_b32 v122, 16, v201
 v_and_b32 v123, 0xffff0000, v201
 v_lshlrev_b32 v124, 16, v202
 v_and_b32 v125, 0xffff0000, v202
 v_lshlrev_b32 v126, 16, v203
 v_and_b32 v127, 0xffff0000, v203
 v_pk_fma_f32 v[120:121], v[120:121], v[48:49], v[50:51] op_sel_hi:[1,0,0]
 v_pk_fma_f32 v[122:123], v[122:123], v[48:49], v[50:51] op_sel_hi:[1,0,0]
 v_pk_fma_f32 v[124:125], v[124:125], v[48:49], v[50:51] op_sel_hi:[1,0,0]
 v_pk_fma_f32 v[126:127], v[126:127], v[48:49], v[50:51] op_sel_hi:[1,0,0]
 v_cvt_pk_bf16_f32 v200, v120, v121
 v_cvt_pk_bf16_f32 v201, v122, v123
 v_cvt_pk_bf16_f32 v202, v124, v125
 v_cvt_pk_bf16_f32 v203, v126, v127
 ds_write_b128 v20, v[200:203] offset:31232
 v_lshlrev_b32 v120, 16, v204
 v_and_b32 v121, 0xffff0000, v204
 v_lshlrev_b32 v122, 16, v205
 v_and_b32 v123, 0xffff0000, v205
 v_lshlrev_b32 v124, 16, v206
 v_and_b32 v125, 0xffff0000, v206
 v_lshlrev_b32 v126, 16, v207
 v_and_b32 v127, 0xffff0000, v207
 v_pk_fma_f32 v[120:121], v[120:121], v[48:49], v[50:51] op_sel_hi:[1,0,0]
 v_pk_fma_f32 v[122:123], v[122:123], v[48:49], v[50:51] op_sel_hi:[1,0,0]
 v_pk_fma_f32 v[124:125], v[124:125], v[48:49], v[50:51] op_sel_hi:[1,0,0]
 v_pk_fma_f32 v[126:127], v[126:127], v[48:49], v[50:51] op_sel_hi:[1,0,0]
 v_cvt_pk_bf16_f32 v204, v120, v121
 v_cvt_pk_bf16_f32 v205, v122, v123
 v_cvt_pk_bf16_f32 v206, v124, v125
 v_cvt_pk_bf16_f32 v207, v126, v127
 ds_write_b128 v20, v[204:207] offset:41472
 s_waitcnt vmcnt(10)
 v_dot2_f32_bf16 v52, v232, v232, v52
 v_dot2_f32_bf16 v56, v232, s5, v56
 v_dot2_f32_bf16 v53, v233, v233, v53
 v_dot2_f32_bf16 v57, v233, s5, v57
 v_dot2_f32_bf16 v54, v234, v234, v54
 v_dot2_f32_bf16 v58, v234, s5, v58
 v_dot2_f32_bf16 v55, v235, v235, v55
 v_dot2_f32_bf16 v59, v235, s5, v59
 buffer_load_dwordx4 v11, s[16:19], s32 offen offset:2048 lds
 v_lshlrev_b32 v120, 16, v208
 v_and_b32 v121, 0xffff0000, v208
 v_lshlrev_b32 v122, 16, v209
 v_and_b32 v123, 0xffff0000, v209
 v_lshlrev_b32 v124, 16, v210
 v_and_b32 v125, 0xffff0000, v210
 v_lshlrev_b32 v126, 16, v211
 v_and_b32 v127, 0xffff0000, v211
 v_pk_fma_f32 v[120:121], v[120:121], v[48:49], v[50:51] op_sel_hi:[1,0,0]
 v_pk_fma_f32 v[122:123], v[122:123], v[48:49], v[50:51] op_sel_hi:[1,0,0]
 v_pk_fma_f32 v[124:125], v[124:125], v[48:49], v[50:51] op_sel_hi:[1,0,0]
 v_pk_fma_f32 v[126:127], v[126:127], v[48:49], v[50:51] op_sel_hi:[1,0,0]
 v_cvt_pk_bf16_f32 v208, v120, v121
 v_cvt_pk_bf16_f32 v209, v122, v123
 v_cvt_pk_bf16_f32 v210, v124, v125
 v_cvt_pk_bf16_f32 v211, v126, v127
 ds_write_b128 v20, v[208:211] offset:51712
 v_lshlrev_b32 v120, 16, v212
 v_and_b32 v121, 0xffff0000, v212
 v_lshlrev_b32 v122, 16, v213
 v_and_b32 v123, 0xffff0000, v213
 v_lshlrev_b32 v124, 16, v214
 v_and_b32 v125, 0xffff0000, v214
 v_lshlrev_b32 v126, 16, v215
 v_and_b32 v127, 0xffff0000, v215
 v_pk_fma_f32 v[120:121], v[120:121], v[48:49], v[50:51] op_sel_hi:[1,0,0]
 v_pk_fma_f32 v[122:123], v[122:123], v[48:49], v[50:51] op_sel_hi:[1,0,0]
 v_pk_fma_f32 v[124:125], v[124:125], v[48:49], v[50:51] op_sel_hi:[1,0,0]
 v_pk_fma_f32 v[126:127], v[126:127], v[48:49], v[50:51] op_sel_hi:[1,0,0]
 v_cvt_pk_bf16_f32 v212, v120, v121
 v_cvt_pk_bf16_f32 v213, v122, v123
 v_cvt_pk_bf16_f32 v214, v124, v125
 v_cvt_pk_bf16_f32 v215, v126, v127
 ds_write_b128 v21, v[212:215] offset:512
 v_lshlrev_b32 v120, 16, v216
 s_waitcnt vmcnt(10)
 v_dot2_f32_bf16 v52, v236, v236, v52
 v_dot2_f32_bf16 v56, v236, s5, v56
 v_dot2_f32_bf16 v53, v237, v237, v53
 v_dot2_f32_bf16 v57, v237, s5, v57
 v_dot2_f32_bf16 v54, v238, v238, v54
 v_dot2_f32_bf16 v58, v238, s5, v58
 v_dot2_f32_bf16 v55, v239, v239, v55
 v_dot2_f32_bf16 v59, v239, s5, v59
 s_add_u32 m0, s42, 36864
 s_add_u32 s32, s32, 884736
 buffer_load_dwordx4 v9, s[16:19], s32 offen lds
 v_and_b32 v121, 0xffff0000, v216
 v_lshlrev_b32 v122, 16, v217
 v_and_b32 v123, 0xffff0000, v217
 v_lshlrev_b32 v124, 16, v218
 v_and_b32 v125, 0xffff0000, v218
 v_lshlrev_b32 v126, 16, v219
 v_and_b32 v127, 0xffff0000, v219
 v_pk_fma_f32 v[120:121], v[120:121], v[48:49], v[50:51] op_sel_hi:[1,0,0]
 v_pk_fma_f32 v[122:123], v[122:123], v[48:49], v[50:51] op_sel_hi:[1,0,0]
 v_pk_fma_f32 v[124:125], v[124:125], v[48:49], v[50:51] op_sel_hi:[1,0,0]
 v_pk_fma_f32 v[126:127], v[126:127], v[48:49], v[50:51] op_sel_hi:[1,0,0]
 v_cvt_pk_bf16_f32 v216, v120, v121
 v_cvt_pk_bf16_f32 v217, v122, v123
 v_cvt_pk_bf16_f32 v218, v124, v125
 v_cvt_pk_bf16_f32 v219, v126, v127
 ds_write_b128 v21, v[216:219] offset:10752
 v_lshlrev_b32 v120, 16, v220
 v_and_b32 v121, 0xffff0000, v220
 v_lshlrev_b32 v122, 16, v221
 v_and_b32 v123, 0xffff0000, v221
 v_lshlrev_b32 v124, 16, v222
 v_and_b32 v125, 0xffff0000, v222
 v_lshlrev_b32 v126, 16, v223
 v_and_b32 v127, 0xffff0000, v223
 v_pk_fma_f32 v[120:121], v[120:121], v[48:49], v[50:51] op_sel_hi:[1,0,0]
 v_pk_fma_f32 v[122:123], v[122:123], v[48:49], v[50:51] op_sel_hi:[1,0,0]
 v_pk_fma_f32 v[124:125], v[124:125], v[48:49], v[50:51] op_sel_hi:[1,0,0]
 v_pk_fma_f32 v[126:127], v[126:127], v[48:49], v[50:51] op_sel_hi:[1,0,0]
 v_cvt_pk_bf16_f32 v220, v120, v121
 v_cvt_pk_bf16_f32 v221, v122, v123
 v_cvt_pk_bf16_f32 v222, v124, v125
 v_cvt_pk_bf16_f32 v223, v126, v127
 ds_write_b128 v21, v[220:223] offset:20992
 s_waitcnt vmcnt(10)
 v_dot2_f32_bf16 v52, v240, v240, v52
 v_dot2_f32_bf16 v56, v240, s5, v56
 v_dot2_f32_bf16 v53, v241, v241, v53
 v_dot2_f32_bf16 v57, v241, s5, v57
 v_dot2_f32_bf16 v54, v242, v242, v54
 v_dot2_f32_bf16 v58, v242, s5, v58
 v_dot2_f32_bf16 v55, v243, v243, v55
 v_dot2_f32_bf16 v59, v243, s5, v59
 buffer_load_dwordx4 v10, s[16:19], s32 offen offset:1024 lds
 v_add_f32 v52, v52, v53
 v_add_f32 v54, v54, v55
 v_add_f32 v56, v56, v57
 v_add_f32 v58, v58, v59
 v_add_f32 v52, v52, v54
 v_add_f32 v56, v56, v58
 s_nop 0
 v_add_f32_dpp v52, v52, v52 quad_perm:[1,0,3,2] row_mask:0xf bank_mask:0xf
 v_add_f32_dpp v56, v56, v56 quad_perm:[1,0,3,2] row_mask:0xf bank_mask:0xf
 s_nop 0
 v_add_f32_dpp v52, v52, v52 quad_perm:[2,3,0,1] row_mask:0xf bank_mask:0xf
 v_add_f32_dpp v56, v56, v56 quad_perm:[2,3,0,1] row_mask:0xf bank_mask:0xf
 s_nop 0
 v_add_f32_dpp v52, v52, v52 row_half_mirror row_mask:0xf bank_mask:0xf
 v_add_f32_dpp v56, v56, v56 row_half_mirror row_mask:0xf bank_mask:0xf
 s_nop 0
 v_add_f32_dpp v52, v52, v52 row_mirror row_mask:0xf bank_mask:0xf
 v_add_f32_dpp v56, v56, v56 row_mirror row_mask:0xf bank_mask:0xf
 v_mul_f32 v56, s4, v56
 v_mul_f32 v52, s4, v52
 v_fma_f32 v52, -v56, v56, v52
 buffer_load_dwordx4 v11, s[16:19], s32 offen offset:2048 lds
 v_max_f32 v52, 0, v52
 v_add_f32 v52, 0x3727c5ac, v52
 v_rsq_f32 v60, v52
 s_nop 0
 v_mul_f32 v60, 0xbfb8aa3b, v60
 v_mul_f32 v62, -v60, v56
 v_lshlrev_b32 v128, 16, v224
 v_and_b32 v129, 0xffff0000, v224
 v_lshlrev_b32 v130, 16, v225
 v_and_b32 v131, 0xffff0000, v225
 v_lshlrev_b32 v132, 16, v226
 v_and_b32 v133, 0xffff0000, v226
 v_lshlrev_b32 v134, 16, v227
 v_and_b32 v135, 0xffff0000, v227
 v_pk_fma_f32 v[128:129], v[128:129], v[60:61], v[62:63] op_sel_hi:[1,0,0]
 v_pk_fma_f32 v[130:131], v[130:131], v[60:61], v[62:63] op_sel_hi:[1,0,0]
 v_pk_fma_f32 v[132:133], v[132:133], v[60:61], v[62:63] op_sel_hi:[1,0,0]
 v_pk_fma_f32 v[134:135], v[134:135], v[60:61], v[62:63] op_sel_hi:[1,0,0]
 v_cvt_pk_bf16_f32 v224, v128, v129
 s_add_u32 m0, s42, 49152
 s_add_u32 s32, s32, 884736
 buffer_load_dwordx4 v9, s[16:19], s32 offen lds
 v_cvt_pk_bf16_f32 v225, v130, v131
 v_cvt_pk_bf16_f32 v226, v132, v133
 v_cvt_pk_bf16_f32 v227, v134, v135
 ds_write_b128 v18, v[224:227] offset:0
 v_lshlrev_b32 v128, 16, v228
 v_and_b32 v129, 0xffff0000, v228
 v_lshlrev_b32 v130, 16, v229
 v_and_b32 v131, 0xffff0000, v229
 v_lshlrev_b32 v132, 16, v230
 v_and_b32 v133, 0xffff0000, v230
 v_lshlrev_b32 v134, 16, v231
 v_and_b32 v135, 0xffff0000, v231
 v_pk_fma_f32 v[128:129], v[128:129], v[60:61], v[62:63] op_sel_hi:[1,0,0]
 v_pk_fma_f32 v[130:131], v[130:131], v[60:61], v[62:63] op_sel_hi:[1,0,0]
 v_pk_fma_f32 v[132:133], v[132:133], v[60:61], v[62:63] op_sel_hi:[1,0,0]
 v_pk_fma_f32 v[134:135], v[134:135], v[60:61], v[62:63] op_sel_hi:[1,0,0]
 v_cvt_pk_bf16_f32 v228, v128, v129
 v_cvt_pk_bf16_f32 v229, v130, v131
 buffer_load_dwordx4 v10, s[16:19], s32 offen offset:1024 lds
 v_cvt_pk_bf16_f32 v230, v132, v133
 v_cvt_pk_bf16_f32 v231, v134, v135
 ds_write_b128 v18, v[228:231] offset:20480
 v_lshlrev_b32 v128, 16, v232
 v_and_b32 v129, 0xffff0000, v232
 v_lshlrev_b32 v130, 16, v233
 v_and_b32 v131, 0xffff0000, v233
 v_lshlrev_b32 v132, 16, v234
 v_and_b32 v133, 0xffff0000, v234
 v_lshlrev_b32 v134, 16, v235
 v_and_b32 v135, 0xffff0000, v235
 v_pk_fma_f32 v[128:129], v[128:129], v[60:61], v[62:63] op_sel_hi:[1,0,0]
 v_pk_fma_f32 v[130:131], v[130:131], v[60:61], v[62:63] op_sel_hi:[1,0,0]
 v_pk_fma_f32 v[132:133], v[132:133], v[60:61], v[62:63] op_sel_hi:[1,0,0]
 v_pk_fma_f32 v[134:135], v[134:135], v[60:61], v[62:63] op_sel_hi:[1,0,0]
 v_cvt_pk_bf16_f32 v232, v128, v129
 v_cvt_pk_bf16_f32 v233, v130, v131
 v_cvt_pk_bf16_f32 v234, v132, v133
 buffer_load_dwordx4 v11, s[16:19], s32 offen offset:2048 lds
 v_cvt_pk_bf16_f32 v235, v134, v135
 ds_write_b128 v18, v[232:235] offset:40960
 v_lshlrev_b32 v128, 16, v236
 v_and_b32 v129, 0xffff0000, v236
 v_lshlrev_b32 v130, 16, v237
 v_and_b32 v131, 0xffff0000, v237
 v_lshlrev_b32 v132, 16, v238
 v_and_b32 v133, 0xffff0000, v238
 v_lshlrev_b32 v134, 16, v239
 v_and_b32 v135, 0xffff0000, v239
 v_pk_fma_f32 v[128:129], v[128:129], v[60:61], v[62:63] op_sel_hi:[1,0,0]
 v_pk_fma_f32 v[130:131], v[130:131], v[60:61], v[62:63] op_sel_hi:[1,0,0]
 v_pk_fma_f32 v[132:133], v[132:133], v[60:61], v[62:63] op_sel_hi:[1,0,0]
 v_pk_fma_f32 v[134:135], v[134:135], v[60:61], v[62:63] op_sel_hi:[1,0,0]
 v_cvt_pk_bf16_f32 v236, v128, v129
 v_cvt_pk_bf16_f32 v237, v130, v131
 v_cvt_pk_bf16_f32 v238, v132, v133
 v_cvt_pk_bf16_f32 v239, v134, v135
 buffer_load_dword v111, v110, s[52:55], s45 offen
 ds_write_b128 v18, v[236:239] offset:61440
 v_lshlrev_b32 v128, 16, v240
 v_and_b32 v129, 0xffff0000, v240
 v_lshlrev_b32 v130, 16, v241
 v_and_b32 v131, 0xffff0000, v241
 v_lshlrev_b32 v132, 16, v242
 v_and_b32 v133, 0xffff0000, v242
 v_lshlrev_b32 v134, 16, v243
 v_and_b32 v135, 0xffff0000, v243
 v_pk_fma_f32 v[128:129], v[128:129], v[60:61], v[62:63] op_sel_hi:[1,0,0]
 v_pk_fma_f32 v[130:131], v[130:131], v[60:61], v[62:63] op_sel_hi:[1,0,0]
 v_pk_fma_f32 v[132:133], v[132:133], v[60:61], v[62:63] op_sel_hi:[1,0,0]
 v_pk_fma_f32 v[134:135], v[134:135], v[60:61], v[62:63] op_sel_hi:[1,0,0]
 v_cvt_pk_bf16_f32 v240, v128, v129
 v_cvt_pk_bf16_f32 v241, v130, v131
 v_cvt_pk_bf16_f32 v242, v132, v133
 v_cvt_pk_bf16_f32 v243, v134, v135
 ds_write_b128 v19, v[240:243]
 s_waitcnt vmcnt(13) lgkmcnt(0)
 s_barrier
 ds_read_b64_tr_b16 v[68:69], v2 offset:0
 ds_read_b64_tr_b16 v[70:71], v2 offset:512
 ds_read_b64_tr_b16 v[72:73], v2 offset:1024
 ds_read_b64_tr_b16 v[74:75], v2 offset:1536
 ds_read_b64_tr_b16 v[76:77], v2 offset:2048
 ds_read_b64_tr_b16 v[78:79], v2 offset:2560
 ds_read_b128 a[16:19], v4 offset:4096
 ds_read_b128 a[36:39], v4 offset:9216
 ds_read_b128 a[56:59], v4 offset:14336
 ds_read_b128 a[0:3], v4 offset:0
 ds_read_b128 a[20:23], v4 offset:5120
 ds_read_b128 a[40:43], v4 offset:10240
 ds_read_b128 a[4:7], v4 offset:1024
 ds_read_b128 a[24:27], v4 offset:6144
 ds_read_b128 a[44:47], v4 offset:11264
 ds_read_b128 a[8:11], v4 offset:2048
 ds_read_b128 a[28:31], v4 offset:7168
 ds_read_b128 a[48:51], v4 offset:12288
 ds_read_b128 a[12:15], v4 offset:3072
 ds_read_b128 a[32:35], v4 offset:8192
 ds_read_b128 a[52:55], v4 offset:13312
 s_waitcnt vmcnt(7) lgkmcnt(0)
 s_barrier
 v_mfma_f32_16x16x32_bf16 v[44:47], v[68:71], a[16:19], 0
 s_add_u32 m0, m0, 12288
 ds_read_b64_tr_b16 v[80:81], v2 offset:12288
 ds_read_b128 a[76:79], v4 offset:19456
 v_mfma_f32_16x16x32_bf16 v[44:47], v[72:75], a[36:39], v[44:47]
 s_add_u32 s32, s32, 884736
 ds_read_b64_tr_b16 v[82:83], v2 offset:12800
 ds_read_b128 a[96:99], v4 offset:24576
 v_mfma_f32_16x16x32_bf16 v[44:47], v[76:79], a[56:59], v[44:47]
 buffer_load_dwordx4 v9, s[16:19], s32 offen lds
 v_mfma_f32_16x16x32_bf16 v[28:31], v[68:71], a[0:3], 0
 ds_read_b64_tr_b16 v[84:85], v2 offset:13312
 ds_read_b128 a[116:119], v4 offset:29696
 ds_read_b128 a[60:63], v4 offset:15360
 v_mfma_f32_16x16x32_bf16 v[28:31], v[72:75], a[20:23], v[28:31]
 ds_read_b64_tr_b16 v[86:87], v2 offset:13824
 ds_read_b128 a[80:83], v4 offset:20480
 v_mfma_f32_16x16x32_bf16 v[28:31], v[76:79], a[40:43], v[28:31]
 ds_read_b64_tr_b16 v[88:89], v2 offset:14336
 ds_read_b128 a[100:103], v4 offset:25600
 v_mfma_f32_16x16x32_bf16 v[32:35], v[68:71], a[4:7], 0
 ds_read_b64_tr_b16 v[90:91], v2 offset:14848
 ds_read_b128 a[64:67], v4 offset:16384
 v_mfma_f32_16x16x32_bf16 v[32:35], v[72:75], a[24:27], v[32:35]
 buffer_load_dwordx4 v10, s[16:19], s32 offen offset:1024 lds
 v_mfma_f32_16x16x32_bf16 v[32:35], v[76:79], a[44:47], v[32:35]
 ds_read_b128 a[84:87], v4 offset:21504
 ds_read_b128 a[104:107], v4 offset:26624
 v_mfma_f32_16x16x32_bf16 v[36:39], v[68:71], a[8:11], 0
 ds_read_b128 a[68:71], v4 offset:17408
 ds_read_b128 a[88:91], v4 offset:22528
 v_mfma_f32_16x16x32_bf16 v[36:39], v[72:75], a[28:31], v[36:39]
 ds_read_b128 a[108:111], v4 offset:27648
 ds_read_b128 a[72:75], v4 offset:18432
 v_mfma_f32_16x16x32_bf16 v[36:39], v[76:79], a[48:51], v[36:39]
 ds_read_b128 a[92:95], v4 offset:23552
 ds_read_b128 a[112:115], v4 offset:28672
 v_mfma_f32_16x16x32_bf16 v[40:43], v[68:71], a[12:15], 0
 buffer_load_dwordx4 v11, s[16:19], s32 offen offset:2048 lds
 v_mfma_f32_16x16x32_bf16 v[40:43], v[72:75], a[32:35], v[40:43]
 v_mfma_f32_16x16x32_bf16 v[40:43], v[76:79], a[52:55], v[40:43]
 s_waitcnt lgkmcnt(0)
 v_mfma_f32_16x16x32_bf16 v[44:47], v[80:83], a[76:79], v[44:47]
 s_sub_u32 m0, m0, 61440
 ds_read_b64_tr_b16 v[68:69], v2 offset:24576
 ds_read_b128 a[136:139], v4 offset:34816
 v_mfma_f32_16x16x32_bf16 v[44:47], v[84:87], a[96:99], v[44:47]
 s_sub_u32 s32, s32, 4423552
 s_cmp_eq_u32 s32, s47
 s_cselect_b32 s32, s51, s32
 ds_read_b64_tr_b16 v[70:71], v2 offset:25088
 ds_read_b128 a[156:159], v4 offset:39936
 v_mfma_f32_16x16x32_bf16 v[44:47], v[88:91], a[116:119], v[44:47]
 buffer_load_dwordx4 v9, s[16:19], s32 offen lds
 v_mfma_f32_16x16x32_bf16 v[28:31], v[80:83], a[60:63], v[28:31]
 ds_read_b64_tr_b16 v[72:73], v2 offset:25600
 ds_read_b128 a[176:179], v4 offset:45056
 ds_read_b128 a[120:123], v4 offset:30720
 v_mfma_f32_16x16x32_bf16 v[28:31], v[84:87], a[80:83], v[28:31]
 ds_read_b64_tr_b16 v[74:75], v2 offset:26112
 ds_read_b128 a[140:143], v4 offset:35840
 v_mfma_f32_16x16x32_bf16 v[28:31], v[88:91], a[100:103], v[28:31]
 ds_read_b64_tr_b16 v[76:77], v2 offset:26624
 ds_read_b128 a[160:163], v4 offset:40960
 v_mfma_f32_16x16x32_bf16 v[32:35], v[80:83], a[64:67], v[32:35]
 ds_read_b64_tr_b16 v[78:79], v2 offset:27136
 ds_read_b128 a[124:127], v4 offset:31744
 v_mfma_f32_16x16x32_bf16 v[32:35], v[84:87], a[84:87], v[32:35]
 buffer_load_dwordx4 v10, s[16:19], s32 offen offset:1024 lds
 v_mfma_f32_16x16x32_bf16 v[32:35], v[88:91], a[104:107], v[32:35]
 ds_read_b128 a[144:147], v4 offset:36864
 ds_read_b128 a[164:167], v4 offset:41984
 v_mfma_f32_16x16x32_bf16 v[36:39], v[80:83], a[68:71], v[36:39]
 ds_read_b128 a[128:131], v4 offset:32768
 ds_read_b128 a[148:151], v4 offset:37888
 v_mfma_f32_16x16x32_bf16 v[36:39], v[84:87], a[88:91], v[36:39]
 ds_read_b128 a[168:171], v4 offset:43008
 ds_read_b128 a[132:135], v4 offset:33792
 v_mfma_f32_16x16x32_bf16 v[36:39], v[88:91], a[108:111], v[36:39]
 ds_read_b128 a[152:155], v4 offset:38912
 ds_read_b128 a[172:175], v4 offset:44032
 v_mfma_f32_16x16x32_bf16 v[40:43], v[80:83], a[72:75], v[40:43]
 buffer_load_dwordx4 v11, s[16:19], s32 offen offset:2048 lds
 v_mfma_f32_16x16x32_bf16 v[40:43], v[84:87], a[92:95], v[40:43]
 s_waitcnt vmcnt(7) lgkmcnt(0)
 v_mfma_f32_16x16x32_bf16 v[40:43], v[88:91], a[112:115], v[40:43]
 s_barrier
 v_mfma_f32_16x16x32_bf16 v[44:47], v[68:71], a[136:139], v[44:47]
 s_add_u32 m0, m0, 12288
 ds_read_b64_tr_b16 v[80:81], v3 offset:0
 ds_read_b128 a[196:199], v4 offset:50176
 v_mfma_f32_16x16x32_bf16 v[44:47], v[72:75], a[156:159], v[44:47]
 s_add_u32 s32, s32, 884736
 ds_read_b64_tr_b16 v[82:83], v3 offset:512
 ds_read_b128 a[216:219], v4 offset:55296
 v_mfma_f32_16x16x32_bf16 v[44:47], v[76:79], a[176:179], v[44:47]
 buffer_load_dwordx4 v9, s[16:19], s32 offen lds
 v_mfma_f32_16x16x32_bf16 v[28:31], v[68:71], a[120:123], v[28:31]
 ds_read_b64_tr_b16 v[84:85], v3 offset:1024
 ds_read_b128 a[236:239], v4 offset:60416
 ds_read_b128 a[180:183], v4 offset:46080
 v_mfma_f32_16x16x32_bf16 v[28:31], v[72:75], a[140:143], v[28:31]
 ds_read_b64_tr_b16 v[86:87], v3 offset:1536
 ds_read_b128 a[200:203], v4 offset:51200
 v_mfma_f32_16x16x32_bf16 v[28:31], v[76:79], a[160:163], v[28:31]
 ds_read_b64_tr_b16 v[88:89], v3 offset:2048
 ds_read_b128 a[220:223], v4 offset:56320
 v_mfma_f32_16x16x32_bf16 v[32:35], v[68:71], a[124:127], v[32:35]
 ds_read_b64_tr_b16 v[90:91], v3 offset:2560
 ds_read_b128 a[184:187], v4 offset:47104
 v_mfma_f32_16x16x32_bf16 v[32:35], v[72:75], a[144:147], v[32:35]
 buffer_load_dwordx4 v10, s[16:19], s32 offen offset:1024 lds
 v_mfma_f32_16x16x32_bf16 v[32:35], v[76:79], a[164:167], v[32:35]
 ds_read_b128 a[204:207], v4 offset:52224
 ds_read_b128 a[224:227], v4 offset:57344
 v_mfma_f32_16x16x32_bf16 v[36:39], v[68:71], a[128:131], v[36:39]
 ds_read_b128 a[188:191], v4 offset:48128
 ds_read_b128 a[208:211], v4 offset:53248
 v_mfma_f32_16x16x32_bf16 v[36:39], v[72:75], a[148:151], v[36:39]
 ds_read_b128 a[228:231], v4 offset:58368
 ds_read_b128 a[192:195], v4 offset:49152
 v_mfma_f32_16x16x32_bf16 v[36:39], v[76:79], a[168:171], v[36:39]
 ds_read_b128 a[212:215], v4 offset:54272
 ds_read_b128 a[232:235], v4 offset:59392
 v_mfma_f32_16x16x32_bf16 v[40:43], v[68:71], a[132:135], v[40:43]
 buffer_load_dwordx4 v11, s[16:19], s32 offen offset:2048 lds
 v_mfma_f32_16x16x32_bf16 v[40:43], v[72:75], a[152:155], v[40:43]
 v_mfma_f32_16x16x32_bf16 v[40:43], v[76:79], a[172:175], v[40:43]
 s_waitcnt lgkmcnt(0)
 v_mfma_f32_16x16x32_bf16 v[44:47], v[80:83], a[196:199], v[44:47]
 s_add_u32 m0, m0, 12288
 ds_read_b64_tr_b16 v[68:69], v3 offset:12288
 ds_read_b128 v[152:155], v5 offset:4096
 v_mfma_f32_16x16x32_bf16 v[44:47], v[84:87], a[216:219], v[44:47]
 s_add_u32 s32, s32, 884736
 ds_read_b64_tr_b16 v[70:71], v3 offset:12800
 ds_read_b128 v[172:175], v5 offset:9216
 v_mfma_f32_16x16x32_bf16 v[44:47], v[88:91], a[236:239], v[44:47]
 buffer_load_dwordx4 v9, s[16:19], s32 offen lds
 v_mfma_f32_16x16x32_bf16 v[28:31], v[80:83], a[180:183], v[28:31]
 ds_read_b64_tr_b16 v[72:73], v3 offset:13312
 ds_read_b128 v[192:195], v5 offset:14336
 ds_read_b128 a[240:243], v5 offset:0
 v_mfma_f32_16x16x32_bf16 v[28:31], v[84:87], a[200:203], v[28:31]
 ds_read_b64_tr_b16 v[74:75], v3 offset:13824
 ds_read_b128 v[156:159], v5 offset:5120
 v_mfma_f32_16x16x32_bf16 v[28:31], v[88:91], a[220:223], v[28:31]
 ds_read_b64_tr_b16 v[76:77], v3 offset:14336
 ds_read_b128 v[176:179], v5 offset:10240
 v_mfma_f32_16x16x32_bf16 v[32:35], v[80:83], a[184:187], v[32:35]
 ds_read_b64_tr_b16 v[78:79], v3 offset:14848
 ds_read_b128 a[244:247], v5 offset:1024
 v_mfma_f32_16x16x32_bf16 v[32:35], v[84:87], a[204:207], v[32:35]
 buffer_load_dwordx4 v10, s[16:19], s32 offen offset:1024 lds
 v_mfma_f32_16x16x32_bf16 v[32:35], v[88:91], a[224:227], v[32:35]
 ds_read_b128 v[160:163], v5 offset:6144
 ds_read_b128 v[180:183], v5 offset:11264
 v_mfma_f32_16x16x32_bf16 v[36:39], v[80:83], a[188:191], v[36:39]
 ds_read_b128 a[248:251], v5 offset:2048
 ds_read_b128 v[164:167], v5 offset:7168
 v_mfma_f32_16x16x32_bf16 v[36:39], v[84:87], a[208:211], v[36:39]
 ds_read_b128 v[184:187], v5 offset:12288
 ds_read_b128 a[252:255], v5 offset:3072
 v_mfma_f32_16x16x32_bf16 v[36:39], v[88:91], a[228:231], v[36:39]
 ds_read_b128 v[168:171], v5 offset:8192
 ds_read_b128 v[188:191], v5 offset:13312
 v_mfma_f32_16x16x32_bf16 v[40:43], v[80:83], a[192:195], v[40:43]
 buffer_load_dwordx4 v11, s[16:19], s32 offen offset:2048 lds
 v_mfma_f32_16x16x32_bf16 v[40:43], v[84:87], a[212:215], v[40:43]
 s_waitcnt vmcnt(6) lgkmcnt(0)
 v_mfma_f32_16x16x32_bf16 v[40:43], v[88:91], a[232:235], v[40:43]
 s_barrier
 v_mfma_f32_16x16x32_bf16 v[44:47], v[68:71], v[152:155], v[44:47]
 s_add_u32 m0, m0, 12288
 ds_read_b64_tr_b16 v[80:81], v3 offset:24576
 ds_read_b128 v[212:215], v5 offset:19456
 v_mfma_f32_16x16x32_bf16 v[44:47], v[72:75], v[172:175], v[44:47]
 s_add_u32 s32, s32, 884736
 ds_read_b64_tr_b16 v[82:83], v3 offset:25088
 ds_read_b128 v[232:235], v5 offset:24576
 v_mfma_f32_16x16x32_bf16 v[44:47], v[76:79], v[192:195], v[44:47]
 buffer_load_dwordx4 v9, s[16:19], s32 offen lds
 v_mfma_f32_16x16x32_bf16 v[28:31], v[68:71], a[240:243], v[28:31]
 ds_read_b64_tr_b16 v[84:85], v3 offset:25600
 ds_read_b128 v[252:255], v5 offset:29696
 ds_read_b128 v[196:199], v5 offset:15360
 v_mfma_f32_16x16x32_bf16 v[28:31], v[72:75], v[156:159], v[28:31]
 ds_read_b64_tr_b16 v[86:87], v3 offset:26112
 ds_read_b128 v[216:219], v5 offset:20480
 v_mfma_f32_16x16x32_bf16 v[28:31], v[76:79], v[176:179], v[28:31]
 ds_read_b64_tr_b16 v[88:89], v3 offset:26624
 ds_read_b128 v[236:239], v5 offset:25600
 v_mfma_f32_16x16x32_bf16 v[32:35], v[68:71], a[244:247], v[32:35]
 ds_read_b64_tr_b16 v[90:91], v3 offset:27136
 ds_read_b128 v[200:203], v5 offset:16384
 v_mfma_f32_16x16x32_bf16 v[32:35], v[72:75], v[160:163], v[32:35]
 buffer_load_dwordx4 v10, s[16:19], s32 offen offset:1024 lds
 v_mfma_f32_16x16x32_bf16 v[32:35], v[76:79], v[180:183], v[32:35]
 ds_read_b128 v[220:223], v5 offset:21504
 ds_read_b128 v[240:243], v5 offset:26624
 v_mfma_f32_16x16x32_bf16 v[36:39], v[68:71], a[248:251], v[36:39]
 ds_read_b128 v[204:207], v5 offset:17408
 ds_read_b128 v[224:227], v5 offset:22528
 v_mfma_f32_16x16x32_bf16 v[36:39], v[72:75], v[164:167], v[36:39]
 ds_read_b128 v[244:247], v5 offset:27648
 ds_read_b128 v[208:211], v5 offset:18432
 v_mfma_f32_16x16x32_bf16 v[36:39], v[76:79], v[184:187], v[36:39]
 ds_read_b128 v[228:231], v5 offset:23552
 ds_read_b128 v[248:251], v5 offset:28672
 v_mfma_f32_16x16x32_bf16 v[40:43], v[68:71], a[252:255], v[40:43]
 buffer_load_dwordx4 v11, s[16:19], s32 offen offset:2048 lds
 v_mfma_f32_16x16x32_bf16 v[40:43], v[72:75], v[168:171], v[40:43]
 v_mfma_f32_16x16x32_bf16 v[40:43], v[76:79], v[188:191], v[40:43]
 s_waitcnt lgkmcnt(0)
 v_mfma_f32_16x16x32_bf16 v[44:47], v[80:83], v[212:215], v[44:47]
 s_add_u32 m0, m0, 12288
 ds_read_b64_tr_b16 v[68:69], v2 offset:0
 v_mfma_f32_16x16x32_bf16 v[44:47], v[84:87], v[232:235], v[44:47]
 s_add_u32 s32, s32, 884736
 ds_read_b64_tr_b16 v[70:71], v2 offset:512
 v_mfma_f32_16x16x32_bf16 v[44:47], v[88:91], v[252:255], v[44:47]
 buffer_load_dwordx4 v9, s[16:19], s32 offen lds
 v_mfma_f32_16x16x32_bf16 v[28:31], v[80:83], v[196:199], v[28:31]
 ds_read_b64_tr_b16 v[72:73], v2 offset:1024
 v_mfma_f32_16x16x32_bf16 v[28:31], v[84:87], v[216:219], v[28:31]
 ds_read_b64_tr_b16 v[74:75], v2 offset:1536
 v_mfma_f32_16x16x32_bf16 v[28:31], v[88:91], v[236:239], v[28:31]
 ds_read_b64_tr_b16 v[76:77], v2 offset:2048
 v_mfma_f32_16x16x32_bf16 v[32:35], v[80:83], v[200:203], v[32:35]
 ds_read_b64_tr_b16 v[78:79], v2 offset:2560
 v_mfma_f32_16x16x32_bf16 v[32:35], v[84:87], v[220:223], v[32:35]
 buffer_load_dwordx4 v10, s[16:19], s32 offen offset:1024 lds
 v_mfma_f32_16x16x32_bf16 v[32:35], v[88:91], v[240:243], v[32:35]
L_p1:
 v_mfma_f32_16x16x32_bf16 v[36:39], v[80:83], v[204:207], v[36:39]
 v_exp_f32 v92, v44
 v_mfma_f32_16x16x32_bf16 v[36:39], v[84:87], v[224:227], v[36:39]
 v_exp_f32 v93, v45
 v_add_f32 v92, 1.0, v92
 v_mfma_f32_16x16x32_bf16 v[36:39], v[88:91], v[244:247], v[36:39]
 v_rcp_f32 v92, v92
 v_add_f32 v93, 1.0, v93
 v_mfma_f32_16x16x32_bf16 v[40:43], v[80:83], v[208:211], v[40:43]
 buffer_load_dwordx4 v11, s[16:19], s32 offen offset:2048 lds
 v_mfma_f32_16x16x32_bf16 v[40:43], v[84:87], v[228:231], v[40:43]
 s_waitcnt vmcnt(6) lgkmcnt(0)
 v_rcp_f32 v93, v93
 v_mfma_f32_16x16x32_bf16 v[40:43], v[88:91], v[248:251], v[40:43]
 s_barrier
 v_exp_f32 v94, v46
 v_mul_f32 v92, v44, v92
 v_mfma_f32_16x16x32_bf16 v[64:67], v[68:71], a[16:19], 0
 s_add_u32 m0, m0, 12288
 ds_read_b64_tr_b16 v[80:81], v2 offset:12288
 v_mul_f32 v93, v45, v93
 v_cvt_pk_bf16_f32 v100, v92, v93
 v_mfma_f32_16x16x32_bf16 v[64:67], v[72:75], a[36:39], v[64:67]
 s_add_u32 s32, s32, 884736
 ds_read_b64_tr_b16 v[82:83], v2 offset:12800
 v_add_f32 v94, 1.0, v94
 v_mfma_f32_16x16x32_bf16 v[64:67], v[76:79], a[56:59], v[64:67]
 buffer_load_dwordx4 v9, s[16:19], s32 offen lds
 v_mfma_f32_16x16x32_bf16 v[48:51], v[68:71], a[0:3], 0
 ds_read_b64_tr_b16 v[84:85], v2 offset:13312
 v_mfma_f32_16x16x32_bf16 v[48:51], v[72:75], a[20:23], v[48:51]
 ds_read_b64_tr_b16 v[86:87], v2 offset:13824
 v_rcp_f32 v94, v94
 v_mfma_f32_16x16x32_bf16 v[48:51], v[76:79], a[40:43], v[48:51]
 ds_read_b64_tr_b16 v[88:89], v2 offset:14336
 v_mul_f32 v94, v46, v94
 v_mfma_f32_16x16x32_bf16 v[52:55], v[68:71], a[4:7], 0
 ds_read_b64_tr_b16 v[90:91], v2 offset:14848
 v_exp_f32 v95, v47
 v_mfma_f32_16x16x32_bf16 v[52:55], v[72:75], a[24:27], v[52:55]
 buffer_load_dwordx4 v10, s[16:19], s32 offen offset:1024 lds
 v_mfma_f32_16x16x32_bf16 v[52:55], v[76:79], a[44:47], v[52:55]
 v_exp_f32 v96, v28
 v_add_f32 v95, 1.0, v95
 v_mfma_f32_16x16x32_bf16 v[56:59], v[68:71], a[8:11], 0
 v_rcp_f32 v95, v95
 v_add_f32 v96, 1.0, v96
 v_mfma_f32_16x16x32_bf16 v[56:59], v[72:75], a[28:31], v[56:59]
 v_rcp_f32 v96, v96
 v_mul_f32 v95, v47, v95
 v_mfma_f32_16x16x32_bf16 v[56:59], v[76:79], a[48:51], v[56:59]
 v_exp_f32 v97, v29
 v_mfma_f32_16x16x32_bf16 v[60:63], v[68:71], a[12:15], 0
 buffer_load_dwordx4 v11, s[16:19], s32 offen offset:2048 lds
 v_mfma_f32_16x16x32_bf16 v[60:63], v[72:75], a[32:35], v[60:63]
 v_exp_f32 v98, v30
 v_cvt_pk_bf16_f32 v101, v94, v95
 v_mfma_f32_16x16x32_bf16 v[60:63], v[76:79], a[52:55], v[60:63]
 s_waitcnt lgkmcnt(0)
 v_exp_f32 v99, v31
 v_mul_f32 v96, v28, v96
 v_mfma_f32_16x16x32_bf16 v[64:67], v[80:83], a[76:79], v[64:67]
 s_sub_u32 m0, m0, 61440
 ds_read_b64_tr_b16 v[68:69], v2 offset:24576
 v_add_f32 v97, 1.0, v97
 v_mfma_f32_16x16x32_bf16 v[64:67], v[84:87], a[96:99], v[64:67]
 s_sub_u32 s32, s32, 4423552
 s_cmp_eq_u32 s32, s47
 s_cselect_b32 s32, s51, s32
 ds_read_b64_tr_b16 v[70:71], v2 offset:25088
 v_add_f32 v98, 1.0, v98
 v_add_f32 v99, 1.0, v99
 v_mfma_f32_16x16x32_bf16 v[64:67], v[88:91], a[116:119], v[64:67]
 buffer_load_dwordx4 v9, s[16:19], s32 offen lds
 v_mfma_f32_16x16x32_bf16 v[48:51], v[80:83], a[60:63], v[48:51]
 ds_read_b64_tr_b16 v[72:73], v2 offset:25600
 ds_write_b64 v8, v[100:101] offset:4096
 v_mfma_f32_16x16x32_bf16 v[48:51], v[84:87], a[80:83], v[48:51]
 ds_read_b64_tr_b16 v[74:75], v2 offset:26112
 v_mfma_f32_16x16x32_bf16 v[48:51], v[88:91], a[100:103], v[48:51]
 ds_read_b64_tr_b16 v[76:77], v2 offset:26624
 v_rcp_f32 v97, v97
 v_mfma_f32_16x16x32_bf16 v[52:55], v[80:83], a[64:67], v[52:55]
 ds_read_b64_tr_b16 v[78:79], v2 offset:27136
 v_mul_f32 v97, v29, v97
 v_mfma_f32_16x16x32_bf16 v[52:55], v[84:87], a[84:87], v[52:55]
 buffer_load_dwordx4 v10, s[16:19], s32 offen offset:1024 lds
 v_mfma_f32_16x16x32_bf16 v[52:55], v[88:91], a[104:107], v[52:55]
 v_rcp_f32 v98, v98
 v_cvt_pk_bf16_f32 v102, v96, v97
 v_mfma_f32_16x16x32_bf16 v[56:59], v[80:83], a[68:71], v[56:59]
 v_rcp_f32 v99, v99
 v_mul_f32 v98, v30, v98
 v_mfma_f32_16x16x32_bf16 v[56:59], v[84:87], a[88:91], v[56:59]
 v_exp_f32 v92, v32
 v_mfma_f32_16x16x32_bf16 v[56:59], v[88:91], a[108:111], v[56:59]
 v_exp_f32 v93, v33
 v_mul_f32 v99, v31, v99
 v_mfma_f32_16x16x32_bf16 v[60:63], v[80:83], a[72:75], v[60:63]
 buffer_load_dwordx4 v11, s[16:19], s32 offen offset:2048 lds
 v_mfma_f32_16x16x32_bf16 v[60:63], v[84:87], a[92:95], v[60:63]
 s_waitcnt vmcnt(6) lgkmcnt(0)
 v_exp_f32 v94, v34
 v_cvt_pk_bf16_f32 v103, v98, v99
 v_mfma_f32_16x16x32_bf16 v[60:63], v[88:91], a[112:115], v[60:63]
 s_barrier
 v_exp_f32 v95, v35
 v_mfma_f32_16x16x32_bf16 v[64:67], v[68:71], a[136:139], v[64:67]
 s_add_u32 m0, m0, 12288
 ds_read_b64_tr_b16 v[80:81], v3 offset:0
 v_add_f32 v92, 1.0, v92
 v_add_f32 v93, 1.0, v93
 v_mfma_f32_16x16x32_bf16 v[64:67], v[72:75], a[156:159], v[64:67]
 s_add_u32 s32, s32, 884736
 ds_read_b64_tr_b16 v[82:83], v3 offset:512
 v_add_f32 v94, 1.0, v94
 v_mfma_f32_16x16x32_bf16 v[64:67], v[76:79], a[176:179], v[64:67]
 buffer_load_dwordx4 v9, s[16:19], s32 offen lds
 v_mfma_f32_16x16x32_bf16 v[48:51], v[68:71], a[120:123], v[48:51]
 ds_read_b64_tr_b16 v[84:85], v3 offset:1024
 ds_write_b64 v8, v[102:103] offset:0
 v_mfma_f32_16x16x32_bf16 v[48:51], v[72:75], a[140:143], v[48:51]
 ds_read_b64_tr_b16 v[86:87], v3 offset:1536
 v_add_f32 v95, 1.0, v95
 v_mfma_f32_16x16x32_bf16 v[48:51], v[76:79], a[160:163], v[48:51]
 ds_read_b64_tr_b16 v[88:89], v3 offset:2048
 v_mfma_f32_16x16x32_bf16 v[52:55], v[68:71], a[124:127], v[52:55]
 ds_read_b64_tr_b16 v[90:91], v3 offset:2560
 v_rcp_f32 v92, v92
 v_mfma_f32_16x16x32_bf16 v[52:55], v[72:75], a[144:147], v[52:55]
 buffer_load_dwordx4 v10, s[16:19], s32 offen offset:1024 lds
 v_mul_f32 v92, v32, v92
 v_mfma_f32_16x16x32_bf16 v[52:55], v[76:79], a[164:167], v[52:55]
 v_rcp_f32 v93, v93
 v_mfma_f32_16x16x32_bf16 v[56:59], v[68:71], a[128:131], v[56:59]
 v_rcp_f32 v94, v94
 v_mul_f32 v93, v33, v93
 v_mfma_f32_16x16x32_bf16 v[56:59], v[72:75], a[148:151], v[56:59]
 v_rcp_f32 v95, v95
 v_cvt_pk_bf16_f32 v104, v92, v93
 v_mfma_f32_16x16x32_bf16 v[56:59], v[76:79], a[168:171], v[56:59]
 v_exp_f32 v96, v36
 v_mul_f32 v94, v34, v94
 v_mfma_f32_16x16x32_bf16 v[60:63], v[68:71], a[132:135], v[60:63]
 buffer_load_dwordx4 v11, s[16:19], s32 offen offset:2048 lds
 v_mfma_f32_16x16x32_bf16 v[60:63], v[72:75], a[152:155], v[60:63]
 v_exp_f32 v97, v37
 v_mfma_f32_16x16x32_bf16 v[60:63], v[76:79], a[172:175], v[60:63]
 s_waitcnt lgkmcnt(0)
 v_exp_f32 v98, v38
 v_mul_f32 v95, v35, v95
 v_mfma_f32_16x16x32_bf16 v[64:67], v[80:83], a[196:199], v[64:67]
 s_add_u32 m0, m0, 12288
 ds_read_b64_tr_b16 v[68:69], v3 offset:12288
 v_cvt_pk_bf16_f32 v105, v94, v95
 v_mfma_f32_16x16x32_bf16 v[64:67], v[84:87], a[216:219], v[64:67]
 s_add_u32 s32, s32, 884736
 ds_read_b64_tr_b16 v[70:71], v3 offset:12800
 v_add_f32 v96, 1.0, v96
 v_add_f32 v97, 1.0, v97
 v_mfma_f32_16x16x32_bf16 v[64:67], v[88:91], a[236:239], v[64:67]
 buffer_load_dwordx4 v9, s[16:19], s32 offen lds
 v_mfma_f32_16x16x32_bf16 v[48:51], v[80:83], a[180:183], v[48:51]
 ds_read_b64_tr_b16 v[72:73], v3 offset:13312
 v_add_f32 v98, 1.0, v98
 v_mfma_f32_16x16x32_bf16 v[48:51], v[84:87], a[200:203], v[48:51]
 ds_read_b64_tr_b16 v[74:75], v3 offset:13824
 ds_write_b64 v8, v[104:105] offset:1024
 v_mfma_f32_16x16x32_bf16 v[48:51], v[88:91], a[220:223], v[48:51]
 ds_read_b64_tr_b16 v[76:77], v3 offset:14336
 v_mfma_f32_16x16x32_bf16 v[52:55], v[80:83], a[184:187], v[52:55]
 ds_read_b64_tr_b16 v[78:79], v3 offset:14848
 v_rcp_f32 v96, v96
 v_mfma_f32_16x16x32_bf16 v[52:55], v[84:87], a[204:207], v[52:55]
 buffer_load_dwordx4 v10, s[16:19], s32 offen offset:1024 lds
 v_mfma_f32_16x16x32_bf16 v[52:55], v[88:91], a[224:227], v[52:55]
 v_rcp_f32 v97, v97
 v_mul_f32 v96, v36, v96
 v_mfma_f32_16x16x32_bf16 v[56:59], v[80:83], a[188:191], v[56:59]
 v_rcp_f32 v98, v98
 v_mul_f32 v97, v37, v97
 v_mfma_f32_16x16x32_bf16 v[56:59], v[84:87], a[208:211], v[56:59]
 v_exp_f32 v99, v39
 v_cvt_pk_bf16_f32 v106, v96, v97
 v_mfma_f32_16x16x32_bf16 v[56:59], v[88:91], a[228:231], v[56:59]
 v_exp_f32 v92, v40
 v_mfma_f32_16x16x32_bf16 v[60:63], v[80:83], a[192:195], v[60:63]
 buffer_load_dwordx4 v11, s[16:19], s32 offen offset:2048 lds
 v_mfma_f32_16x16x32_bf16 v[60:63], v[84:87], a[212:215], v[60:63]
 s_waitcnt vmcnt(6) lgkmcnt(0)
 v_exp_f32 v93, v41
 v_mul_f32 v98, v38, v98
 v_mfma_f32_16x16x32_bf16 v[60:63], v[88:91], a[232:235], v[60:63]
 s_barrier
 v_exp_f32 v94, v42
 v_add_f32 v99, 1.0, v99
 v_mfma_f32_16x16x32_bf16 v[64:67], v[68:71], v[152:155], v[64:67]
 s_add_u32 m0, m0, 12288
 ds_read_b64_tr_b16 v[80:81], v3 offset:24576
 v_add_f32 v92, 1.0, v92
 v_mfma_f32_16x16x32_bf16 v[64:67], v[72:75], v[172:175], v[64:67]
 s_add_u32 s32, s32, 884736
 ds_read_b64_tr_b16 v[82:83], v3 offset:25088
 v_add_f32 v93, 1.0, v93
 v_mfma_f32_16x16x32_bf16 v[64:67], v[76:79], v[192:195], v[64:67]
 buffer_load_dwordx4 v9, s[16:19], s32 offen lds
 v_mfma_f32_16x16x32_bf16 v[48:51], v[68:71], a[240:243], v[48:51]
 ds_read_b64_tr_b16 v[84:85], v3 offset:25600
 v_add_f32 v94, 1.0, v94
 v_mfma_f32_16x16x32_bf16 v[48:51], v[72:75], v[156:159], v[48:51]
 ds_read_b64_tr_b16 v[86:87], v3 offset:26112
 v_rcp_f32 v99, v99
 v_mfma_f32_16x16x32_bf16 v[48:51], v[76:79], v[176:179], v[48:51]
 ds_read_b64_tr_b16 v[88:89], v3 offset:26624
 v_mul_f32 v99, v39, v99
 v_cvt_pk_bf16_f32 v107, v98, v99
 v_mfma_f32_16x16x32_bf16 v[52:55], v[68:71], a[244:247], v[52:55]
 ds_read_b64_tr_b16 v[90:91], v3 offset:27136
 v_mfma_f32_16x16x32_bf16 v[52:55], v[72:75], v[160:163], v[52:55]
 buffer_load_dwordx4 v10, s[16:19], s32 offen offset:1024 lds
 v_mfma_f32_16x16x32_bf16 v[52:55], v[76:79], v[180:183], v[52:55]
 ds_write_b64 v8, v[106:107] offset:2048
 v_rcp_f32 v92, v92
 v_mfma_f32_16x16x32_bf16 v[56:59], v[68:71], a[248:251], v[56:59]
 v_rcp_f32 v93, v93
 v_mfma_f32_16x16x32_bf16 v[56:59], v[72:75], v[164:167], v[56:59]
 v_rcp_f32 v94, v94
 v_mul_f32 v92, v40, v92
 v_mfma_f32_16x16x32_bf16 v[56:59], v[76:79], v[184:187], v[56:59]
 v_exp_f32 v95, v43
 v_mul_f32 v93, v41, v93
 v_mfma_f32_16x16x32_bf16 v[60:63], v[68:71], a[252:255], v[60:63]
 buffer_load_dwordx4 v11, s[16:19], s32 offen offset:2048 lds
 v_mfma_f32_16x16x32_bf16 v[60:63], v[72:75], v[168:171], v[60:63]
 v_cvt_pk_bf16_f32 v108, v92, v93
 v_mul_f32 v94, v42, v94
 v_add_f32 v95, 1.0, v95
 v_mfma_f32_16x16x32_bf16 v[60:63], v[76:79], v[188:191], v[60:63]
 s_waitcnt lgkmcnt(1)
 v_rcp_f32 v95, v95
 v_mfma_f32_16x16x32_bf16 v[64:67], v[80:83], v[212:215], v[64:67]
 s_add_u32 m0, m0, 12288
 ds_read_b64_tr_b16 v[68:69], v2 offset:0
 v_mul_f32 v95, v43, v95
 v_cvt_pk_bf16_f32 v109, v94, v95
 v_mfma_f32_16x16x32_bf16 v[64:67], v[84:87], v[232:235], v[64:67]
 s_add_u32 s32, s32, 884736
 ds_read_b64_tr_b16 v[70:71], v2 offset:512
 v_mfma_f32_16x16x32_bf16 v[64:67], v[88:91], v[252:255], v[64:67]
 buffer_load_dwordx4 v9, s[16:19], s32 offen lds
 v_mfma_f32_16x16x32_bf16 v[48:51], v[80:83], v[196:199], v[48:51]
 ds_read_b64_tr_b16 v[72:73], v2 offset:1024
 v_mfma_f32_16x16x32_bf16 v[48:51], v[84:87], v[216:219], v[48:51]
 ds_read_b64_tr_b16 v[74:75], v2 offset:1536
 ds_write_b64 v8, v[108:109] offset:3072
 v_add_u32 v8, 10240, v8
 v_mfma_f32_16x16x32_bf16 v[48:51], v[88:91], v[236:239], v[48:51]
 ds_read_b64_tr_b16 v[76:77], v2 offset:2048
 v_mfma_f32_16x16x32_bf16 v[52:55], v[80:83], v[200:203], v[52:55]
 ds_read_b64_tr_b16 v[78:79], v2 offset:2560
 v_mfma_f32_16x16x32_bf16 v[52:55], v[84:87], v[220:223], v[52:55]
 buffer_load_dwordx4 v10, s[16:19], s32 offen offset:1024 lds
 v_mfma_f32_16x16x32_bf16 v[52:55], v[88:91], v[240:243], v[52:55]
 v_mfma_f32_16x16x32_bf16 v[56:59], v[80:83], v[204:207], v[56:59]
 v_exp_f32 v92, v64
 v_mfma_f32_16x16x32_bf16 v[56:59], v[84:87], v[224:227], v[56:59]
 v_exp_f32 v93, v65
 v_add_f32 v92, 1.0, v92
 v_mfma_f32_16x16x32_bf16 v[56:59], v[88:91], v[244:247], v[56:59]
 v_rcp_f32 v92, v92
 v_add_f32 v93, 1.0, v93
 v_mfma_f32_16x16x32_bf16 v[60:63], v[80:83], v[208:211], v[60:63]
 buffer_load_dwordx4 v11, s[16:19], s32 offen offset:2048 lds
 v_mfma_f32_16x16x32_bf16 v[60:63], v[84:87], v[228:231], v[60:63]
 s_waitcnt vmcnt(6) lgkmcnt(0)
 v_rcp_f32 v93, v93
 v_mfma_f32_16x16x32_bf16 v[60:63], v[88:91], v[248:251], v[60:63]
 s_barrier
 v_exp_f32 v94, v66
 v_mul_f32 v92, v64, v92
 v_mfma_f32_16x16x32_bf16 v[44:47], v[68:71], a[16:19], 0
 s_add_u32 m0, m0, 12288
 ds_read_b64_tr_b16 v[80:81], v2 offset:12288
 v_mul_f32 v93, v65, v93
 v_cvt_pk_bf16_f32 v100, v92, v93
 v_mfma_f32_16x16x32_bf16 v[44:47], v[72:75], a[36:39], v[44:47]
 s_add_u32 s32, s32, 884736
 ds_read_b64_tr_b16 v[82:83], v2 offset:12800
 v_add_f32 v94, 1.0, v94
 v_mfma_f32_16x16x32_bf16 v[44:47], v[76:79], a[56:59], v[44:47]
 buffer_load_dwordx4 v9, s[16:19], s32 offen lds
 v_mfma_f32_16x16x32_bf16 v[28:31], v[68:71], a[0:3], 0
 ds_read_b64_tr_b16 v[84:85], v2 offset:13312
 v_mfma_f32_16x16x32_bf16 v[28:31], v[72:75], a[20:23], v[28:31]
 ds_read_b64_tr_b16 v[86:87], v2 offset:13824
 v_rcp_f32 v94, v94
 v_mfma_f32_16x16x32_bf16 v[28:31], v[76:79], a[40:43], v[28:31]
 ds_read_b64_tr_b16 v[88:89], v2 offset:14336
 v_mul_f32 v94, v66, v94
 v_mfma_f32_16x16x32_bf16 v[32:35], v[68:71], a[4:7], 0
 ds_read_b64_tr_b16 v[90:91], v2 offset:14848
 v_exp_f32 v95, v67
 v_mfma_f32_16x16x32_bf16 v[32:35], v[72:75], a[24:27], v[32:35]
 buffer_load_dwordx4 v10, s[16:19], s32 offen offset:1024 lds
 v_mfma_f32_16x16x32_bf16 v[32:35], v[76:79], a[44:47], v[32:35]
 v_exp_f32 v96, v48
 v_add_f32 v95, 1.0, v95
 v_mfma_f32_16x16x32_bf16 v[36:39], v[68:71], a[8:11], 0
 v_rcp_f32 v95, v95
 v_add_f32 v96, 1.0, v96
 v_mfma_f32_16x16x32_bf16 v[36:39], v[72:75], a[28:31], v[36:39]
 v_rcp_f32 v96, v96
 v_mul_f32 v95, v67, v95
 v_mfma_f32_16x16x32_bf16 v[36:39], v[76:79], a[48:51], v[36:39]
 v_exp_f32 v97, v49
 v_mfma_f32_16x16x32_bf16 v[40:43], v[68:71], a[12:15], 0
 buffer_load_dwordx4 v11, s[16:19], s32 offen offset:2048 lds
 v_mfma_f32_16x16x32_bf16 v[40:43], v[72:75], a[32:35], v[40:43]
 v_exp_f32 v98, v50
 v_cvt_pk_bf16_f32 v101, v94, v95
 v_mfma_f32_16x16x32_bf16 v[40:43], v[76:79], a[52:55], v[40:43]
 s_waitcnt lgkmcnt(0)
 v_exp_f32 v99, v51
 v_mul_f32 v96, v48, v96
 v_mfma_f32_16x16x32_bf16 v[44:47], v[80:83], a[76:79], v[44:47]
 s_sub_u32 m0, m0, 61440
 ds_read_b64_tr_b16 v[68:69], v2 offset:24576
 v_add_f32 v97, 1.0, v97
 v_mfma_f32_16x16x32_bf16 v[44:47], v[84:87], a[96:99], v[44:47]
 s_sub_u32 s32, s32, 4423552
 s_cmp_eq_u32 s32, s47
 s_cselect_b32 s32, s51, s32
 ds_read_b64_tr_b16 v[70:71], v2 offset:25088
 v_add_f32 v98, 1.0, v98
 v_add_f32 v99, 1.0, v99
 v_mfma_f32_16x16x32_bf16 v[44:47], v[88:91], a[116:119], v[44:47]
 buffer_load_dwordx4 v9, s[16:19], s32 offen lds
 v_mfma_f32_16x16x32_bf16 v[28:31], v[80:83], a[60:63], v[28:31]
 ds_read_b64_tr_b16 v[72:73], v2 offset:25600
 ds_write_b64 v8, v[100:101] offset:4096
 v_mfma_f32_16x16x32_bf16 v[28:31], v[84:87], a[80:83], v[28:31]
 ds_read_b64_tr_b16 v[74:75], v2 offset:26112
 v_mfma_f32_16x16x32_bf16 v[28:31], v[88:91], a[100:103], v[28:31]
 ds_read_b64_tr_b16 v[76:77], v2 offset:26624
 v_rcp_f32 v97, v97
 v_mfma_f32_16x16x32_bf16 v[32:35], v[80:83], a[64:67], v[32:35]
 ds_read_b64_tr_b16 v[78:79], v2 offset:27136
 v_mul_f32 v97, v49, v97
 v_mfma_f32_16x16x32_bf16 v[32:35], v[84:87], a[84:87], v[32:35]
 buffer_load_dwordx4 v10, s[16:19], s32 offen offset:1024 lds
 v_mfma_f32_16x16x32_bf16 v[32:35], v[88:91], a[104:107], v[32:35]
 v_rcp_f32 v98, v98
 v_cvt_pk_bf16_f32 v102, v96, v97
 v_mfma_f32_16x16x32_bf16 v[36:39], v[80:83], a[68:71], v[36:39]
 v_rcp_f32 v99, v99
 v_mul_f32 v98, v50, v98
 v_mfma_f32_16x16x32_bf16 v[36:39], v[84:87], a[88:91], v[36:39]
 v_exp_f32 v92, v52
 v_mfma_f32_16x16x32_bf16 v[36:39], v[88:91], a[108:111], v[36:39]
 v_exp_f32 v93, v53
 v_mul_f32 v99, v51, v99
 v_mfma_f32_16x16x32_bf16 v[40:43], v[80:83], a[72:75], v[40:43]
 buffer_load_dwordx4 v11, s[16:19], s32 offen offset:2048 lds
 v_mfma_f32_16x16x32_bf16 v[40:43], v[84:87], a[92:95], v[40:43]
 s_waitcnt vmcnt(6) lgkmcnt(0)
 v_exp_f32 v94, v54
 v_cvt_pk_bf16_f32 v103, v98, v99
 v_mfma_f32_16x16x32_bf16 v[40:43], v[88:91], a[112:115], v[40:43]
 s_barrier
 v_exp_f32 v95, v55
 v_mfma_f32_16x16x32_bf16 v[44:47], v[68:71], a[136:139], v[44:47]
 s_add_u32 m0, m0, 12288
 ds_read_b64_tr_b16 v[80:81], v3 offset:0
 v_add_f32 v92, 1.0, v92
 v_add_f32 v93, 1.0, v93
 v_mfma_f32_16x16x32_bf16 v[44:47], v[72:75], a[156:159], v[44:47]
 s_add_u32 s32, s32, 884736
 ds_read_b64_tr_b16 v[82:83], v3 offset:512
 v_add_f32 v94, 1.0, v94
 v_mfma_f32_16x16x32_bf16 v[44:47], v[76:79], a[176:179], v[44:47]
 buffer_load_dwordx4 v9, s[16:19], s32 offen lds
 v_mfma_f32_16x16x32_bf16 v[28:31], v[68:71], a[120:123], v[28:31]
 ds_read_b64_tr_b16 v[84:85], v3 offset:1024
 ds_write_b64 v8, v[102:103] offset:0
 v_mfma_f32_16x16x32_bf16 v[28:31], v[72:75], a[140:143], v[28:31]
 ds_read_b64_tr_b16 v[86:87], v3 offset:1536
 v_add_f32 v95, 1.0, v95
 v_mfma_f32_16x16x32_bf16 v[28:31], v[76:79], a[160:163], v[28:31]
 ds_read_b64_tr_b16 v[88:89], v3 offset:2048
 v_mfma_f32_16x16x32_bf16 v[32:35], v[68:71], a[124:127], v[32:35]
 ds_read_b64_tr_b16 v[90:91], v3 offset:2560
 v_rcp_f32 v92, v92
 v_mfma_f32_16x16x32_bf16 v[32:35], v[72:75], a[144:147], v[32:35]
 buffer_load_dwordx4 v10, s[16:19], s32 offen offset:1024 lds
 v_mul_f32 v92, v52, v92
 v_mfma_f32_16x16x32_bf16 v[32:35], v[76:79], a[164:167], v[32:35]
 v_rcp_f32 v93, v93
 v_mfma_f32_16x16x32_bf16 v[36:39], v[68:71], a[128:131], v[36:39]
 v_rcp_f32 v94, v94
 v_mul_f32 v93, v53, v93
 v_mfma_f32_16x16x32_bf16 v[36:39], v[72:75], a[148:151], v[36:39]
 v_rcp_f32 v95, v95
 v_cvt_pk_bf16_f32 v104, v92, v93
 v_mfma_f32_16x16x32_bf16 v[36:39], v[76:79], a[168:171], v[36:39]
 v_exp_f32 v96, v56
 v_mul_f32 v94, v54, v94
 v_mfma_f32_16x16x32_bf16 v[40:43], v[68:71], a[132:135], v[40:43]
 buffer_load_dwordx4 v11, s[16:19], s32 offen offset:2048 lds
 v_mfma_f32_16x16x32_bf16 v[40:43], v[72:75], a[152:155], v[40:43]
 v_exp_f32 v97, v57
 v_mfma_f32_16x16x32_bf16 v[40:43], v[76:79], a[172:175], v[40:43]
 s_waitcnt lgkmcnt(0)
 v_exp_f32 v98, v58
 v_mul_f32 v95, v55, v95
 v_mfma_f32_16x16x32_bf16 v[44:47], v[80:83], a[196:199], v[44:47]
 s_add_u32 m0, m0, 12288
 ds_read_b64_tr_b16 v[68:69], v3 offset:12288
 v_cvt_pk_bf16_f32 v105, v94, v95
 v_mfma_f32_16x16x32_bf16 v[44:47], v[84:87], a[216:219], v[44:47]
 s_add_u32 s32, s32, 884736
 ds_read_b64_tr_b16 v[70:71], v3 offset:12800
 v_add_f32 v96, 1.0, v96
 v_add_f32 v97, 1.0, v97
 v_mfma_f32_16x16x32_bf16 v[44:47], v[88:91], a[236:239], v[44:47]
 buffer_load_dwordx4 v9, s[16:19], s32 offen lds
 v_mfma_f32_16x16x32_bf16 v[28:31], v[80:83], a[180:183], v[28:31]
 ds_read_b64_tr_b16 v[72:73], v3 offset:13312
 v_add_f32 v98, 1.0, v98
 v_mfma_f32_16x16x32_bf16 v[28:31], v[84:87], a[200:203], v[28:31]
 ds_read_b64_tr_b16 v[74:75], v3 offset:13824
 ds_write_b64 v8, v[104:105] offset:1024
 v_mfma_f32_16x16x32_bf16 v[28:31], v[88:91], a[220:223], v[28:31]
 ds_read_b64_tr_b16 v[76:77], v3 offset:14336
 v_mfma_f32_16x16x32_bf16 v[32:35], v[80:83], a[184:187], v[32:35]
 ds_read_b64_tr_b16 v[78:79], v3 offset:14848
 v_rcp_f32 v96, v96
 v_mfma_f32_16x16x32_bf16 v[32:35], v[84:87], a[204:207], v[32:35]
 buffer_load_dwordx4 v10, s[16:19], s32 offen offset:1024 lds
 v_mfma_f32_16x16x32_bf16 v[32:35], v[88:91], a[224:227], v[32:35]
 v_rcp_f32 v97, v97
 v_mul_f32 v96, v56, v96
 v_mfma_f32_16x16x32_bf16 v[36:39], v[80:83], a[188:191], v[36:39]
 v_rcp_f32 v98, v98
 v_mul_f32 v97, v57, v97
 v_mfma_f32_16x16x32_bf16 v[36:39], v[84:87], a[208:211], v[36:39]
 v_exp_f32 v99, v59
 v_cvt_pk_bf16_f32 v106, v96, v97
 v_mfma_f32_16x16x32_bf16 v[36:39], v[88:91], a[228:231], v[36:39]
 v_exp_f32 v92, v60
 v_mfma_f32_16x16x32_bf16 v[40:43], v[80:83], a[192:195], v[40:43]
 buffer_load_dwordx4 v11, s[16:19], s32 offen offset:2048 lds
 v_mfma_f32_16x16x32_bf16 v[40:43], v[84:87], a[212:215], v[40:43]
 s_waitcnt vmcnt(6) lgkmcnt(0)
 v_exp_f32 v93, v61
 v_mul_f32 v98, v58, v98
 v_mfma_f32_16x16x32_bf16 v[40:43], v[88:91], a[232:235], v[40:43]
 s_barrier
 v_exp_f32 v94, v62
 v_add_f32 v99, 1.0, v99
 v_mfma_f32_16x16x32_bf16 v[44:47], v[68:71], v[152:155], v[44:47]
 s_add_u32 m0, m0, 12288
 ds_read_b64_tr_b16 v[80:81], v3 offset:24576
 v_add_f32 v92, 1.0, v92
 v_mfma_f32_16x16x32_bf16 v[44:47], v[72:75], v[172:175], v[44:47]
 s_add_u32 s32, s32, 884736
 ds_read_b64_tr_b16 v[82:83], v3 offset:25088
 v_add_f32 v93, 1.0, v93
 v_mfma_f32_16x16x32_bf16 v[44:47], v[76:79], v[192:195], v[44:47]
 buffer_load_dwordx4 v9, s[16:19], s32 offen lds
 v_mfma_f32_16x16x32_bf16 v[28:31], v[68:71], a[240:243], v[28:31]
 ds_read_b64_tr_b16 v[84:85], v3 offset:25600
 v_add_f32 v94, 1.0, v94
 v_mfma_f32_16x16x32_bf16 v[28:31], v[72:75], v[156:159], v[28:31]
 ds_read_b64_tr_b16 v[86:87], v3 offset:26112
 v_rcp_f32 v99, v99
 v_mfma_f32_16x16x32_bf16 v[28:31], v[76:79], v[176:179], v[28:31]
 ds_read_b64_tr_b16 v[88:89], v3 offset:26624
 v_mul_f32 v99, v59, v99
 v_cvt_pk_bf16_f32 v107, v98, v99
 v_mfma_f32_16x16x32_bf16 v[32:35], v[68:71], a[244:247], v[32:35]
 ds_read_b64_tr_b16 v[90:91], v3 offset:27136
 v_mfma_f32_16x16x32_bf16 v[32:35], v[72:75], v[160:163], v[32:35]
 buffer_load_dwordx4 v10, s[16:19], s32 offen offset:1024 lds
 v_mfma_f32_16x16x32_bf16 v[32:35], v[76:79], v[180:183], v[32:35]
 ds_write_b64 v8, v[106:107] offset:2048
 v_rcp_f32 v92, v92
 v_mfma_f32_16x16x32_bf16 v[36:39], v[68:71], a[248:251], v[36:39]
 v_rcp_f32 v93, v93
 v_mfma_f32_16x16x32_bf16 v[36:39], v[72:75], v[164:167], v[36:39]
 v_rcp_f32 v94, v94
 v_mul_f32 v92, v60, v92
 v_mfma_f32_16x16x32_bf16 v[36:39], v[76:79], v[184:187], v[36:39]
 v_exp_f32 v95, v63
 v_mul_f32 v93, v61, v93
 v_mfma_f32_16x16x32_bf16 v[40:43], v[68:71], a[252:255], v[40:43]
 buffer_load_dwordx4 v11, s[16:19], s32 offen offset:2048 lds
 v_mfma_f32_16x16x32_bf16 v[40:43], v[72:75], v[168:171], v[40:43]
 v_cvt_pk_bf16_f32 v108, v92, v93
 v_mul_f32 v94, v62, v94
 v_add_f32 v95, 1.0, v95
 v_mfma_f32_16x16x32_bf16 v[40:43], v[76:79], v[188:191], v[40:43]
 s_waitcnt lgkmcnt(1)
 v_rcp_f32 v95, v95
 v_mfma_f32_16x16x32_bf16 v[44:47], v[80:83], v[212:215], v[44:47]
 s_add_u32 m0, m0, 12288
 ds_read_b64_tr_b16 v[68:69], v2 offset:0
 v_mul_f32 v95, v63, v95
 v_cvt_pk_bf16_f32 v109, v94, v95
 v_mfma_f32_16x16x32_bf16 v[44:47], v[84:87], v[232:235], v[44:47]
 s_add_u32 s32, s32, 884736
 ds_read_b64_tr_b16 v[70:71], v2 offset:512
 v_mfma_f32_16x16x32_bf16 v[44:47], v[88:91], v[252:255], v[44:47]
 buffer_load_dwordx4 v9, s[16:19], s32 offen lds
 v_mfma_f32_16x16x32_bf16 v[28:31], v[80:83], v[196:199], v[28:31]
 ds_read_b64_tr_b16 v[72:73], v2 offset:1024
 v_mfma_f32_16x16x32_bf16 v[28:31], v[84:87], v[216:219], v[28:31]
 ds_read_b64_tr_b16 v[74:75], v2 offset:1536
 ds_write_b64 v8, v[108:109] offset:3072
 v_add_u32 v8, 10240, v8
 v_mfma_f32_16x16x32_bf16 v[28:31], v[88:91], v[236:239], v[28:31]
 ds_read_b64_tr_b16 v[76:77], v2 offset:2048
 v_mfma_f32_16x16x32_bf16 v[32:35], v[80:83], v[200:203], v[32:35]
 ds_read_b64_tr_b16 v[78:79], v2 offset:2560
 v_mfma_f32_16x16x32_bf16 v[32:35], v[84:87], v[220:223], v[32:35]
 buffer_load_dwordx4 v10, s[16:19], s32 offen offset:1024 lds
 v_mfma_f32_16x16x32_bf16 v[32:35], v[88:91], v[240:243], v[32:35]
 s_add_u32 s33, s33, 1
 s_cbranch_scc0 L_p1
 v_mfma_f32_16x16x32_bf16 v[36:39], v[80:83], v[204:207], v[36:39]
 v_exp_f32 v92, v44
 v_mfma_f32_16x16x32_bf16 v[36:39], v[84:87], v[224:227], v[36:39]
 v_exp_f32 v93, v45
 v_add_f32 v92, 1.0, v92
 v_mfma_f32_16x16x32_bf16 v[36:39], v[88:91], v[244:247], v[36:39]
 v_rcp_f32 v92, v92
 v_add_f32 v93, 1.0, v93
 v_mfma_f32_16x16x32_bf16 v[40:43], v[80:83], v[208:211], v[40:43]
 buffer_load_dwordx4 v11, s[16:19], s32 offen offset:2048 lds
 v_mfma_f32_16x16x32_bf16 v[40:43], v[84:87], v[228:231], v[40:43]
 s_waitcnt vmcnt(6) lgkmcnt(0)
 v_rcp_f32 v93, v93
 v_mfma_f32_16x16x32_bf16 v[40:43], v[88:91], v[248:251], v[40:43]
 s_barrier
 v_exp_f32 v94, v46
 v_mul_f32 v92, v44, v92
 v_mfma_f32_16x16x32_bf16 v[64:67], v[68:71], a[16:19], 0
 s_add_u32 m0, m0, 12288
 ds_read_b64_tr_b16 v[80:81], v2 offset:12288
 v_mul_f32 v93, v45, v93
 v_cvt_pk_bf16_f32 v100, v92, v93
 v_mfma_f32_16x16x32_bf16 v[64:67], v[72:75], a[36:39], v[64:67]
 s_add_u32 s32, s32, 884736
 ds_read_b64_tr_b16 v[82:83], v2 offset:12800
 v_add_f32 v94, 1.0, v94
 v_mfma_f32_16x16x32_bf16 v[64:67], v[76:79], a[56:59], v[64:67]
 buffer_load_dwordx4 v9, s[16:19], s32 offen lds
 v_mfma_f32_16x16x32_bf16 v[48:51], v[68:71], a[0:3], 0
 ds_read_b64_tr_b16 v[84:85], v2 offset:13312
 v_mfma_f32_16x16x32_bf16 v[48:51], v[72:75], a[20:23], v[48:51]
 ds_read_b64_tr_b16 v[86:87], v2 offset:13824
 v_rcp_f32 v94, v94
 v_mfma_f32_16x16x32_bf16 v[48:51], v[76:79], a[40:43], v[48:51]
 ds_read_b64_tr_b16 v[88:89], v2 offset:14336
 v_mul_f32 v94, v46, v94
 v_mfma_f32_16x16x32_bf16 v[52:55], v[68:71], a[4:7], 0
 ds_read_b64_tr_b16 v[90:91], v2 offset:14848
 v_exp_f32 v95, v47
 v_mfma_f32_16x16x32_bf16 v[52:55], v[72:75], a[24:27], v[52:55]
 buffer_load_dwordx4 v10, s[16:19], s32 offen offset:1024 lds
 v_mfma_f32_16x16x32_bf16 v[52:55], v[76:79], a[44:47], v[52:55]
 v_exp_f32 v96, v28
 v_add_f32 v95, 1.0, v95
 v_mfma_f32_16x16x32_bf16 v[56:59], v[68:71], a[8:11], 0
 v_rcp_f32 v95, v95
 v_add_f32 v96, 1.0, v96
 v_mfma_f32_16x16x32_bf16 v[56:59], v[72:75], a[28:31], v[56:59]
 v_rcp_f32 v96, v96
 v_mul_f32 v95, v47, v95
 v_mfma_f32_16x16x32_bf16 v[56:59], v[76:79], a[48:51], v[56:59]
 v_exp_f32 v97, v29
 v_mfma_f32_16x16x32_bf16 v[60:63], v[68:71], a[12:15], 0
 buffer_load_dwordx4 v11, s[16:19], s32 offen offset:2048 lds
 v_mfma_f32_16x16x32_bf16 v[60:63], v[72:75], a[32:35], v[60:63]
 v_exp_f32 v98, v30
 v_cvt_pk_bf16_f32 v101, v94, v95
 v_mfma_f32_16x16x32_bf16 v[60:63], v[76:79], a[52:55], v[60:63]
 s_waitcnt lgkmcnt(0)
 v_exp_f32 v99, v31
 v_mul_f32 v96, v28, v96
 v_mfma_f32_16x16x32_bf16 v[64:67], v[80:83], a[76:79], v[64:67]
 s_sub_u32 m0, m0, 61440
 ds_read_b64_tr_b16 v[68:69], v2 offset:24576
 v_add_f32 v97, 1.0, v97
 v_mfma_f32_16x16x32_bf16 v[64:67], v[84:87], a[96:99], v[64:67]
 s_sub_u32 s32, s32, 4423552
 s_cmp_eq_u32 s32, s47
 s_cselect_b32 s32, s51, s32
 ds_read_b64_tr_b16 v[70:71], v2 offset:25088
 v_add_f32 v98, 1.0, v98
 v_add_f32 v99, 1.0, v99
 v_mfma_f32_16x16x32_bf16 v[64:67], v[88:91], a[116:119], v[64:67]
 buffer_load_dwordx4 v9, s[16:19], s32 offen lds
 v_mfma_f32_16x16x32_bf16 v[48:51], v[80:83], a[60:63], v[48:51]
 ds_read_b64_tr_b16 v[72:73], v2 offset:25600
 ds_write_b64 v8, v[100:101] offset:4096
 v_mfma_f32_16x16x32_bf16 v[48:51], v[84:87], a[80:83], v[48:51]
 ds_read_b64_tr_b16 v[74:75], v2 offset:26112
 v_mfma_f32_16x16x32_bf16 v[48:51], v[88:91], a[100:103], v[48:51]
 ds_read_b64_tr_b16 v[76:77], v2 offset:26624
 v_rcp_f32 v97, v97
 v_mfma_f32_16x16x32_bf16 v[52:55], v[80:83], a[64:67], v[52:55]
 ds_read_b64_tr_b16 v[78:79], v2 offset:27136
 v_mul_f32 v97, v29, v97
 v_mfma_f32_16x16x32_bf16 v[52:55], v[84:87], a[84:87], v[52:55]
 buffer_load_dwordx4 v10, s[16:19], s32 offen offset:1024 lds
 v_mfma_f32_16x16x32_bf16 v[52:55], v[88:91], a[104:107], v[52:55]
 v_rcp_f32 v98, v98
 v_cvt_pk_bf16_f32 v102, v96, v97
 v_mfma_f32_16x16x32_bf16 v[56:59], v[80:83], a[68:71], v[56:59]
 v_rcp_f32 v99, v99
 v_mul_f32 v98, v30, v98
 v_mfma_f32_16x16x32_bf16 v[56:59], v[84:87], a[88:91], v[56:59]
 v_exp_f32 v92, v32
 v_mfma_f32_16x16x32_bf16 v[56:59], v[88:91], a[108:111], v[56:59]
 v_exp_f32 v93, v33
 v_mul_f32 v99, v31, v99
 v_mfma_f32_16x16x32_bf16 v[60:63], v[80:83], a[72:75], v[60:63]
 buffer_load_dwordx4 v11, s[16:19], s32 offen offset:2048 lds
 v_mfma_f32_16x16x32_bf16 v[60:63], v[84:87], a[92:95], v[60:63]
 s_waitcnt vmcnt(6) lgkmcnt(0)
 v_exp_f32 v94, v34
 v_cvt_pk_bf16_f32 v103, v98, v99
 v_mfma_f32_16x16x32_bf16 v[60:63], v[88:91], a[112:115], v[60:63]
 s_barrier
 v_exp_f32 v95, v35
 v_mfma_f32_16x16x32_bf16 v[64:67], v[68:71], a[136:139], v[64:67]
 s_add_u32 m0, m0, 12288
 ds_read_b64_tr_b16 v[80:81], v3 offset:0
 v_add_f32 v92, 1.0, v92
 v_add_f32 v93, 1.0, v93
 v_mfma_f32_16x16x32_bf16 v[64:67], v[72:75], a[156:159], v[64:67]
 s_add_u32 s32, s32, 884736
 ds_read_b64_tr_b16 v[82:83], v3 offset:512
 v_add_f32 v94, 1.0, v94
 v_mfma_f32_16x16x32_bf16 v[64:67], v[76:79], a[176:179], v[64:67]
 buffer_load_dwordx4 v9, s[16:19], s32 offen lds
 v_mfma_f32_16x16x32_bf16 v[48:51], v[68:71], a[120:123], v[48:51]
 ds_read_b64_tr_b16 v[84:85], v3 offset:1024
 ds_write_b64 v8, v[102:103] offset:0
 v_mfma_f32_16x16x32_bf16 v[48:51], v[72:75], a[140:143], v[48:51]
 ds_read_b64_tr_b16 v[86:87], v3 offset:1536
 v_add_f32 v95, 1.0, v95
 v_mfma_f32_16x16x32_bf16 v[48:51], v[76:79], a[160:163], v[48:51]
 ds_read_b64_tr_b16 v[88:89], v3 offset:2048
 v_mfma_f32_16x16x32_bf16 v[52:55], v[68:71], a[124:127], v[52:55]
 ds_read_b64_tr_b16 v[90:91], v3 offset:2560
 v_rcp_f32 v92, v92
 v_mfma_f32_16x16x32_bf16 v[52:55], v[72:75], a[144:147], v[52:55]
 buffer_load_dwordx4 v10, s[16:19], s32 offen offset:1024 lds
 v_mul_f32 v92, v32, v92
 v_mfma_f32_16x16x32_bf16 v[52:55], v[76:79], a[164:167], v[52:55]
 v_rcp_f32 v93, v93
 v_mfma_f32_16x16x32_bf16 v[56:59], v[68:71], a[128:131], v[56:59]
 v_rcp_f32 v94, v94
 v_mul_f32 v93, v33, v93
 v_mfma_f32_16x16x32_bf16 v[56:59], v[72:75], a[148:151], v[56:59]
 v_rcp_f32 v95, v95
 v_cvt_pk_bf16_f32 v104, v92, v93
 v_mfma_f32_16x16x32_bf16 v[56:59], v[76:79], a[168:171], v[56:59]
 v_exp_f32 v96, v36
 v_mul_f32 v94, v34, v94
 v_mfma_f32_16x16x32_bf16 v[60:63], v[68:71], a[132:135], v[60:63]
 buffer_load_dwordx4 v11, s[16:19], s32 offen offset:2048 lds
 v_mfma_f32_16x16x32_bf16 v[60:63], v[72:75], a[152:155], v[60:63]
 v_exp_f32 v97, v37
 v_mfma_f32_16x16x32_bf16 v[60:63], v[76:79], a[172:175], v[60:63]
 s_waitcnt lgkmcnt(0)
 v_exp_f32 v98, v38
 v_mul_f32 v95, v35, v95
 v_mfma_f32_16x16x32_bf16 v[64:67], v[80:83], a[196:199], v[64:67]
 s_add_u32 m0, m0, 12288
 ds_read_b64_tr_b16 v[68:69], v3 offset:12288
 v_cvt_pk_bf16_f32 v105, v94, v95
 v_mfma_f32_16x16x32_bf16 v[64:67], v[84:87], a[216:219], v[64:67]
 s_add_u32 s32, s32, 884736
 ds_read_b64_tr_b16 v[70:71], v3 offset:12800
 v_add_f32 v96, 1.0, v96
 v_add_f32 v97, 1.0, v97
 v_mfma_f32_16x16x32_bf16 v[64:67], v[88:91], a[236:239], v[64:67]
 buffer_load_dwordx4 v9, s[16:19], s32 offen lds
 v_mfma_f32_16x16x32_bf16 v[48:51], v[80:83], a[180:183], v[48:51]
 ds_read_b64_tr_b16 v[72:73], v3 offset:13312
 v_add_f32 v98, 1.0, v98
 v_mfma_f32_16x16x32_bf16 v[48:51], v[84:87], a[200:203], v[48:51]
 ds_read_b64_tr_b16 v[74:75], v3 offset:13824
 ds_write_b64 v8, v[104:105] offset:1024
 v_mfma_f32_16x16x32_bf16 v[48:51], v[88:91], a[220:223], v[48:51]
 ds_read_b64_tr_b16 v[76:77], v3 offset:14336
 v_mfma_f32_16x16x32_bf16 v[52:55], v[80:83], a[184:187], v[52:55]
 ds_read_b64_tr_b16 v[78:79], v3 offset:14848
 v_rcp_f32 v96, v96
 v_mfma_f32_16x16x32_bf16 v[52:55], v[84:87], a[204:207], v[52:55]
 buffer_load_dwordx4 v10, s[16:19], s32 offen offset:1024 lds
 v_mfma_f32_16x16x32_bf16 v[52:55], v[88:91], a[224:227], v[52:55]
 v_rcp_f32 v97, v97
 v_mul_f32 v96, v36, v96
 v_mfma_f32_16x16x32_bf16 v[56:59], v[80:83], a[188:191], v[56:59]
 v_rcp_f32 v98, v98
 v_mul_f32 v97, v37, v97
 v_mfma_f32_16x16x32_bf16 v[56:59], v[84:87], a[208:211], v[56:59]
 v_exp_f32 v99, v39
 v_cvt_pk_bf16_f32 v106, v96, v97
 v_mfma_f32_16x16x32_bf16 v[56:59], v[88:91], a[228:231], v[56:59]
 v_exp_f32 v92, v40
 v_mfma_f32_16x16x32_bf16 v[60:63], v[80:83], a[192:195], v[60:63]
 buffer_load_dwordx4 v11, s[16:19], s32 offen offset:2048 lds
 v_mfma_f32_16x16x32_bf16 v[60:63], v[84:87], a[212:215], v[60:63]
 s_waitcnt vmcnt(6) lgkmcnt(0)
 v_exp_f32 v93, v41
 v_mul_f32 v98, v38, v98
 v_mfma_f32_16x16x32_bf16 v[60:63], v[88:91], a[232:235], v[60:63]
 s_barrier
 v_exp_f32 v94, v42
 v_add_f32 v99, 1.0, v99
 v_mfma_f32_16x16x32_bf16 v[64:67], v[68:71], v[152:155], v[64:67]
 s_add_u32 m0, m0, 12288
 ds_read_b64_tr_b16 v[80:81], v3 offset:24576
 v_add_f32 v92, 1.0, v92
 v_mfma_f32_16x16x32_bf16 v[64:67], v[72:75], v[172:175], v[64:67]
 s_add_u32 s32, s32, 884736
 ds_read_b64_tr_b16 v[82:83], v3 offset:25088
 v_add_f32 v93, 1.0, v93
 v_mfma_f32_16x16x32_bf16 v[64:67], v[76:79], v[192:195], v[64:67]
 buffer_load_dwordx4 v9, s[16:19], s32 offen lds
 v_mfma_f32_16x16x32_bf16 v[48:51], v[68:71], a[240:243], v[48:51]
 ds_read_b64_tr_b16 v[84:85], v3 offset:25600
 v_add_f32 v94, 1.0, v94
 v_mfma_f32_16x16x32_bf16 v[48:51], v[72:75], v[156:159], v[48:51]
 ds_read_b64_tr_b16 v[86:87], v3 offset:26112
 v_rcp_f32 v99, v99
 v_mfma_f32_16x16x32_bf16 v[48:51], v[76:79], v[176:179], v[48:51]
 ds_read_b64_tr_b16 v[88:89], v3 offset:26624
 v_mul_f32 v99, v39, v99
 v_cvt_pk_bf16_f32 v107, v98, v99
 v_mfma_f32_16x16x32_bf16 v[52:55], v[68:71], a[244:247], v[52:55]
 ds_read_b64_tr_b16 v[90:91], v3 offset:27136
 v_mfma_f32_16x16x32_bf16 v[52:55], v[72:75], v[160:163], v[52:55]
 buffer_load_dwordx4 v10, s[16:19], s32 offen offset:1024 lds
 v_mfma_f32_16x16x32_bf16 v[52:55], v[76:79], v[180:183], v[52:55]
 ds_write_b64 v8, v[106:107] offset:2048
 v_rcp_f32 v92, v92
 v_mfma_f32_16x16x32_bf16 v[56:59], v[68:71], a[248:251], v[56:59]
 v_rcp_f32 v93, v93
 v_mfma_f32_16x16x32_bf16 v[56:59], v[72:75], v[164:167], v[56:59]
 v_rcp_f32 v94, v94
 v_mul_f32 v92, v40, v92
 v_mfma_f32_16x16x32_bf16 v[56:59], v[76:79], v[184:187], v[56:59]
 v_exp_f32 v95, v43
 v_mul_f32 v93, v41, v93
 v_mfma_f32_16x16x32_bf16 v[60:63], v[68:71], a[252:255], v[60:63]
 buffer_load_dwordx4 v11, s[16:19], s32 offen offset:2048 lds
 v_mfma_f32_16x16x32_bf16 v[60:63], v[72:75], v[168:171], v[60:63]
 v_cvt_pk_bf16_f32 v108, v92, v93
 v_mul_f32 v94, v42, v94
 v_add_f32 v95, 1.0, v95
 v_mfma_f32_16x16x32_bf16 v[60:63], v[76:79], v[188:191], v[60:63]
 s_waitcnt lgkmcnt(1)
 v_rcp_f32 v95, v95
 v_mfma_f32_16x16x32_bf16 v[64:67], v[80:83], v[212:215], v[64:67]
 s_add_u32 m0, m0, 12288
 ds_read_b64_tr_b16 v[68:69], v2 offset:0
 v_mul_f32 v95, v43, v95
 v_cvt_pk_bf16_f32 v109, v94, v95
 v_mfma_f32_16x16x32_bf16 v[64:67], v[84:87], v[232:235], v[64:67]
 s_add_u32 s32, s32, 884736
 ds_read_b64_tr_b16 v[70:71], v2 offset:512
 v_mfma_f32_16x16x32_bf16 v[64:67], v[88:91], v[252:255], v[64:67]
 buffer_load_dwordx4 v9, s[16:19], s32 offen lds
 v_mfma_f32_16x16x32_bf16 v[48:51], v[80:83], v[196:199], v[48:51]
 ds_read_b64_tr_b16 v[72:73], v2 offset:1024
 v_mfma_f32_16x16x32_bf16 v[48:51], v[84:87], v[216:219], v[48:51]
 ds_read_b64_tr_b16 v[74:75], v2 offset:1536
 ds_write_b64 v8, v[108:109] offset:3072
 v_add_u32 v8, 10240, v8
 v_mfma_f32_16x16x32_bf16 v[48:51], v[88:91], v[236:239], v[48:51]
 ds_read_b64_tr_b16 v[76:77], v2 offset:2048
 v_mfma_f32_16x16x32_bf16 v[52:55], v[80:83], v[200:203], v[52:55]
 ds_read_b64_tr_b16 v[78:79], v2 offset:2560
 v_mfma_f32_16x16x32_bf16 v[52:55], v[84:87], v[220:223], v[52:55]
 buffer_load_dwordx4 v10, s[16:19], s32 offen offset:1024 lds
 v_mfma_f32_16x16x32_bf16 v[52:55], v[88:91], v[240:243], v[52:55]
 v_mfma_f32_16x16x32_bf16 v[56:59], v[80:83], v[204:207], v[56:59]
 v_exp_f32 v92, v64
 v_exp_f32 v93, v65
 v_mfma_f32_16x16x32_bf16 v[56:59], v[84:87], v[224:227], v[56:59]
 v_exp_f32 v94, v66
 v_add_f32 v92, 1.0, v92
 v_add_f32 v93, 1.0, v93
 v_mfma_f32_16x16x32_bf16 v[56:59], v[88:91], v[244:247], v[56:59]
 v_rcp_f32 v92, v92
 v_add_f32 v94, 1.0, v94
 v_mfma_f32_16x16x32_bf16 v[60:63], v[80:83], v[208:211], v[60:63]
 buffer_load_dwordx4 v11, s[16:19], s32 offen offset:2048 lds
 v_mul_f32 v92, v64, v92
 v_mfma_f32_16x16x32_bf16 v[60:63], v[84:87], v[228:231], v[60:63]
 s_waitcnt vmcnt(6) lgkmcnt(0)
 v_rcp_f32 v93, v93
 v_rcp_f32 v94, v94
 v_mfma_f32_16x16x32_bf16 v[60:63], v[88:91], v[248:251], v[60:63]
 s_barrier
 v_exp_f32 v95, v67
 v_mul_f32 v93, v65, v93
 v_cvt_pk_bf16_f32 v100, v92, v93
 v_mfma_f32_16x16x32_bf16 v[44:47], v[68:71], a[16:19], 0
 s_add_u32 m0, m0, 12288
 ds_read_b64_tr_b16 v[80:81], v2 offset:12288
 v_mul_f32 v94, v66, v94
 v_add_f32 v95, 1.0, v95
 v_mfma_f32_16x16x32_bf16 v[44:47], v[72:75], a[36:39], v[44:47]
 s_add_u32 s32, s32, 884736
 ds_read_b64_tr_b16 v[82:83], v2 offset:12800
 v_rcp_f32 v95, v95
 v_mfma_f32_16x16x32_bf16 v[44:47], v[76:79], a[56:59], v[44:47]
 buffer_load_dwordx4 v9, s[16:19], s32 offen lds
 v_mfma_f32_16x16x32_bf16 v[28:31], v[68:71], a[0:3], 0
 ds_read_b64_tr_b16 v[84:85], v2 offset:13312
 v_mul_f32 v95, v67, v95
 v_cvt_pk_bf16_f32 v101, v94, v95
 v_mfma_f32_16x16x32_bf16 v[28:31], v[72:75], a[20:23], v[28:31]
 ds_read_b64_tr_b16 v[86:87], v2 offset:13824
 v_exp_f32 v96, v48
 v_mfma_f32_16x16x32_bf16 v[28:31], v[76:79], a[40:43], v[28:31]
 ds_read_b64_tr_b16 v[88:89], v2 offset:14336
 v_add_f32 v96, 1.0, v96
 v_rcp_f32 v96, v96
 v_mfma_f32_16x16x32_bf16 v[32:35], v[68:71], a[4:7], 0
 ds_read_b64_tr_b16 v[90:91], v2 offset:14848
 v_mul_f32 v96, v48, v96
 v_mfma_f32_16x16x32_bf16 v[32:35], v[72:75], a[24:27], v[32:35]
 buffer_load_dwordx4 v10, s[16:19], s32 offen offset:1024 lds
 v_mfma_f32_16x16x32_bf16 v[32:35], v[76:79], a[44:47], v[32:35]
 ds_write_b64 v8, v[100:101] offset:4096
 v_exp_f32 v97, v49
 v_mfma_f32_16x16x32_bf16 v[36:39], v[68:71], a[8:11], 0
 v_exp_f32 v98, v50
 v_add_f32 v97, 1.0, v97
 v_rcp_f32 v97, v97
 v_mfma_f32_16x16x32_bf16 v[36:39], v[72:75], a[28:31], v[36:39]
 v_exp_f32 v99, v51
 v_mul_f32 v97, v49, v97
 v_cvt_pk_bf16_f32 v102, v96, v97
 v_mfma_f32_16x16x32_bf16 v[36:39], v[76:79], a[48:51], v[36:39]
 v_exp_f32 v92, v52
 v_add_f32 v98, 1.0, v98
 v_add_f32 v99, 1.0, v99
 v_mfma_f32_16x16x32_bf16 v[40:43], v[68:71], a[12:15], 0
 buffer_load_dwordx4 v11, s[16:19], s32 offen offset:2048 lds
 v_mfma_f32_16x16x32_bf16 v[40:43], v[72:75], a[32:35], v[40:43]
 v_rcp_f32 v98, v98
 v_add_f32 v92, 1.0, v92
 v_mfma_f32_16x16x32_bf16 v[40:43], v[76:79], a[52:55], v[40:43]
 s_waitcnt lgkmcnt(1)
 v_rcp_f32 v99, v99
 v_mul_f32 v98, v50, v98
 v_rcp_f32 v92, v92
 v_mfma_f32_16x16x32_bf16 v[44:47], v[80:83], a[76:79], v[44:47]
 s_sub_u32 m0, m0, 61440
 ds_read_b64_tr_b16 v[68:69], v2 offset:24576
 ds_read_b128 a[16:19], v6 offset:4096
 v_add_u32 v9, s49, v12
 v_mul_f32 v99, v51, v99
 v_mfma_f32_16x16x32_bf16 v[44:47], v[84:87], a[96:99], v[44:47]
 ds_read_b64_tr_b16 v[70:71], v2 offset:25088
 ds_read_b128 a[0:3], v6 offset:0
 v_mfma_f32_16x16x32_bf16 v[44:47], v[88:91], a[116:119], v[44:47]
 buffer_load_dwordx4 v9, s[20:23], s84 offen lds
 v_mfma_f32_16x16x32_bf16 v[28:31], v[80:83], a[60:63], v[28:31]
 ds_read_b64_tr_b16 v[72:73], v2 offset:25600
 ds_read_b128 a[4:7], v6 offset:1024
 v_mfma_f32_16x16x32_bf16 v[28:31], v[84:87], a[80:83], v[28:31]
 ds_read_b64_tr_b16 v[74:75], v2 offset:26112
 ds_read_b128 a[8:11], v6 offset:2048
 v_mfma_f32_16x16x32_bf16 v[28:31], v[88:91], a[100:103], v[28:31]
 ds_read_b64_tr_b16 v[76:77], v2 offset:26624
 v_cvt_pk_bf16_f32 v103, v98, v99
 v_mul_f32 v92, v52, v92
 v_mfma_f32_16x16x32_bf16 v[32:35], v[80:83], a[64:67], v[32:35]
 ds_read_b64_tr_b16 v[78:79], v2 offset:27136
 v_exp_f32 v93, v53
 v_mfma_f32_16x16x32_bf16 v[32:35], v[84:87], a[84:87], v[32:35]
 buffer_load_dwordx4 v9, s[20:23], s85 offen offset:1024 lds
 v_mfma_f32_16x16x32_bf16 v[32:35], v[88:91], a[104:107], v[32:35]
 ds_read_b128 a[12:15], v6 offset:3072
 v_add_f32 v93, 1.0, v93
 v_mfma_f32_16x16x32_bf16 v[36:39], v[80:83], a[68:71], v[36:39]
 ds_read_b128 a[36:39], v6 offset:9216
 ds_write_b64 v8, v[102:103] offset:0
 v_mfma_f32_16x16x32_bf16 v[36:39], v[84:87], a[88:91], v[36:39]
 ds_read_b128 a[20:23], v6 offset:5120
 v_rcp_f32 v93, v93
 v_mfma_f32_16x16x32_bf16 v[36:39], v[88:91], a[108:111], v[36:39]
 ds_read_b128 a[24:27], v6 offset:6144
 v_mul_f32 v93, v53, v93
 v_cvt_pk_bf16_f32 v104, v92, v93
 v_mfma_f32_16x16x32_bf16 v[40:43], v[80:83], a[72:75], v[40:43]
 buffer_load_dwordx4 v9, s[20:23], s86 offen offset:2048 lds
 v_mfma_f32_16x16x32_bf16 v[40:43], v[84:87], a[92:95], v[40:43]
 s_waitcnt vmcnt(6) lgkmcnt(5)
 v_exp_f32 v94, v54
 v_exp_f32 v95, v55
 v_mfma_f32_16x16x32_bf16 v[40:43], v[88:91], a[112:115], v[40:43]
 s_barrier
 v_exp_f32 v96, v56
 v_add_f32 v94, 1.0, v94
 v_add_f32 v95, 1.0, v95
 v_mfma_f32_16x16x32_bf16 v[44:47], v[68:71], a[136:139], v[44:47]
 s_add_u32 m0, m0, 12288
 ds_read_b64_tr_b16 v[80:81], v3 offset:0
 ds_read_b128 a[28:31], v6 offset:7168
 v_add_f32 v96, 1.0, v96
 v_mfma_f32_16x16x32_bf16 v[44:47], v[72:75], a[156:159], v[44:47]
 ds_read_b64_tr_b16 v[82:83], v3 offset:512
 ds_read_b128 a[32:35], v6 offset:8192
 v_mfma_f32_16x16x32_bf16 v[44:47], v[76:79], a[176:179], v[44:47]
 buffer_load_dwordx4 v9, s[20:23], s87 offen lds
 v_mfma_f32_16x16x32_bf16 v[28:31], v[68:71], a[120:123], v[28:31]
 ds_read_b64_tr_b16 v[84:85], v3 offset:1024
 ds_read_b128 a[56:59], v6 offset:14336
 v_mfma_f32_16x16x32_bf16 v[28:31], v[72:75], a[140:143], v[28:31]
 ds_read_b64_tr_b16 v[86:87], v3 offset:1536
 ds_read_b128 a[40:43], v6 offset:10240
 v_mfma_f32_16x16x32_bf16 v[28:31], v[76:79], a[160:163], v[28:31]
 ds_read_b64_tr_b16 v[88:89], v3 offset:2048
 v_rcp_f32 v94, v94
 v_mfma_f32_16x16x32_bf16 v[32:35], v[68:71], a[124:127], v[32:35]
 ds_read_b64_tr_b16 v[90:91], v3 offset:2560
 v_mul_f32 v94, v54, v94
 v_mfma_f32_16x16x32_bf16 v[32:35], v[72:75], a[144:147], v[32:35]
 buffer_load_dwordx4 v9, s[20:23], s88 offen offset:1024 lds
 v_mfma_f32_16x16x32_bf16 v[32:35], v[76:79], a[164:167], v[32:35]
 ds_read_b128 a[44:47], v6 offset:11264
 v_rcp_f32 v95, v95
 v_rcp_f32 v96, v96
 v_mfma_f32_16x16x32_bf16 v[36:39], v[68:71], a[128:131], v[36:39]
 s_add_u32 s49, s49, 128
 s_cmp_eq_u32 s49, 1152
 s_cselect_b32 s49, 0, s49
 ds_read_b128 a[48:51], v6 offset:12288
 v_mul_f32 v95, v55, v95
 v_cvt_pk_bf16_f32 v105, v94, v95
 v_mfma_f32_16x16x32_bf16 v[36:39], v[72:75], a[148:151], v[36:39]
 ds_read_b128 a[52:55], v6 offset:13312
 v_mul_f32 v96, v56, v96
 v_mfma_f32_16x16x32_bf16 v[36:39], v[76:79], a[168:171], v[36:39]
 ds_read_b128 a[76:79], v6 offset:19456
 v_exp_f32 v97, v57
 v_mfma_f32_16x16x32_bf16 v[40:43], v[68:71], a[132:135], v[40:43]
 buffer_load_dwordx4 v9, s[20:23], s89 offen offset:2048 lds
 v_add_f32 v97, 1.0, v97
 v_mfma_f32_16x16x32_bf16 v[40:43], v[72:75], a[152:155], v[40:43]
 v_rcp_f32 v97, v97
 v_exp_f32 v98, v58
 v_mfma_f32_16x16x32_bf16 v[40:43], v[76:79], a[172:175], v[40:43]
 s_waitcnt lgkmcnt(4)
 v_exp_f32 v99, v59
 v_mul_f32 v97, v57, v97
 v_cvt_pk_bf16_f32 v106, v96, v97
 v_mfma_f32_16x16x32_bf16 v[44:47], v[80:83], a[196:199], v[44:47]
 s_add_u32 m0, m0, 12288
 ds_read_b64_tr_b16 v[68:69], v3 offset:12288
 ds_read_b128 a[60:63], v6 offset:15360
 ds_write_b64 v8, v[104:105] offset:1024
 v_mfma_f32_16x16x32_bf16 v[44:47], v[84:87], a[216:219], v[44:47]
 ds_read_b64_tr_b16 v[70:71], v3 offset:12800
 ds_read_b128 a[64:67], v6 offset:16384
 v_mfma_f32_16x16x32_bf16 v[44:47], v[88:91], a[236:239], v[44:47]
 buffer_load_dwordx4 v9, s[20:23], s90 offen lds
 v_mfma_f32_16x16x32_bf16 v[28:31], v[80:83], a[180:183], v[28:31]
 ds_read_b64_tr_b16 v[72:73], v3 offset:13312
 ds_read_b128 a[68:71], v6 offset:17408
 v_mfma_f32_16x16x32_bf16 v[28:31], v[84:87], a[200:203], v[28:31]
 ds_read_b64_tr_b16 v[74:75], v3 offset:13824
 ds_read_b128 a[72:75], v6 offset:18432
 v_mfma_f32_16x16x32_bf16 v[28:31], v[88:91], a[220:223], v[28:31]
 ds_read_b64_tr_b16 v[76:77], v3 offset:14336
 v_add_f32 v98, 1.0, v98
 v_mfma_f32_16x16x32_bf16 v[32:35], v[80:83], a[184:187], v[32:35]
 ds_read_b64_tr_b16 v[78:79], v3 offset:14848
 v_add_f32 v99, 1.0, v99
 v_mfma_f32_16x16x32_bf16 v[32:35], v[84:87], a[204:207], v[32:35]
 buffer_load_dwordx4 v9, s[20:23], s91 offen offset:1024 lds
 v_mfma_f32_16x16x32_bf16 v[32:35], v[88:91], a[224:227], v[32:35]
 ds_read_b128 a[96:99], v6 offset:24576
 v_rcp_f32 v98, v98
 v_mfma_f32_16x16x32_bf16 v[36:39], v[80:83], a[188:191], v[36:39]
 ds_read_b128 a[80:83], v6 offset:20480
 v_mul_f32 v98, v58, v98
 v_mfma_f32_16x16x32_bf16 v[36:39], v[84:87], a[208:211], v[36:39]
 ds_read_b128 a[84:87], v6 offset:21504
 v_rcp_f32 v99, v99
 v_mfma_f32_16x16x32_bf16 v[36:39], v[88:91], a[228:231], v[36:39]
 ds_read_b128 a[88:91], v6 offset:22528
 v_mul_f32 v99, v59, v99
 v_cvt_pk_bf16_f32 v107, v98, v99
 v_mfma_f32_16x16x32_bf16 v[40:43], v[80:83], a[192:195], v[40:43]
 buffer_load_dwordx4 v9, s[20:23], s92 offen offset:2048 lds
 v_mfma_f32_16x16x32_bf16 v[40:43], v[84:87], a[212:215], v[40:43]
 s_waitcnt vmcnt(6) lgkmcnt(4)
 v_exp_f32 v92, v60
 v_exp_f32 v93, v61
 v_exp_f32 v94, v62
 v_mfma_f32_16x16x32_bf16 v[40:43], v[88:91], a[232:235], v[40:43]
 s_barrier
 v_exp_f32 v95, v63
 v_add_f32 v92, 1.0, v92
 v_add_f32 v93, 1.0, v93
 v_mfma_f32_16x16x32_bf16 v[44:47], v[68:71], v[152:155], v[44:47]
 s_add_u32 m0, m0, 12288
 ds_read_b64_tr_b16 v[80:81], v3 offset:24576
 ds_read_b128 a[92:95], v6 offset:23552
 ds_write_b64 v8, v[106:107] offset:2048
 v_mfma_f32_16x16x32_bf16 v[44:47], v[72:75], v[172:175], v[44:47]
 ds_read_b64_tr_b16 v[82:83], v3 offset:25088
 ds_read_b128 a[116:119], v6 offset:29696
 v_mfma_f32_16x16x32_bf16 v[44:47], v[76:79], v[192:195], v[44:47]
 buffer_load_dwordx4 v9, s[20:23], s93 offen lds
 v_mfma_f32_16x16x32_bf16 v[28:31], v[68:71], a[240:243], v[28:31]
 ds_read_b64_tr_b16 v[84:85], v3 offset:25600
 ds_read_b128 a[100:103], v6 offset:25600
 v_mfma_f32_16x16x32_bf16 v[28:31], v[72:75], v[156:159], v[28:31]
 ds_read_b64_tr_b16 v[86:87], v3 offset:26112
 ds_read_b128 a[104:107], v6 offset:26624
 v_mfma_f32_16x16x32_bf16 v[28:31], v[76:79], v[176:179], v[28:31]
 ds_read_b64_tr_b16 v[88:89], v3 offset:26624
 v_add_f32 v94, 1.0, v94
 v_mfma_f32_16x16x32_bf16 v[32:35], v[68:71], a[244:247], v[32:35]
 ds_read_b64_tr_b16 v[90:91], v3 offset:27136
 v_add_f32 v95, 1.0, v95
 v_mfma_f32_16x16x32_bf16 v[32:35], v[72:75], v[160:163], v[32:35]
 buffer_load_dwordx4 v9, s[20:23], s94 offen offset:1024 lds
 v_mfma_f32_16x16x32_bf16 v[32:35], v[76:79], v[180:183], v[32:35]
 ds_read_b128 a[108:111], v6 offset:27648
 v_rcp_f32 v92, v92
 v_mfma_f32_16x16x32_bf16 v[36:39], v[68:71], a[248:251], v[36:39]
 ds_read_b128 a[112:115], v6 offset:28672
 v_mul_f32 v92, v60, v92
 v_mfma_f32_16x16x32_bf16 v[36:39], v[72:75], v[164:167], v[36:39]
 ds_read_b128 a[136:139], v6 offset:34816
 v_rcp_f32 v93, v93
 v_mfma_f32_16x16x32_bf16 v[36:39], v[76:79], v[184:187], v[36:39]
 ds_read_b128 a[120:123], v6 offset:30720
 v_mul_f32 v93, v61, v93
 v_cvt_pk_bf16_f32 v108, v92, v93
 v_mfma_f32_16x16x32_bf16 v[40:43], v[68:71], a[252:255], v[40:43]
 buffer_load_dwordx4 v9, s[20:23], s95 offen offset:2048 lds
 v_mfma_f32_16x16x32_bf16 v[40:43], v[72:75], v[168:171], v[40:43]
 v_rcp_f32 v94, v94
 v_rcp_f32 v95, v95
 v_mfma_f32_16x16x32_bf16 v[40:43], v[76:79], v[188:191], v[40:43]
 s_waitcnt lgkmcnt(4)
 v_mul_f32 v94, v62, v94
 v_mul_f32 v95, v63, v95
 v_cvt_pk_bf16_f32 v109, v94, v95
 v_mfma_f32_16x16x32_bf16 v[44:47], v[80:83], v[212:215], v[44:47]
 s_add_u32 m0, m0, 12288
 ds_read_b64_tr_b16 v[68:69], v2 offset:0
 ds_read_b128 a[124:127], v6 offset:31744
 v_mfma_f32_16x16x32_bf16 v[44:47], v[84:87], v[232:235], v[44:47]
 ds_read_b64_tr_b16 v[70:71], v2 offset:512
 ds_read_b128 a[128:131], v6 offset:32768
 v_mfma_f32_16x16x32_bf16 v[44:47], v[88:91], v[252:255], v[44:47]
 buffer_load_dwordx4 v9, s[20:23], s96 offen lds
 v_mfma_f32_16x16x32_bf16 v[28:31], v[80:83], v[196:199], v[28:31]
 ds_read_b64_tr_b16 v[72:73], v2 offset:1024
 ds_read_b128 a[132:135], v6 offset:33792
 ds_write_b64 v8, v[108:109] offset:3072
 v_subrev_u32 v8, 71680, v8
 v_mfma_f32_16x16x32_bf16 v[28:31], v[84:87], v[216:219], v[28:31]
 ds_read_b64_tr_b16 v[74:75], v2 offset:1536
 ds_read_b128 a[156:159], v6 offset:39936
 v_mfma_f32_16x16x32_bf16 v[28:31], v[88:91], v[236:239], v[28:31]
 ds_read_b64_tr_b16 v[76:77], v2 offset:2048
 v_mfma_f32_16x16x32_bf16 v[32:35], v[80:83], v[200:203], v[32:35]
 ds_read_b64_tr_b16 v[78:79], v2 offset:2560
 v_mfma_f32_16x16x32_bf16 v[32:35], v[84:87], v[220:223], v[32:35]
 buffer_load_dwordx4 v9, s[20:23], s97 offen offset:1024 lds
 v_mfma_f32_16x16x32_bf16 v[32:35], v[88:91], v[240:243], v[32:35]
 ds_read_b128 a[140:143], v6 offset:35840
 v_mfma_f32_16x16x32_bf16 v[36:39], v[80:83], v[204:207], v[36:39]
 ds_read_b128 a[144:147], v6 offset:36864
 v_exp_f32 v92, v44
 v_exp_f32 v93, v45
 v_mfma_f32_16x16x32_bf16 v[36:39], v[84:87], v[224:227], v[36:39]
 ds_read_b128 a[148:151], v6 offset:37888
 v_add_f32 v92, 1.0, v92
 v_add_f32 v93, 1.0, v93
 v_rcp_f32 v92, v92
 v_mfma_f32_16x16x32_bf16 v[36:39], v[88:91], v[244:247], v[36:39]
 ds_read_b128 a[152:155], v6 offset:38912
 v_mul_f32 v92, v44, v92
 v_rcp_f32 v93, v93
 v_exp_f32 v94, v46
 v_mfma_f32_16x16x32_bf16 v[40:43], v[80:83], v[208:211], v[40:43]
 buffer_load_dwordx4 v9, s[20:23], s98 offen offset:2048 lds
 v_mfma_f32_16x16x32_bf16 v[40:43], v[84:87], v[228:231], v[40:43]
 s_waitcnt vmcnt(6) lgkmcnt(4)
 v_exp_f32 v95, v47
 v_mul_f32 v93, v45, v93
 v_cvt_pk_bf16_f32 v100, v92, v93
 v_add_f32 v94, 1.0, v94
 v_rcp_f32 v94, v94
 v_exp_f32 v96, v28
 v_mfma_f32_16x16x32_bf16 v[40:43], v[88:91], v[248:251], v[40:43]
 s_barrier
 v_exp_f32 v97, v29
 v_mul_f32 v94, v46, v94
 v_add_f32 v95, 1.0, v95
 v_add_f32 v96, 1.0, v96
 v_rcp_f32 v95, v95
 v_rcp_f32 v96, v96
 v_mfma_f32_16x16x32_bf16 v[64:67], v[68:71], a[16:19], 0
 s_add_u32 m0, m0, 12288
 ds_read_b64_tr_b16 v[80:81], v2 offset:12288
 ds_read_b128 a[176:179], v6 offset:45056
 v_mfma_f32_16x16x32_bf16 v[64:67], v[72:75], a[36:39], v[64:67]
 ds_read_b64_tr_b16 v[82:83], v2 offset:12800
 ds_read_b128 a[160:163], v6 offset:40960
 v_mfma_f32_16x16x32_bf16 v[64:67], v[76:79], a[56:59], v[64:67]
 buffer_load_dwordx4 v9, s[20:23], s99 offen lds
 v_mfma_f32_16x16x32_bf16 v[48:51], v[68:71], a[0:3], 0
 ds_read_b64_tr_b16 v[84:85], v2 offset:13312
 ds_read_b128 a[164:167], v6 offset:41984
 v_mfma_f32_16x16x32_bf16 v[48:51], v[72:75], a[20:23], v[48:51]
 ds_read_b64_tr_b16 v[86:87], v2 offset:13824
 ds_read_b128 a[168:171], v6 offset:43008
 v_mfma_f32_16x16x32_bf16 v[48:51], v[76:79], a[40:43], v[48:51]
 ds_read_b64_tr_b16 v[88:89], v2 offset:14336
 ds_read_b128 a[172:175], v6 offset:44032
 v_mfma_f32_16x16x32_bf16 v[52:55], v[68:71], a[4:7], 0
 ds_read_b64_tr_b16 v[90:91], v2 offset:14848
 ds_read_b128 a[196:199], v6 offset:50176
 v_mfma_f32_16x16x32_bf16 v[52:55], v[72:75], a[24:27], v[52:55]
 buffer_load_dwordx4 v9, s[20:23], s100 offen offset:1024 lds
 v_mfma_f32_16x16x32_bf16 v[52:55], v[76:79], a[44:47], v[52:55]
 ds_read_b128 a[180:183], v6 offset:46080
 v_mul_f32 v95, v47, v95
 v_cvt_pk_bf16_f32 v101, v94, v95
 v_mul_f32 v96, v28, v96
 v_add_f32 v97, 1.0, v97
 v_mfma_f32_16x16x32_bf16 v[56:59], v[68:71], a[8:11], 0
 ds_read_b128 a[184:187], v6 offset:47104
 v_rcp_f32 v97, v97
 v_exp_f32 v98, v30
 v_mfma_f32_16x16x32_bf16 v[56:59], v[72:75], a[28:31], v[56:59]
 ds_read_b128 a[188:191], v6 offset:48128
 v_mul_f32 v97, v29, v97
 v_cvt_pk_bf16_f32 v102, v96, v97
 v_add_f32 v98, 1.0, v98
 v_rcp_f32 v98, v98
 v_mfma_f32_16x16x32_bf16 v[56:59], v[76:79], a[48:51], v[56:59]
 ds_read_b128 a[192:195], v6 offset:49152
 v_mul_f32 v98, v30, v98
 v_exp_f32 v99, v31
 v_exp_f32 v92, v32
 v_mfma_f32_16x16x32_bf16 v[60:63], v[68:71], a[12:15], 0
 buffer_load_dwordx4 v9, s[20:23], s101 offen offset:2048 lds
 v_mfma_f32_16x16x32_bf16 v[60:63], v[72:75], a[32:35], v[60:63]
 v_exp_f32 v93, v33
 v_add_f32 v99, 1.0, v99
 v_add_f32 v92, 1.0, v92
 v_rcp_f32 v99, v99
 v_rcp_f32 v92, v92
 v_mfma_f32_16x16x32_bf16 v[60:63], v[76:79], a[52:55], v[60:63]
 s_waitcnt lgkmcnt(5)
 v_exp_f32 v94, v34
 v_mul_f32 v99, v31, v99
 v_cvt_pk_bf16_f32 v103, v98, v99
 v_mul_f32 v92, v32, v92
 v_add_f32 v93, 1.0, v93
 v_rcp_f32 v93, v93
 v_exp_f32 v95, v35
 v_mfma_f32_16x16x32_bf16 v[64:67], v[80:83], a[76:79], v[64:67]
 s_sub_u32 m0, m0, 61440
 ds_read_b64_tr_b16 v[68:69], v2 offset:24576
 ds_read_b128 a[216:219], v6 offset:55296
 v_add_u32 v9, s49, v12
 v_mfma_f32_16x16x32_bf16 v[64:67], v[84:87], a[96:99], v[64:67]
 ds_read_b64_tr_b16 v[70:71], v2 offset:25088
 ds_read_b128 a[200:203], v6 offset:51200
 ds_write_b64 v8, v[100:101] offset:4096
 v_mfma_f32_16x16x32_bf16 v[64:67], v[88:91], a[116:119], v[64:67]
 buffer_load_dwordx4 v9, s[20:23], s84 offen lds
 v_mfma_f32_16x16x32_bf16 v[48:51], v[80:83], a[60:63], v[48:51]
 ds_read_b64_tr_b16 v[72:73], v2 offset:25600
 ds_read_b128 a[204:207], v6 offset:52224
 ds_write_b64 v8, v[102:103] offset:0
 v_mfma_f32_16x16x32_bf16 v[48:51], v[84:87], a[80:83], v[48:51]
 ds_read_b64_tr_b16 v[74:75], v2 offset:26112
 ds_read_b128 a[208:211], v6 offset:53248
 v_mfma_f32_16x16x32_bf16 v[48:51], v[88:91], a[100:103], v[48:51]
 ds_read_b64_tr_b16 v[76:77], v2 offset:26624
 ds_read_b128 a[212:215], v6 offset:54272
 v_mfma_f32_16x16x32_bf16 v[52:55], v[80:83], a[64:67], v[52:55]
 ds_read_b64_tr_b16 v[78:79], v2 offset:27136
 ds_read_b128 a[236:239], v6 offset:60416
 v_mfma_f32_16x16x32_bf16 v[52:55], v[84:87], a[84:87], v[52:55]
 buffer_load_dwordx4 v9, s[20:23], s85 offen offset:1024 lds
 v_mfma_f32_16x16x32_bf16 v[52:55], v[88:91], a[104:107], v[52:55]
 ds_read_b128 a[220:223], v6 offset:56320
 v_mul_f32 v93, v33, v93
 v_mfma_f32_16x16x32_bf16 v[56:59], v[80:83], a[68:71], v[56:59]
 ds_read_b128 a[224:227], v6 offset:57344
 v_cvt_pk_bf16_f32 v104, v92, v93
 v_add_f32 v94, 1.0, v94
 v_add_f32 v95, 1.0, v95
 v_mfma_f32_16x16x32_bf16 v[56:59], v[84:87], a[88:91], v[56:59]
 ds_read_b128 a[228:231], v6 offset:58368
 v_rcp_f32 v94, v94
 v_rcp_f32 v95, v95
 v_exp_f32 v96, v36
 v_mfma_f32_16x16x32_bf16 v[56:59], v[88:91], a[108:111], v[56:59]
 ds_read_b128 a[232:235], v6 offset:59392
 v_mul_f32 v94, v34, v94
 v_mul_f32 v95, v35, v95
 v_cvt_pk_bf16_f32 v105, v94, v95
 v_add_f32 v96, 1.0, v96
 v_mfma_f32_16x16x32_bf16 v[60:63], v[80:83], a[72:75], v[60:63]
 buffer_load_dwordx4 v9, s[20:23], s86 offen offset:2048 lds
 v_mfma_f32_16x16x32_bf16 v[60:63], v[84:87], a[92:95], v[60:63]
 s_waitcnt vmcnt(6) lgkmcnt(5)
 v_rcp_f32 v96, v96
 v_exp_f32 v97, v37
 v_exp_f32 v98, v38
 v_exp_f32 v99, v39
 v_mfma_f32_16x16x32_bf16 v[60:63], v[88:91], a[112:115], v[60:63]
 s_barrier
 v_mul_f32 v96, v36, v96
 v_add_f32 v97, 1.0, v97
 v_add_f32 v98, 1.0, v98
 v_add_f32 v99, 1.0, v99
 v_rcp_f32 v97, v97
 v_rcp_f32 v98, v98
 v_rcp_f32 v99, v99
 v_mfma_f32_16x16x32_bf16 v[64:67], v[68:71], a[136:139], v[64:67]
 s_add_u32 m0, m0, 12288
 ds_read_b64_tr_b16 v[80:81], v3 offset:0
 ds_read_b128 v[152:155], v7 offset:4096
 ds_write_b64 v8, v[104:105] offset:1024
 v_mfma_f32_16x16x32_bf16 v[64:67], v[72:75], a[156:159], v[64:67]
 ds_read_b64_tr_b16 v[82:83], v3 offset:512
 ds_read_b128 a[240:243], v7 offset:0
 v_mfma_f32_16x16x32_bf16 v[64:67], v[76:79], a[176:179], v[64:67]
 buffer_load_dwordx4 v9, s[20:23], s87 offen lds
 v_mfma_f32_16x16x32_bf16 v[48:51], v[68:71], a[120:123], v[48:51]
 ds_read_b64_tr_b16 v[84:85], v3 offset:1024
 ds_read_b128 a[244:247], v7 offset:1024
 v_mfma_f32_16x16x32_bf16 v[48:51], v[72:75], a[140:143], v[48:51]
 ds_read_b64_tr_b16 v[86:87], v3 offset:1536
 ds_read_b128 a[248:251], v7 offset:2048
 v_mfma_f32_16x16x32_bf16 v[48:51], v[76:79], a[160:163], v[48:51]
 ds_read_b64_tr_b16 v[88:89], v3 offset:2048
 ds_read_b128 a[252:255], v7 offset:3072
 v_mfma_f32_16x16x32_bf16 v[52:55], v[68:71], a[124:127], v[52:55]
 ds_read_b64_tr_b16 v[90:91], v3 offset:2560
 ds_read_b128 v[172:175], v7 offset:9216
 v_mfma_f32_16x16x32_bf16 v[52:55], v[72:75], a[144:147], v[52:55]
 buffer_load_dwordx4 v9, s[20:23], s88 offen offset:1024 lds
 v_mfma_f32_16x16x32_bf16 v[52:55], v[76:79], a[164:167], v[52:55]
 ds_read_b128 v[156:159], v7 offset:5120
 v_mul_f32 v97, v37, v97
 v_cvt_pk_bf16_f32 v106, v96, v97
 v_mul_f32 v98, v38, v98
 v_mfma_f32_16x16x32_bf16 v[56:59], v[68:71], a[128:131], v[56:59]
 s_add_u32 s49, s49, 128
 s_cmp_eq_u32 s49, 1152
 s_cselect_b32 s49, 0, s49
 ds_read_b128 v[160:163], v7 offset:6144
 v_mul_f32 v99, v39, v99
 v_cvt_pk_bf16_f32 v107, v98, v99
 v_exp_f32 v92, v40
 v_mfma_f32_16x16x32_bf16 v[56:59], v[72:75], a[148:151], v[56:59]
 ds_read_b128 v[164:167], v7 offset:7168
 v_add_f32 v92, 1.0, v92
 v_rcp_f32 v92, v92
 v_exp_f32 v93, v41
 v_mfma_f32_16x16x32_bf16 v[56:59], v[76:79], a[168:171], v[56:59]
 ds_read_b128 v[168:171], v7 offset:8192
 v_mul_f32 v92, v40, v92
 v_add_f32 v93, 1.0, v93
 v_rcp_f32 v93, v93
 v_mfma_f32_16x16x32_bf16 v[60:63], v[68:71], a[132:135], v[60:63]
 buffer_load_dwordx4 v9, s[20:23], s89 offen offset:2048 lds
 v_mfma_f32_16x16x32_bf16 v[60:63], v[72:75], a[152:155], v[60:63]
 v_exp_f32 v94, v42
 v_mul_f32 v93, v41, v93
 v_cvt_pk_bf16_f32 v108, v92, v93
 v_exp_f32 v95, v43
 v_mfma_f32_16x16x32_bf16 v[60:63], v[76:79], a[172:175], v[60:63]
 s_waitcnt lgkmcnt(5)
 v_add_f32 v94, 1.0, v94
 v_add_f32 v95, 1.0, v95
 v_rcp_f32 v94, v94
 v_rcp_f32 v95, v95
 v_mfma_f32_16x16x32_bf16 v[64:67], v[80:83], a[196:199], v[64:67]
 s_add_u32 m0, m0, 12288
 ds_read_b64_tr_b16 v[68:69], v3 offset:12288
 ds_read_b128 v[192:195], v7 offset:14336
 ds_write_b64 v8, v[106:107] offset:2048
 v_mul_f32 v94, v42, v94
 v_mul_f32 v95, v43, v95
 v_cvt_pk_bf16_f32 v109, v94, v95
 v_mfma_f32_16x16x32_bf16 v[64:67], v[84:87], a[216:219], v[64:67]
 ds_read_b64_tr_b16 v[70:71], v3 offset:12800
 ds_read_b128 v[176:179], v7 offset:10240
 v_mfma_f32_16x16x32_bf16 v[64:67], v[88:91], a[236:239], v[64:67]
 buffer_load_dwordx4 v9, s[20:23], s90 offen lds
 v_mfma_f32_16x16x32_bf16 v[48:51], v[80:83], a[180:183], v[48:51]
 ds_read_b64_tr_b16 v[72:73], v3 offset:13312
 ds_read_b128 v[180:183], v7 offset:11264
 v_mfma_f32_16x16x32_bf16 v[48:51], v[84:87], a[200:203], v[48:51]
 ds_read_b64_tr_b16 v[74:75], v3 offset:13824
 ds_read_b128 v[184:187], v7 offset:12288
 ds_write_b64 v8, v[108:109] offset:3072
 v_mfma_f32_16x16x32_bf16 v[48:51], v[88:91], a[220:223], v[48:51]
 ds_read_b64_tr_b16 v[76:77], v3 offset:14336
 ds_read_b128 v[188:191], v7 offset:13312
 v_mfma_f32_16x16x32_bf16 v[52:55], v[80:83], a[184:187], v[52:55]
 ds_read_b64_tr_b16 v[78:79], v3 offset:14848
 ds_read_b128 v[212:215], v7 offset:19456
 v_mfma_f32_16x16x32_bf16 v[52:55], v[84:87], a[204:207], v[52:55]
 buffer_load_dwordx4 v9, s[20:23], s91 offen offset:1024 lds
 v_mfma_f32_16x16x32_bf16 v[52:55], v[88:91], a[224:227], v[52:55]
 ds_read_b128 v[196:199], v7 offset:15360
 v_mfma_f32_16x16x32_bf16 v[56:59], v[80:83], a[188:191], v[56:59]
 ds_read_b128 v[200:203], v7 offset:16384
 v_mfma_f32_16x16x32_bf16 v[56:59], v[84:87], a[208:211], v[56:59]
 ds_read_b128 v[204:207], v7 offset:17408
 v_mfma_f32_16x16x32_bf16 v[56:59], v[88:91], a[228:231], v[56:59]
 ds_read_b128 v[208:211], v7 offset:18432
 v_mfma_f32_16x16x32_bf16 v[60:63], v[80:83], a[192:195], v[60:63]
 buffer_load_dwordx4 v9, s[20:23], s92 offen offset:2048 lds
 v_mfma_f32_16x16x32_bf16 v[60:63], v[84:87], a[212:215], v[60:63]
 s_waitcnt vmcnt(9) lgkmcnt(5)
 v_mfma_f32_16x16x32_bf16 v[60:63], v[88:91], a[232:235], v[60:63]
 s_barrier
 v_mfma_f32_16x16x32_bf16 v[64:67], v[68:71], v[152:155], v[64:67]
 s_add_u32 m0, m0, 12288
 ds_read_b64_tr_b16 v[80:81], v3 offset:24576
 ds_read_b128 v[232:235], v6 offset:4096
 v_mfma_f32_16x16x32_bf16 v[64:67], v[72:75], v[172:175], v[64:67]
 ds_read_b64_tr_b16 v[82:83], v3 offset:25088
 ds_read_b128 v[216:219], v6 offset:0
 v_mfma_f32_16x16x32_bf16 v[64:67], v[76:79], v[192:195], v[64:67]
 buffer_load_dwordx4 v9, s[20:23], s93 offen lds
 v_mfma_f32_16x16x32_bf16 v[48:51], v[68:71], a[240:243], v[48:51]
 ds_read_b64_tr_b16 v[84:85], v3 offset:25600
 ds_read_b128 v[220:223], v6 offset:1024
 v_mfma_f32_16x16x32_bf16 v[48:51], v[72:75], v[156:159], v[48:51]
 ds_read_b64_tr_b16 v[86:87], v3 offset:26112
 ds_read_b128 v[224:227], v6 offset:2048
 v_mfma_f32_16x16x32_bf16 v[48:51], v[76:79], v[176:179], v[48:51]
 ds_read_b64_tr_b16 v[88:89], v3 offset:26624
 buffer_load_dwordx4 v9, s[20:23], s94 offen offset:1024 lds
 ds_read_b128 v[228:231], v6 offset:3072
 v_mfma_f32_16x16x32_bf16 v[52:55], v[68:71], a[244:247], v[52:55]
 ds_read_b64_tr_b16 v[90:91], v3 offset:27136
 ds_read_b128 v[252:255], v6 offset:9216
 v_mfma_f32_16x16x32_bf16 v[52:55], v[72:75], v[160:163], v[52:55]
 buffer_load_dwordx4 v9, s[20:23], s95 offen offset:2048 lds
 v_mfma_f32_16x16x32_bf16 v[52:55], v[76:79], v[180:183], v[52:55]
 s_add_u32 m0, m0, 12288
 ds_read_b128 v[236:239], v6 offset:5120
 v_mfma_f32_16x16x32_bf16 v[56:59], v[68:71], a[248:251], v[56:59]
 buffer_load_dwordx4 v9, s[20:23], s96 offen lds
 ds_read_b128 v[240:243], v6 offset:6144
 v_mfma_f32_16x16x32_bf16 v[56:59], v[72:75], v[164:167], v[56:59]
 ds_read_b128 v[244:247], v6 offset:7168
 v_mfma_f32_16x16x32_bf16 v[56:59], v[76:79], v[184:187], v[56:59]
 buffer_load_dwordx4 v9, s[20:23], s97 offen offset:1024 lds
 ds_read_b128 v[248:251], v6 offset:8192
 v_mfma_f32_16x16x32_bf16 v[60:63], v[68:71], a[252:255], v[60:63]
 buffer_load_dwordx4 v9, s[20:23], s98 offen offset:2048 lds
 v_mfma_f32_16x16x32_bf16 v[60:63], v[72:75], v[168:171], v[60:63]
 s_waitcnt vmcnt(12) lgkmcnt(5)
 v_mfma_f32_16x16x32_bf16 v[60:63], v[76:79], v[188:191], v[60:63]
 s_barrier
 v_mfma_f32_16x16x32_bf16 v[64:67], v[80:83], v[212:215], v[64:67]
 s_add_u32 m0, m0, 12288
 ds_read_b64_tr_b16 v[68:69], v2 offset:0
 v_mfma_f32_16x16x32_bf16 v[64:67], v[84:87], v[232:235], v[64:67]
 ds_read_b64_tr_b16 v[70:71], v2 offset:512
 s_waitcnt lgkmcnt(6)
 v_mfma_f32_16x16x32_bf16 v[64:67], v[88:91], v[252:255], v[64:67]
 buffer_load_dwordx4 v9, s[20:23], s99 offen lds
 v_mfma_f32_16x16x32_bf16 v[48:51], v[80:83], v[196:199], v[48:51]
 ds_read_b64_tr_b16 v[72:73], v2 offset:1024
 v_mfma_f32_16x16x32_bf16 v[48:51], v[84:87], v[216:219], v[48:51]
 ds_read_b64_tr_b16 v[74:75], v2 offset:1536
 s_waitcnt lgkmcnt(7)
 v_mfma_f32_16x16x32_bf16 v[48:51], v[88:91], v[236:239], v[48:51]
 ds_read_b64_tr_b16 v[76:77], v2 offset:2048
 v_mfma_f32_16x16x32_bf16 v[52:55], v[80:83], v[200:203], v[52:55]
 ds_read_b64_tr_b16 v[78:79], v2 offset:2560
 v_mfma_f32_16x16x32_bf16 v[52:55], v[84:87], v[220:223], v[52:55]
 buffer_load_dwordx4 v9, s[20:23], s100 offen offset:1024 lds
 s_waitcnt lgkmcnt(8)
 v_mfma_f32_16x16x32_bf16 v[52:55], v[88:91], v[240:243], v[52:55]
 s_mov_b32 s33, -7
 s_waitcnt lgkmcnt(6)
L_p2:
 v_mfma_f32_16x16x32_bf16 v[56:59], v[80:83], v[204:207], v[56:59]
 v_cvt_pk_bf16_f32 v100, v64, v65
 v_cvt_pk_bf16_f32 v101, v66, v67
 v_mfma_f32_16x16x32_bf16 v[56:59], v[84:87], v[224:227], v[56:59]
 v_cvt_pk_bf16_f32 v102, v48, v49
 v_cvt_pk_bf16_f32 v103, v50, v51
 v_mfma_f32_16x16x32_bf16 v[56:59], v[88:91], v[244:247], v[56:59]
 buffer_store_dwordx4 v[100:103], v26, s[24:27], s34 offen sc1
 v_mfma_f32_16x16x32_bf16 v[60:63], v[80:83], v[208:211], v[60:63]
 buffer_load_dwordx4 v9, s[20:23], s101 offen offset:2048 lds
 v_mfma_f32_16x16x32_bf16 v[60:63], v[84:87], v[228:231], v[60:63]
 s_waitcnt vmcnt(13) lgkmcnt(0)
 v_cvt_pk_bf16_f32 v104, v52, v53
 v_cvt_pk_bf16_f32 v105, v54, v55
 v_mfma_f32_16x16x32_bf16 v[60:63], v[88:91], v[248:251], v[60:63]
 s_barrier
 v_mfma_f32_16x16x32_bf16 v[64:67], v[68:71], a[16:19], 0
 s_sub_u32 m0, m0, 61440
 ds_read_b64_tr_b16 v[80:81], v2 offset:12288
 v_add_u32 v9, s49, v12
 v_cvt_pk_bf16_f32 v106, v56, v57
 v_mfma_f32_16x16x32_bf16 v[64:67], v[72:75], a[36:39], v[64:67]
 ds_read_b64_tr_b16 v[82:83], v2 offset:12800
 v_cvt_pk_bf16_f32 v107, v58, v59
 v_mfma_f32_16x16x32_bf16 v[64:67], v[76:79], a[56:59], v[64:67]
 buffer_load_dwordx4 v9, s[20:23], s84 offen lds
 v_mfma_f32_16x16x32_bf16 v[48:51], v[68:71], a[0:3], 0
 ds_read_b64_tr_b16 v[84:85], v2 offset:13312
 v_cvt_pk_bf16_f32 v108, v60, v61
 v_mfma_f32_16x16x32_bf16 v[48:51], v[72:75], a[20:23], v[48:51]
 ds_read_b64_tr_b16 v[86:87], v2 offset:13824
 v_cvt_pk_bf16_f32 v109, v62, v63
 v_mfma_f32_16x16x32_bf16 v[48:51], v[76:79], a[40:43], v[48:51]
 ds_read_b64_tr_b16 v[88:89], v2 offset:14336
 v_mfma_f32_16x16x32_bf16 v[52:55], v[68:71], a[4:7], 0
 ds_read_b64_tr_b16 v[90:91], v2 offset:14848
 v_mfma_f32_16x16x32_bf16 v[52:55], v[72:75], a[24:27], v[52:55]
 buffer_load_dwordx4 v9, s[20:23], s85 offen offset:1024 lds
 v_mfma_f32_16x16x32_bf16 v[52:55], v[76:79], a[44:47], v[52:55]
 buffer_store_dwordx4 v[104:107], v26, s[24:27], s34 offen offset:1024 sc1
 v_mfma_f32_16x16x32_bf16 v[56:59], v[68:71], a[8:11], 0
 buffer_store_dwordx2 v[108:109], v27, s[24:27], s34 offen offset:2048 sc1
 v_mfma_f32_16x16x32_bf16 v[56:59], v[72:75], a[28:31], v[56:59]
 s_add_u32 s34, s34, 81920
 s_cmp_eq_u32 s34, s48
 s_cselect_b32 s34, s50, s34
 v_mfma_f32_16x16x32_bf16 v[56:59], v[76:79], a[48:51], v[56:59]
 v_mfma_f32_16x16x32_bf16 v[60:63], v[68:71], a[12:15], 0
 buffer_load_dwordx4 v9, s[20:23], s86 offen offset:2048 lds
 v_mfma_f32_16x16x32_bf16 v[60:63], v[72:75], a[32:35], v[60:63]
 s_waitcnt vmcnt(15) lgkmcnt(0)
 v_mfma_f32_16x16x32_bf16 v[60:63], v[76:79], a[52:55], v[60:63]
 s_barrier
 v_mfma_f32_16x16x32_bf16 v[64:67], v[80:83], a[76:79], v[64:67]
 s_add_u32 m0, m0, 12288
 ds_read_b64_tr_b16 v[68:69], v2 offset:24576
 v_mfma_f32_16x16x32_bf16 v[64:67], v[84:87], a[96:99], v[64:67]
 ds_read_b64_tr_b16 v[70:71], v2 offset:25088
 v_mfma_f32_16x16x32_bf16 v[64:67], v[88:91], a[116:119], v[64:67]
 buffer_load_dwordx4 v9, s[20:23], s87 offen lds
 v_mfma_f32_16x16x32_bf16 v[48:51], v[80:83], a[60:63], v[48:51]
 ds_read_b64_tr_b16 v[72:73], v2 offset:25600
 v_mfma_f32_16x16x32_bf16 v[48:51], v[84:87], a[80:83], v[48:51]
 ds_read_b64_tr_b16 v[74:75], v2 offset:26112
 v_mfma_f32_16x16x32_bf16 v[48:51], v[88:91], a[100:103], v[48:51]
 ds_read_b64_tr_b16 v[76:77], v2 offset:26624
 v_mfma_f32_16x16x32_bf16 v[52:55], v[80:83], a[64:67], v[52:55]
 ds_read_b64_tr_b16 v[78:79], v2 offset:27136
 v_mfma_f32_16x16x32_bf16 v[52:55], v[84:87], a[84:87], v[52:55]
 buffer_load_dwordx4 v9, s[20:23], s88 offen offset:1024 lds
 v_mfma_f32_16x16x32_bf16 v[52:55], v[88:91], a[104:107], v[52:55]
 v_mfma_f32_16x16x32_bf16 v[56:59], v[80:83], a[68:71], v[56:59]
 s_add_u32 s49, s49, 128
 s_cmp_eq_u32 s49, 1152
 s_cselect_b32 s49, 0, s49
 v_mfma_f32_16x16x32_bf16 v[56:59], v[84:87], a[88:91], v[56:59]
 v_mfma_f32_16x16x32_bf16 v[56:59], v[88:91], a[108:111], v[56:59]
 v_mfma_f32_16x16x32_bf16 v[60:63], v[80:83], a[72:75], v[60:63]
 buffer_load_dwordx4 v9, s[20:23], s89 offen offset:2048 lds
 v_mfma_f32_16x16x32_bf16 v[60:63], v[84:87], a[92:95], v[60:63]
 s_waitcnt vmcnt(15) lgkmcnt(0)
 v_mfma_f32_16x16x32_bf16 v[60:63], v[88:91], a[112:115], v[60:63]
 s_barrier
 v_mfma_f32_16x16x32_bf16 v[64:67], v[68:71], a[136:139], v[64:67]
 s_add_u32 m0, m0, 12288
 ds_read_b64_tr_b16 v[80:81], v3 offset:0
 v_mfma_f32_16x16x32_bf16 v[64:67], v[72:75], a[156:159], v[64:67]
 ds_read_b64_tr_b16 v[82:83], v3 offset:512
 v_mfma_f32_16x16x32_bf16 v[64:67], v[76:79], a[176:179], v[64:67]
 buffer_load_dwordx4 v9, s[20:23], s90 offen lds
 v_mfma_f32_16x16x32_bf16 v[48:51], v[68:71], a[120:123], v[48:51]
 ds_read_b64_tr_b16 v[84:85], v3 offset:1024
 v_mfma_f32_16x16x32_bf16 v[48:51], v[72:75], a[140:143], v[48:51]
 ds_read_b64_tr_b16 v[86:87], v3 offset:1536
 v_mfma_f32_16x16x32_bf16 v[48:51], v[76:79], a[160:163], v[48:51]
 ds_read_b64_tr_b16 v[88:89], v3 offset:2048
 v_mfma_f32_16x16x32_bf16 v[52:55], v[68:71], a[124:127], v[52:55]
 ds_read_b64_tr_b16 v[90:91], v3 offset:2560
 v_mfma_f32_16x16x32_bf16 v[52:55], v[72:75], a[144:147], v[52:55]
 buffer_load_dwordx4 v9, s[20:23], s91 offen offset:1024 lds
 v_mfma_f32_16x16x32_bf16 v[52:55], v[76:79], a[164:167], v[52:55]
 v_mfma_f32_16x16x32_bf16 v[56:59], v[68:71], a[128:131], v[56:59]
 v_mfma_f32_16x16x32_bf16 v[56:59], v[72:75], a[148:151], v[56:59]
 v_mfma_f32_16x16x32_bf16 v[56:59], v[76:79], a[168:171], v[56:59]
 v_mfma_f32_16x16x32_bf16 v[60:63], v[68:71], a[132:135], v[60:63]
 buffer_load_dwordx4 v9, s[20:23], s92 offen offset:2048 lds
 v_mfma_f32_16x16x32_bf16 v[60:63], v[72:75], a[152:155], v[60:63]
 s_waitcnt vmcnt(15) lgkmcnt(0)
 v_mfma_f32_16x16x32_bf16 v[60:63], v[76:79], a[172:175], v[60:63]
 s_barrier
 v_mfma_f32_16x16x32_bf16 v[64:67], v[80:83], a[196:199], v[64:67]
 s_add_u32 m0, m0, 12288
 ds_read_b64_tr_b16 v[68:69], v3 offset:12288
 v_mfma_f32_16x16x32_bf16 v[64:67], v[84:87], a[216:219], v[64:67]
 ds_read_b64_tr_b16 v[70:71], v3 offset:12800
 v_mfma_f32_16x16x32_bf16 v[64:67], v[88:91], a[236:239], v[64:67]
 buffer_load_dwordx4 v9, s[20:23], s93 offen lds
 v_mfma_f32_16x16x32_bf16 v[48:51], v[80:83], a[180:183], v[48:51]
 ds_read_b64_tr_b16 v[72:73], v3 offset:13312
 v_mfma_f32_16x16x32_bf16 v[48:51], v[84:87], a[200:203], v[48:51]
 ds_read_b64_tr_b16 v[74:75], v3 offset:13824
 v_mfma_f32_16x16x32_bf16 v[48:51], v[88:91], a[220:223], v[48:51]
 ds_read_b64_tr_b16 v[76:77], v3 offset:14336
 v_mfma_f32_16x16x32_bf16 v[52:55], v[80:83], a[184:187], v[52:55]
 ds_read_b64_tr_b16 v[78:79], v3 offset:14848
 v_mfma_f32_16x16x32_bf16 v[52:55], v[84:87], a[204:207], v[52:55]
 buffer_load_dwordx4 v9, s[20:23], s94 offen offset:1024 lds
 v_mfma_f32_16x16x32_bf16 v[52:55], v[88:91], a[224:227], v[52:55]
 v_mfma_f32_16x16x32_bf16 v[56:59], v[80:83], a[188:191], v[56:59]
 v_mfma_f32_16x16x32_bf16 v[56:59], v[84:87], a[208:211], v[56:59]
 v_mfma_f32_16x16x32_bf16 v[56:59], v[88:91], a[228:231], v[56:59]
 v_mfma_f32_16x16x32_bf16 v[60:63], v[80:83], a[192:195], v[60:63]
 buffer_load_dwordx4 v9, s[20:23], s95 offen offset:2048 lds
 v_mfma_f32_16x16x32_bf16 v[60:63], v[84:87], a[212:215], v[60:63]
 s_waitcnt vmcnt(14) lgkmcnt(0)
 v_mfma_f32_16x16x32_bf16 v[60:63], v[88:91], a[232:235], v[60:63]
 s_barrier
 v_mfma_f32_16x16x32_bf16 v[64:67], v[68:71], v[152:155], v[64:67]
 s_add_u32 m0, m0, 12288
 ds_read_b64_tr_b16 v[80:81], v3 offset:24576
 v_mfma_f32_16x16x32_bf16 v[64:67], v[72:75], v[172:175], v[64:67]
 ds_read_b64_tr_b16 v[82:83], v3 offset:25088
 v_mfma_f32_16x16x32_bf16 v[64:67], v[76:79], v[192:195], v[64:67]
 buffer_load_dwordx4 v9, s[20:23], s96 offen lds
 v_mfma_f32_16x16x32_bf16 v[48:51], v[68:71], a[240:243], v[48:51]
 ds_read_b64_tr_b16 v[84:85], v3 offset:25600
 v_mfma_f32_16x16x32_bf16 v[48:51], v[72:75], v[156:159], v[48:51]
 ds_read_b64_tr_b16 v[86:87], v3 offset:26112
 v_mfma_f32_16x16x32_bf16 v[48:51], v[76:79], v[176:179], v[48:51]
 ds_read_b64_tr_b16 v[88:89], v3 offset:26624
 v_mfma_f32_16x16x32_bf16 v[52:55], v[68:71], a[244:247], v[52:55]
 ds_read_b64_tr_b16 v[90:91], v3 offset:27136
 v_mfma_f32_16x16x32_bf16 v[52:55], v[72:75], v[160:163], v[52:55]
 buffer_load_dwordx4 v9, s[20:23], s97 offen offset:1024 lds
 v_mfma_f32_16x16x32_bf16 v[52:55], v[76:79], v[180:183], v[52:55]
 v_mfma_f32_16x16x32_bf16 v[56:59], v[68:71], a[248:251], v[56:59]
 v_mfma_f32_16x16x32_bf16 v[56:59], v[72:75], v[164:167], v[56:59]
 v_mfma_f32_16x16x32_bf16 v[56:59], v[76:79], v[184:187], v[56:59]
 v_mfma_f32_16x16x32_bf16 v[60:63], v[68:71], a[252:255], v[60:63]
 buffer_load_dwordx4 v9, s[20:23], s98 offen offset:2048 lds
 v_mfma_f32_16x16x32_bf16 v[60:63], v[72:75], v[168:171], v[60:63]
 s_waitcnt vmcnt(12) lgkmcnt(0)
 v_mfma_f32_16x16x32_bf16 v[60:63], v[76:79], v[188:191], v[60:63]
 s_barrier
 v_mfma_f32_16x16x32_bf16 v[64:67], v[80:83], v[212:215], v[64:67]
 s_add_u32 m0, m0, 12288
 ds_read_b64_tr_b16 v[68:69], v2 offset:0
 v_mfma_f32_16x16x32_bf16 v[64:67], v[84:87], v[232:235], v[64:67]
 ds_read_b64_tr_b16 v[70:71], v2 offset:512
 v_mfma_f32_16x16x32_bf16 v[64:67], v[88:91], v[252:255], v[64:67]
 buffer_load_dwordx4 v9, s[20:23], s99 offen lds
 v_mfma_f32_16x16x32_bf16 v[48:51], v[80:83], v[196:199], v[48:51]
 ds_read_b64_tr_b16 v[72:73], v2 offset:1024
 v_mfma_f32_16x16x32_bf16 v[48:51], v[84:87], v[216:219], v[48:51]
 ds_read_b64_tr_b16 v[74:75], v2 offset:1536
 v_mfma_f32_16x16x32_bf16 v[48:51], v[88:91], v[236:239], v[48:51]
 ds_read_b64_tr_b16 v[76:77], v2 offset:2048
 v_mfma_f32_16x16x32_bf16 v[52:55], v[80:83], v[200:203], v[52:55]
 ds_read_b64_tr_b16 v[78:79], v2 offset:2560
 v_mfma_f32_16x16x32_bf16 v[52:55], v[84:87], v[220:223], v[52:55]
 buffer_load_dwordx4 v9, s[20:23], s100 offen offset:1024 lds
 v_mfma_f32_16x16x32_bf16 v[52:55], v[88:91], v[240:243], v[52:55]
 s_add_u32 s33, s33, 1
 s_cbranch_scc0 L_p2
 v_mfma_f32_16x16x32_bf16 v[56:59], v[80:83], v[204:207], v[56:59]
 v_cvt_pk_bf16_f32 v100, v64, v65
 v_cvt_pk_bf16_f32 v101, v66, v67
 v_mfma_f32_16x16x32_bf16 v[56:59], v[84:87], v[224:227], v[56:59]
 v_cvt_pk_bf16_f32 v102, v48, v49
 v_cvt_pk_bf16_f32 v103, v50, v51
 v_mfma_f32_16x16x32_bf16 v[56:59], v[88:91], v[244:247], v[56:59]
 buffer_store_dwordx4 v[100:103], v26, s[24:27], s34 offen sc1
 v_mfma_f32_16x16x32_bf16 v[60:63], v[80:83], v[208:211], v[60:63]
 buffer_load_dwordx4 v9, s[20:23], s101 offen offset:2048 lds
 v_mfma_f32_16x16x32_bf16 v[60:63], v[84:87], v[228:231], v[60:63]
 s_waitcnt vmcnt(13) lgkmcnt(0)
 v_cvt_pk_bf16_f32 v104, v52, v53
 v_cvt_pk_bf16_f32 v105, v54, v55
 v_mfma_f32_16x16x32_bf16 v[60:63], v[88:91], v[248:251], v[60:63]
 s_barrier
 v_mfma_f32_16x16x32_bf16 v[64:67], v[68:71], a[16:19], 0
 ds_read_b64_tr_b16 v[80:81], v2 offset:12288
 v_cvt_pk_bf16_f32 v106, v56, v57
 v_cvt_pk_bf16_f32 v107, v58, v59
 v_mfma_f32_16x16x32_bf16 v[64:67], v[72:75], a[36:39], v[64:67]
 ds_read_b64_tr_b16 v[82:83], v2 offset:12800
 v_mfma_f32_16x16x32_bf16 v[64:67], v[76:79], a[56:59], v[64:67]
 s_mul_i32 s31, s40, 25600
 v_mfma_f32_16x16x32_bf16 v[48:51], v[68:71], a[0:3], 0
 ds_read_b64_tr_b16 v[84:85], v2 offset:13312
 v_cvt_pk_bf16_f32 v108, v60, v61
 v_cvt_pk_bf16_f32 v109, v62, v63
 v_mfma_f32_16x16x32_bf16 v[48:51], v[72:75], a[20:23], v[48:51]
 ds_read_b64_tr_b16 v[86:87], v2 offset:13824
 v_mfma_f32_16x16x32_bf16 v[48:51], v[76:79], a[40:43], v[48:51]
 ds_read_b64_tr_b16 v[88:89], v2 offset:14336
 v_mfma_f32_16x16x32_bf16 v[52:55], v[68:71], a[4:7], 0
 ds_read_b64_tr_b16 v[90:91], v2 offset:14848
 v_mfma_f32_16x16x32_bf16 v[52:55], v[72:75], a[24:27], v[52:55]
 s_mul_i32 s35, s28, 6400
 s_add_u32 s31, s31, s35
 v_mfma_f32_16x16x32_bf16 v[52:55], v[76:79], a[44:47], v[52:55]
 v_min_u32 v110, 49, v1
 v_lshlrev_b32 v110, 7, v110
 v_mfma_f32_16x16x32_bf16 v[56:59], v[68:71], a[8:11], 0
 buffer_store_dwordx4 v[104:107], v26, s[24:27], s34 offen offset:1024 sc1
 v_mfma_f32_16x16x32_bf16 v[56:59], v[72:75], a[28:31], v[56:59]
 buffer_store_dwordx2 v[108:109], v27, s[24:27], s34 offen offset:2048 sc1
 v_mfma_f32_16x16x32_bf16 v[56:59], v[76:79], a[48:51], v[56:59]
 s_add_u32 s34, s34, 81920
 s_cmp_eq_u32 s34, s48
 s_cselect_b32 s34, s50, s34
 v_mfma_f32_16x16x32_bf16 v[60:63], v[68:71], a[12:15], 0
 buffer_load_dword v111, v110, s[8:11], s31 offen
 v_mfma_f32_16x16x32_bf16 v[60:63], v[72:75], a[32:35], v[60:63]
 s_waitcnt vmcnt(13) lgkmcnt(0)
 v_mfma_f32_16x16x32_bf16 v[60:63], v[76:79], a[52:55], v[60:63]
 s_barrier
 v_mfma_f32_16x16x32_bf16 v[64:67], v[80:83], a[76:79], v[64:67]
 ds_read_b64_tr_b16 v[68:69], v2 offset:24576
 v_mfma_f32_16x16x32_bf16 v[64:67], v[84:87], a[96:99], v[64:67]
 ds_read_b64_tr_b16 v[70:71], v2 offset:25088
 v_mfma_f32_16x16x32_bf16 v[64:67], v[88:91], a[116:119], v[64:67]
 s_getpc_b64 s[44:45]
 L_pc2:
 s_add_u32 s44, s44, fin_kernel-L_pc2
 s_addc_u32 s45, s45, 0
 v_mfma_f32_16x16x32_bf16 v[48:51], v[80:83], a[60:63], v[48:51]
 ds_read_b64_tr_b16 v[72:73], v2 offset:25600
 v_mfma_f32_16x16x32_bf16 v[48:51], v[84:87], a[80:83], v[48:51]
 ds_read_b64_tr_b16 v[74:75], v2 offset:26112
 v_mfma_f32_16x16x32_bf16 v[48:51], v[88:91], a[100:103], v[48:51]
 ds_read_b64_tr_b16 v[76:77], v2 offset:26624
 v_mfma_f32_16x16x32_bf16 v[52:55], v[80:83], a[64:67], v[52:55]
 ds_read_b64_tr_b16 v[78:79], v2 offset:27136
 v_mfma_f32_16x16x32_bf16 v[52:55], v[84:87], a[84:87], v[52:55]
 s_lshl_b32 s31, s40, 3
 v_mfma_f32_16x16x32_bf16 v[52:55], v[88:91], a[104:107], v[52:55]
 v_lshrrev_b32 v110, 5, v0
 v_add_u32 v110, s31, v110
 v_mfma_f32_16x16x32_bf16 v[56:59], v[80:83], a[68:71], v[56:59]
 v_lshlrev_b32 v110, 7, v110
 v_min_u32 v110, L_allend-fin_kernel-4, v110
 v_mfma_f32_16x16x32_bf16 v[56:59], v[84:87], a[88:91], v[56:59]
 v_mfma_f32_16x16x32_bf16 v[56:59], v[88:91], a[108:111], v[56:59]
 v_mfma_f32_16x16x32_bf16 v[60:63], v[80:83], a[72:75], v[60:63]
 global_load_dword v111, v110, s[44:45]
 v_mfma_f32_16x16x32_bf16 v[60:63], v[84:87], a[92:95], v[60:63]
 s_waitcnt vmcnt(11) lgkmcnt(0)
 v_mfma_f32_16x16x32_bf16 v[60:63], v[88:91], a[112:115], v[60:63]
 s_barrier
 v_mfma_f32_16x16x32_bf16 v[64:67], v[68:71], a[136:139], v[64:67]
 ds_read_b64_tr_b16 v[80:81], v3 offset:0
 v_mfma_f32_16x16x32_bf16 v[64:67], v[72:75], a[156:159], v[64:67]
 ds_read_b64_tr_b16 v[82:83], v3 offset:512
 v_mfma_f32_16x16x32_bf16 v[64:67], v[76:79], a[176:179], v[64:67]
 v_mfma_f32_16x16x32_bf16 v[48:51], v[68:71], a[120:123], v[48:51]
 ds_read_b64_tr_b16 v[84:85], v3 offset:1024
 v_mfma_f32_16x16x32_bf16 v[48:51], v[72:75], a[140:143], v[48:51]
 ds_read_b64_tr_b16 v[86:87], v3 offset:1536
 v_mfma_f32_16x16x32_bf16 v[48:51], v[76:79], a[160:163], v[48:51]
 ds_read_b64_tr_b16 v[88:89], v3 offset:2048
 v_mfma_f32_16x16x32_bf16 v[52:55], v[68:71], a[124:127], v[52:55]
 ds_read_b64_tr_b16 v[90:91], v3 offset:2560
 v_mfma_f32_16x16x32_bf16 v[52:55], v[72:75], a[144:147], v[52:55]
 v_mfma_f32_16x16x32_bf16 v[52:55], v[76:79], a[164:167], v[52:55]
 v_mfma_f32_16x16x32_bf16 v[56:59], v[68:71], a[128:131], v[56:59]
 v_mfma_f32_16x16x32_bf16 v[56:59], v[72:75], a[148:151], v[56:59]
 v_mfma_f32_16x16x32_bf16 v[56:59], v[76:79], a[168:171], v[56:59]
 v_mfma_f32_16x16x32_bf16 v[60:63], v[68:71], a[132:135], v[60:63]
 v_mfma_f32_16x16x32_bf16 v[60:63], v[72:75], a[152:155], v[60:63]
 s_waitcnt vmcnt(8) lgkmcnt(0)
 v_mfma_f32_16x16x32_bf16 v[60:63], v[76:79], a[172:175], v[60:63]
 s_barrier
 v_mfma_f32_16x16x32_bf16 v[64:67], v[80:83], a[196:199], v[64:67]
 ds_read_b64_tr_b16 v[68:69], v3 offset:12288
 v_mfma_f32_16x16x32_bf16 v[64:67], v[84:87], a[216:219], v[64:67]
 ds_read_b64_tr_b16 v[70:71], v3 offset:12800
 v_mfma_f32_16x16x32_bf16 v[64:67], v[88:91], a[236:239], v[64:67]
 v_mfma_f32_16x16x32_bf16 v[48:51], v[80:83], a[180:183], v[48:51]
 ds_read_b64_tr_b16 v[72:73], v3 offset:13312
 v_mfma_f32_16x16x32_bf16 v[48:51], v[84:87], a[200:203], v[48:51]
 ds_read_b64_tr_b16 v[74:75], v3 offset:13824
 v_mfma_f32_16x16x32_bf16 v[48:51], v[88:91], a[220:223], v[48:51]
 ds_read_b64_tr_b16 v[76:77], v3 offset:14336
 v_mfma_f32_16x16x32_bf16 v[52:55], v[80:83], a[184:187], v[52:55]
 ds_read_b64_tr_b16 v[78:79], v3 offset:14848
 v_mfma_f32_16x16x32_bf16 v[52:55], v[84:87], a[204:207], v[52:55]
 v_mfma_f32_16x16x32_bf16 v[52:55], v[88:91], a[224:227], v[52:55]
 v_mfma_f32_16x16x32_bf16 v[56:59], v[80:83], a[188:191], v[56:59]
 v_mfma_f32_16x16x32_bf16 v[56:59], v[84:87], a[208:211], v[56:59]
 v_mfma_f32_16x16x32_bf16 v[56:59], v[88:91], a[228:231], v[56:59]
 v_mfma_f32_16x16x32_bf16 v[60:63], v[80:83], a[192:195], v[60:63]
 v_mfma_f32_16x16x32_bf16 v[60:63], v[84:87], a[212:215], v[60:63]
 s_waitcnt vmcnt(4) lgkmcnt(0)
 v_mfma_f32_16x16x32_bf16 v[60:63], v[88:91], a[232:235], v[60:63]
 s_barrier
 v_mfma_f32_16x16x32_bf16 v[64:67], v[68:71], v[152:155], v[64:67]
 ds_read_b64_tr_b16 v[80:81], v3 offset:24576
 v_mfma_f32_16x16x32_bf16 v[64:67], v[72:75], v[172:175], v[64:67]
 ds_read_b64_tr_b16 v[82:83], v3 offset:25088
 v_mfma_f32_16x16x32_bf16 v[64:67], v[76:79], v[192:195], v[64:67]
 v_mfma_f32_16x16x32_bf16 v[48:51], v[68:71], a[240:243], v[48:51]
 ds_read_b64_tr_b16 v[84:85], v3 offset:25600
 v_mfma_f32_16x16x32_bf16 v[48:51], v[72:75], v[156:159], v[48:51]
 ds_read_b64_tr_b16 v[86:87], v3 offset:26112
 v_mfma_f32_16x16x32_bf16 v[48:51], v[76:79], v[176:179], v[48:51]
 ds_read_b64_tr_b16 v[88:89], v3 offset:26624
 v_mfma_f32_16x16x32_bf16 v[52:55], v[68:71], a[244:247], v[52:55]
 ds_read_b64_tr_b16 v[90:91], v3 offset:27136
 v_mfma_f32_16x16x32_bf16 v[52:55], v[72:75], v[160:163], v[52:55]
 v_mfma_f32_16x16x32_bf16 v[52:55], v[76:79], v[180:183], v[52:55]
 v_mfma_f32_16x16x32_bf16 v[56:59], v[68:71], a[248:251], v[56:59]
 v_mfma_f32_16x16x32_bf16 v[56:59], v[72:75], v[164:167], v[56:59]
 v_mfma_f32_16x16x32_bf16 v[56:59], v[76:79], v[184:187], v[56:59]
 v_mfma_f32_16x16x32_bf16 v[60:63], v[68:71], a[252:255], v[60:63]
 v_mfma_f32_16x16x32_bf16 v[60:63], v[72:75], v[168:171], v[60:63]
 s_waitcnt lgkmcnt(0)
 v_mfma_f32_16x16x32_bf16 v[60:63], v[76:79], v[188:191], v[60:63]
 s_barrier
 v_mfma_f32_16x16x32_bf16 v[64:67], v[80:83], v[212:215], v[64:67]
 v_mfma_f32_16x16x32_bf16 v[64:67], v[84:87], v[232:235], v[64:67]
 v_mfma_f32_16x16x32_bf16 v[64:67], v[88:91], v[252:255], v[64:67]
 v_mfma_f32_16x16x32_bf16 v[48:51], v[80:83], v[196:199], v[48:51]
 v_mfma_f32_16x16x32_bf16 v[48:51], v[84:87], v[216:219], v[48:51]
 v_mfma_f32_16x16x32_bf16 v[48:51], v[88:91], v[236:239], v[48:51]
 v_mfma_f32_16x16x32_bf16 v[52:55], v[80:83], v[200:203], v[52:55]
 v_mfma_f32_16x16x32_bf16 v[52:55], v[84:87], v[220:223], v[52:55]
 v_mfma_f32_16x16x32_bf16 v[52:55], v[88:91], v[240:243], v[52:55]
 v_mfma_f32_16x16x32_bf16 v[56:59], v[80:83], v[204:207], v[56:59]
 v_mfma_f32_16x16x32_bf16 v[56:59], v[84:87], v[224:227], v[56:59]
 v_mfma_f32_16x16x32_bf16 v[56:59], v[88:91], v[244:247], v[56:59]
 v_mfma_f32_16x16x32_bf16 v[60:63], v[80:83], v[208:211], v[60:63]
 v_mfma_f32_16x16x32_bf16 v[60:63], v[84:87], v[228:231], v[60:63]
 v_mfma_f32_16x16x32_bf16 v[60:63], v[88:91], v[248:251], v[60:63]
 v_cvt_pk_bf16_f32 v100, v64, v65
 v_cvt_pk_bf16_f32 v101, v66, v67
 v_cvt_pk_bf16_f32 v102, v48, v49
 v_cvt_pk_bf16_f32 v103, v50, v51
 buffer_store_dwordx4 v[100:103], v26, s[24:27], s34 offen
 v_cvt_pk_bf16_f32 v104, v52, v53
 v_cvt_pk_bf16_f32 v105, v54, v55
 v_cvt_pk_bf16_f32 v106, v56, v57
 v_cvt_pk_bf16_f32 v107, v58, v59
 buffer_store_dwordx4 v[104:107], v26, s[24:27], s34 offen offset:1024
 v_cvt_pk_bf16_f32 v108, v60, v61
 v_cvt_pk_bf16_f32 v109, v62, v63
 buffer_store_dwordx2 v[108:109], v27, s[24:27], s34 offen offset:2048
 s_endpgm
L_qkv2:
 s_mov_b32 s16, s6
 s_and_b32 s17, s7, 0xffff
 s_mov_b32 s18, 1990656
 s_mov_b32 s19, 0x20000
 s_mov_b32 s8, s24
 s_and_b32 s9, s25, 0xffff
 s_mov_b32 s10, 663552
 s_mov_b32 s11, 0x20000
 s_add_u32 s24, s36, 33554432
 s_addc_u32 s25, s37, 0
 s_and_b32 s25, s25, 0xffff
 s_mov_b32 s26, 2359296
 s_mov_b32 s27, 0x20000
 s_and_b32 s31, s52, 1
 s_lshl_b32 s31, s31, 10
 s_mul_i32 s86, s29, 88
 s_add_u32 s31, s31, s86
 s_lshl_b32 s52, s31, 4
 s_add_u32 s84, s52, 32768
 s_lshl_b32 s31, s31, 2
 s_add_u32 s85, s31, 2097152
 s_sub_u32 s86, 1024, s86
 s_and_b32 s31, s28, 1
 s_lshl_b32 s31, s31, 1
 v_bfe_u32 v13, v1, 4, 1
 v_or_b32 v13, s31, v13
 v_bfe_u32 v14, v1, 1, 2
 v_xor_b32 v13, v13, v14
 v_lshlrev_b32 v13, 5, v13
 v_and_b32 v14, 1, v1
 v_lshl_add_u32 v7, v14, 4, v13
 v_lshrrev_b32 v8, 6, v7
 s_lshl_b32 s31, s28, 3
 v_lshrrev_b32 v13, 3, v1
 v_add_u32 v13, s31, v13
 s_mov_b32 s31, 3456
 v_mul_lo_u32 v13, v13, s31
 v_add_u32 v7, v13, v7
 v_mov_b32 v4, v7
 v_add_u32 v5, 109568, v7
 v_add_u32 v6, 219136, v7
 s_lshl_b32 s32, s30, 10
 s_mul_i32 s89, s28, 3072
 s_mul_i32 s55, s30, 31
 s_and_b32 s31, s55, 15
 v_lshlrev_b32 v100, 1, v0
 v_subrev_u32 v100, 32, v100
 v_and_b32 v101, 0x1ff, v100
 v_mul_u32_u24 v102, 57, v101
 v_lshrrev_b32 v102, 10, v102
 v_mul_u32_u24 v103, 18, v102
 v_sub_u32 v101, v101, v103
 v_xor_b32 v102, s31, v102
 v_mul_u32_u24 v103, 37, v102
 v_lshrrev_b32 v103, 8, v103
 v_mul_u32_u24 v103, 7, v103
 v_sub_u32 v102, v102, v103
 v_mul_u32_u24 v102, 40, v102
 v_lshl_add_u32 v101, v101, 1, v102
 v_cmp_gt_u32 vcc, 288, v100
 v_lshlrev_b32 v100, 2, v0
 v_add_u32 v100, 159744, v100
 v_cndmask_b32 v101, 36, v101, vcc
 ds_write_b32 v100, v101
 v_mul_u32_u24 v100, 11, v1
 v_lshrrev_b32 v100, 5, v100
 v_mul_u32_u24 v101, 3, v100
 v_sub_u32 v101, v1, v101
 v_sub_u32 v102, 8, v100
 s_cmp_eq_u32 s30, 0
 s_cselect_b64 vcc, 0, -1
 v_cndmask_b32 v100, v100, v102, vcc
 v_mul_u32_u24 v12, 1152, v101
 v_lshl_add_u32 v12, v100, 7, v12
 s_mul_i32 s31, s30, 576
 s_lshl_b32 s35, s28, 5
 s_sub_u32 s35, s35, s31
 s_add_u32 s35, s35, 64
 v_lshlrev_b32 v100, 7, v100
 v_add_u32 v100, s35, v100
 v_mul_u32_u24 v101, 26880, v101
 v_lshl_add_u32 v9, v101, 16, v100
 s_add_u32 s45, s35, 3523215872
 v_writelane_b32 v9, s45, 13
 s_mov_b32 s45, 2816
 v_writelane_b32 v12, s45, 13
 s_lshl_b32 s45, s30, 6
 s_add_u32 s45, s45, 71303680
 v_writelane_b32 v12, s45, 12
 s_lshl_b32 s45, s30, 9
 s_sub_u32 s45, 576, s45
 s_lshl_b32 s43, s40, 5
 s_add_u32 s45, s45, s43
 s_mul_i32 s43, s41, 1761607680
 s_add_u32 s45, s45, s43
 v_writelane_b32 v9, s45, 12
 v_bfe_u32 v13, v1, 3, 2
 v_xor_b32 v13, s28, v13
 v_lshlrev_b32 v13, 5, v13
 v_lshrrev_b32 v14, 4, v1
 v_mul_u32_u24 v14, 3072, v14
 v_add_u32 v13, v13, v14
 v_bfe_u32 v14, v1, 2, 2
 v_lshl_add_u32 v13, v14, 7, v13
 v_and_b32 v14, 3, v1
 v_lshl_add_u32 v2, v14, 3, v13
 v_bfe_u32 v13, v1, 3, 1
 v_mul_u32_u24 v13, 3, v13
 v_lshrrev_b32 v14, 4, v1
 v_xor_b32 v13, v13, v14
 v_lshlrev_b32 v13, 4, v13
 v_and_b32 v14, 15, v1
 v_lshl_add_u32 v3, v14, 6, v13
 v_add_u32 v3, 49152, v3
 v_add_u32 v24, 18432, v3
 v_add_u32 v25, 61440, v24
 v_and_b32 v13, 15, v1
 v_mul_u32_u24 v16, 280, v13
 v_add_u32 v16, 67584, v16
 v_lshrrev_b32 v13, 4, v1
 v_lshlrev_b32 v13, 3, v13
 v_add_u32 v17, 159744, v13
 s_lshl_b32 s31, s28, 10
 s_add_u32 s31, s31, 67584
 v_bfe_u32 v13, v1, 2, 1
 v_mul_u32_u24 v13, 5120, v13
 v_lshrrev_b32 v14, 3, v1
 v_lshl_add_u32 v13, v14, 6, v13
 v_and_b32 v14, 3, v1
 v_lshl_add_u32 v13, v14, 4, v13
 v_add_u32 v20, s31, v13
 v_add_u32 v21, 61440, v20
 s_movk_i32 s42, 1024
 s_mov_b32 s43, 49152
 s_cmp_eq_u32 s40, 0
 s_cselect_b32 s42, 5120, s42
 s_cselect_b32 s43, 71680, s43
 s_lshl_b32 s45, s41, 9
 s_add_u32 s43, s43, s45
 v_bfe_u32 v13, v1, 2, 1
 v_mul_lo_u32 v13, v13, s42
 v_lshrrev_b32 v14, 3, v1
 v_lshl_add_u32 v13, v14, 6, v13
 v_and_b32 v14, 3, v1
 v_lshl_add_u32 v13, v14, 4, v13
 v_add_u32 v19, s43, v13
 s_lshl_b32 s42, s42, 1
 s_mov_b32 s4, 0x3ae38e39
 s_mov_b32 s5, 0x3f803f80
 buffer_load_dwordx4 v[188:191], v15, s[12:15], 0 offen offset:128
 s_waitcnt vmcnt(10)
 v_dot2_f32_bf16 v28, v148, v148, 0
 v_dot2_f32_bf16 v32, v148, s5, 0
 v_dot2_f32_bf16 v29, v149, v149, 0
 v_dot2_f32_bf16 v33, v149, s5, 0
 v_dot2_f32_bf16 v30, v150, v150, 0
 v_dot2_f32_bf16 v34, v150, s5, 0
 v_dot2_f32_bf16 v31, v151, v151, 0
 v_dot2_f32_bf16 v35, v151, s5, 0
 buffer_load_dwordx4 v[192:195], v15, s[12:15], 0 offen offset:256
 s_waitcnt vmcnt(10)
 v_dot2_f32_bf16 v28, v152, v152, v28
 v_dot2_f32_bf16 v32, v152, s5, v32
 v_dot2_f32_bf16 v29, v153, v153, v29
 v_dot2_f32_bf16 v33, v153, s5, v33
 v_dot2_f32_bf16 v30, v154, v154, v30
 v_dot2_f32_bf16 v34, v154, s5, v34
 v_dot2_f32_bf16 v31, v155, v155, v31
 v_dot2_f32_bf16 v35, v155, s5, v35
 buffer_load_dwordx4 v[196:199], v15, s[12:15], 0 offen offset:384
 s_waitcnt vmcnt(10)
 v_dot2_f32_bf16 v28, v156, v156, v28
 v_dot2_f32_bf16 v32, v156, s5, v32
 v_dot2_f32_bf16 v29, v157, v157, v29
 v_dot2_f32_bf16 v33, v157, s5, v33
 v_dot2_f32_bf16 v30, v158, v158, v30
 v_dot2_f32_bf16 v34, v158, s5, v34
 v_dot2_f32_bf16 v31, v159, v159, v31
 v_dot2_f32_bf16 v35, v159, s5, v35
 buffer_load_dwordx4 v[200:203], v15, s[12:15], 0 offen offset:512
 s_waitcnt vmcnt(10)
 v_dot2_f32_bf16 v28, v160, v160, v28
 v_dot2_f32_bf16 v32, v160, s5, v32
 v_dot2_f32_bf16 v29, v161, v161, v29
 v_dot2_f32_bf16 v33, v161, s5, v33
 v_dot2_f32_bf16 v30, v162, v162, v30
 v_dot2_f32_bf16 v34, v162, s5, v34
 v_dot2_f32_bf16 v31, v163, v163, v31
 v_dot2_f32_bf16 v35, v163, s5, v35
 buffer_load_dwordx4 v[204:207], v15, s[12:15], 0 offen offset:640
 s_waitcnt vmcnt(10)
 v_dot2_f32_bf16 v28, v164, v164, v28
 v_dot2_f32_bf16 v32, v164, s5, v32
 v_dot2_f32_bf16 v29, v165, v165, v29
 v_dot2_f32_bf16 v33, v165, s5, v33
 v_dot2_f32_bf16 v30, v166, v166, v30
 v_dot2_f32_bf16 v34, v166, s5, v34
 v_dot2_f32_bf16 v31, v167, v167, v31
 v_dot2_f32_bf16 v35, v167, s5, v35
 buffer_load_dwordx4 v[208:211], v15, s[12:15], 0 offen offset:768
 s_waitcnt vmcnt(10)
 v_dot2_f32_bf16 v28, v168, v168, v28
 v_dot2_f32_bf16 v32, v168, s5, v32
 v_dot2_f32_bf16 v29, v169, v169, v29
 v_dot2_f32_bf16 v33, v169, s5, v33
 v_dot2_f32_bf16 v30, v170, v170, v30
 v_dot2_f32_bf16 v34, v170, s5, v34
 v_dot2_f32_bf16 v31, v171, v171, v31
 v_dot2_f32_bf16 v35, v171, s5, v35
 buffer_load_dwordx4 v[212:215], v15, s[12:15], 0 offen offset:896
 s_waitcnt vmcnt(10)
 v_dot2_f32_bf16 v28, v172, v172, v28
 v_dot2_f32_bf16 v32, v172, s5, v32
 v_dot2_f32_bf16 v29, v173, v173, v29
 v_dot2_f32_bf16 v33, v173, s5, v33
 v_dot2_f32_bf16 v30, v174, v174, v30
 v_dot2_f32_bf16 v34, v174, s5, v34
 v_dot2_f32_bf16 v31, v175, v175, v31
 v_dot2_f32_bf16 v35, v175, s5, v35
 buffer_load_dwordx4 v[216:219], v15, s[12:15], 0 offen offset:1024
 s_waitcnt vmcnt(10)
 v_dot2_f32_bf16 v28, v176, v176, v28
 v_dot2_f32_bf16 v32, v176, s5, v32
 v_dot2_f32_bf16 v29, v177, v177, v29
 v_dot2_f32_bf16 v33, v177, s5, v33
 v_dot2_f32_bf16 v30, v178, v178, v30
 v_dot2_f32_bf16 v34, v178, s5, v34
 v_dot2_f32_bf16 v31, v179, v179, v31
 v_dot2_f32_bf16 v35, v179, s5, v35
 buffer_load_dwordx4 v[220:223], v22, s[12:15], s94 offen offset:0
 s_waitcnt vmcnt(10)
 v_dot2_f32_bf16 v28, v180, v180, v28
 v_dot2_f32_bf16 v32, v180, s5, v32
 v_dot2_f32_bf16 v29, v181, v181, v29
 v_dot2_f32_bf16 v33, v181, s5, v33
 v_dot2_f32_bf16 v30, v182, v182, v30
 v_dot2_f32_bf16 v34, v182, s5, v34
 v_dot2_f32_bf16 v31, v183, v183, v31
 v_dot2_f32_bf16 v35, v183, s5, v35
 buffer_load_dwordx4 v[224:227], v22, s[12:15], s94 offen offset:128
 v_add_f32 v28, v28, v29
 v_add_f32 v30, v30, v31
 v_add_f32 v32, v32, v33
 v_add_f32 v34, v34, v35
 v_add_f32 v28, v28, v30
 v_add_f32 v32, v32, v34
 s_nop 0
 v_add_f32_dpp v28, v28, v28 quad_perm:[1,0,3,2] row_mask:0xf bank_mask:0xf
 v_add_f32_dpp v32, v32, v32 quad_perm:[1,0,3,2] row_mask:0xf bank_mask:0xf
 s_nop 0
 v_add_f32_dpp v28, v28, v28 quad_perm:[2,3,0,1] row_mask:0xf bank_mask:0xf
 v_add_f32_dpp v32, v32, v32 quad_perm:[2,3,0,1] row_mask:0xf bank_mask:0xf
 s_nop 0
 v_add_f32_dpp v28, v28, v28 row_half_mirror row_mask:0xf bank_mask:0xf
 v_add_f32_dpp v32, v32, v32 row_half_mirror row_mask:0xf bank_mask:0xf
 v_mul_f32 v32, s4, v32
 v_mul_f32 v28, s4, v28
 v_fma_f32 v28, -v32, v32, v28
 v_max_f32 v28, 0, v28
 v_add_f32 v28, 0x3727c5ac, v28
 v_rsq_f32 v36, v28
 s_nop 0
 v_mul_f32 v38, -v36, v32
 v_lshlrev_b32 v104, 16, v148
 v_and_b32 v105, 0xffff0000, v148
 s_waitcnt vmcnt(10)
 v_dot2_f32_bf16 v40, v184, v184, 0
 v_dot2_f32_bf16 v44, v184, s5, 0
 v_dot2_f32_bf16 v41, v185, v185, 0
 v_dot2_f32_bf16 v45, v185, s5, 0
 v_dot2_f32_bf16 v42, v186, v186, 0
 v_dot2_f32_bf16 v46, v186, s5, 0
 v_dot2_f32_bf16 v43, v187, v187, 0
 v_dot2_f32_bf16 v47, v187, s5, 0
 buffer_load_dwordx4 v[228:231], v22, s[12:15], s94 offen offset:256
 v_lshlrev_b32 v106, 16, v149
 v_and_b32 v107, 0xffff0000, v149
 v_lshlrev_b32 v108, 16, v150
 v_and_b32 v109, 0xffff0000, v150
 v_lshlrev_b32 v110, 16, v151
 v_and_b32 v111, 0xffff0000, v151
 v_pk_fma_f32 v[104:105], v[104:105], v[36:37], v[38:39] op_sel_hi:[1,0,0]
 v_pk_fma_f32 v[106:107], v[106:107], v[36:37], v[38:39] op_sel_hi:[1,0,0]
 v_pk_fma_f32 v[108:109], v[108:109], v[36:37], v[38:39] op_sel_hi:[1,0,0]
 v_pk_fma_f32 v[110:111], v[110:111], v[36:37], v[38:39] op_sel_hi:[1,0,0]
 v_cvt_pk_bf16_f32 v148, v104, v105
 v_cvt_pk_bf16_f32 v149, v106, v107
 v_cvt_pk_bf16_f32 v150, v108, v109
 v_cvt_pk_bf16_f32 v151, v110, v111
 ds_write_b128 v19, v[148:151]
 v_add_u32 v19, s42, v19
 v_lshlrev_b32 v104, 16, v152
 v_and_b32 v105, 0xffff0000, v152
 v_lshlrev_b32 v106, 16, v153
 v_and_b32 v107, 0xffff0000, v153
 v_lshlrev_b32 v108, 16, v154
 s_waitcnt vmcnt(10)
 v_dot2_f32_bf16 v40, v188, v188, v40
 v_dot2_f32_bf16 v44, v188, s5, v44
 v_dot2_f32_bf16 v41, v189, v189, v41
 v_dot2_f32_bf16 v45, v189, s5, v45
 v_dot2_f32_bf16 v42, v190, v190, v42
 v_dot2_f32_bf16 v46, v190, s5, v46
 v_dot2_f32_bf16 v43, v191, v191, v43
 v_dot2_f32_bf16 v47, v191, s5, v47
 buffer_load_dwordx4 v[232:235], v22, s[12:15], s94 offen offset:384
 v_and_b32 v109, 0xffff0000, v154
 v_lshlrev_b32 v110, 16, v155
 v_and_b32 v111, 0xffff0000, v155
 v_pk_fma_f32 v[104:105], v[104:105], v[36:37], v[38:39] op_sel_hi:[1,0,0]
 v_pk_fma_f32 v[106:107], v[106:107], v[36:37], v[38:39] op_sel_hi:[1,0,0]
 v_pk_fma_f32 v[108:109], v[108:109], v[36:37], v[38:39] op_sel_hi:[1,0,0]
 v_pk_fma_f32 v[110:111], v[110:111], v[36:37], v[38:39] op_sel_hi:[1,0,0]
 v_cvt_pk_bf16_f32 v152, v104, v105
 v_cvt_pk_bf16_f32 v153, v106, v107
 v_cvt_pk_bf16_f32 v154, v108, v109
 v_cvt_pk_bf16_f32 v155, v110, v111
 ds_write_b128 v19, v[152:155]
 v_add_u32 v19, s42, v19
 v_lshlrev_b32 v104, 16, v156
 v_and_b32 v105, 0xffff0000, v156
 v_lshlrev_b32 v106, 16, v157
 v_and_b32 v107, 0xffff0000, v157
 v_lshlrev_b32 v108, 16, v158
 v_and_b32 v109, 0xffff0000, v158
 v_lshlrev_b32 v110, 16, v159
 v_and_b32 v111, 0xffff0000, v159
 s_waitcnt vmcnt(10)
 v_dot2_f32_bf16 v40, v192, v192, v40
 v_dot2_f32_bf16 v44, v192, s5, v44
 v_dot2_f32_bf16 v41, v193, v193, v41
 v_dot2_f32_bf16 v45, v193, s5, v45
 v_dot2_f32_bf16 v42, v194, v194, v42
 v_dot2_f32_bf16 v46, v194, s5, v46
 v_dot2_f32_bf16 v43, v195, v195, v43
 v_dot2_f32_bf16 v47, v195, s5, v47
 buffer_load_dwordx4 v[236:239], v22, s[12:15], s94 offen offset:512
 v_pk_fma_f32 v[104:105], v[104:105], v[36:37], v[38:39] op_sel_hi:[1,0,0]
 v_pk_fma_f32 v[106:107], v[106:107], v[36:37], v[38:39] op_sel_hi:[1,0,0]
 v_pk_fma_f32 v[108:109], v[108:109], v[36:37], v[38:39] op_sel_hi:[1,0,0]
 v_pk_fma_f32 v[110:111], v[110:111], v[36:37], v[38:39] op_sel_hi:[1,0,0]
 v_cvt_pk_bf16_f32 v156, v104, v105
 v_cvt_pk_bf16_f32 v157, v106, v107
 v_cvt_pk_bf16_f32 v158, v108, v109
 v_cvt_pk_bf16_f32 v159, v110, v111
 ds_write_b128 v19, v[156:159]
 v_add_u32 v19, s42, v19
 v_lshlrev_b32 v104, 16, v160
 v_and_b32 v105, 0xffff0000, v160
 v_lshlrev_b32 v106, 16, v161
 v_and_b32 v107, 0xffff0000, v161
 v_lshlrev_b32 v108, 16, v162
 v_and_b32 v109, 0xffff0000, v162
 v_lshlrev_b32 v110, 16, v163
 v_and_b32 v111, 0xffff0000, v163
 v_pk_fma_f32 v[104:105], v[104:105], v[36:37], v[38:39] op_sel_hi:[1,0,0]
 v_pk_fma_f32 v[106:107], v[106:107], v[36:37], v[38:39] op_sel_hi:[1,0,0]
 v_pk_fma_f32 v[108:109], v[108:109], v[36:37], v[38:39] op_sel_hi:[1,0,0]
 s_waitcnt vmcnt(10)
 v_dot2_f32_bf16 v40, v196, v196, v40
 v_dot2_f32_bf16 v44, v196, s5, v44
 v_dot2_f32_bf16 v41, v197, v197, v41
 v_dot2_f32_bf16 v45, v197, s5, v45
 v_dot2_f32_bf16 v42, v198, v198, v42
 v_dot2_f32_bf16 v46, v198, s5, v46
 v_dot2_f32_bf16 v43, v199, v199, v43
 v_dot2_f32_bf16 v47, v199, s5, v47
 buffer_load_dwordx4 v[240:243], v22, s[12:15], s94 offen offset:640
 v_pk_fma_f32 v[110:111], v[110:111], v[36:37], v[38:39] op_sel_hi:[1,0,0]
 v_cvt_pk_bf16_f32 v160, v104, v105
 v_cvt_pk_bf16_f32 v161, v106, v107
 v_cvt_pk_bf16_f32 v162, v108, v109
 v_cvt_pk_bf16_f32 v163, v110, v111
 ds_write_b128 v19, v[160:163]
 v_add_u32 v19, s42, v19
 v_lshlrev_b32 v104, 16, v164
 v_and_b32 v105, 0xffff0000, v164
 v_lshlrev_b32 v106, 16, v165
 v_and_b32 v107, 0xffff0000, v165
 v_lshlrev_b32 v108, 16, v166
 v_and_b32 v109, 0xffff0000, v166
 v_lshlrev_b32 v110, 16, v167
 v_and_b32 v111, 0xffff0000, v167
 v_pk_fma_f32 v[104:105], v[104:105], v[36:37], v[38:39] op_sel_hi:[1,0,0]
 v_pk_fma_f32 v[106:107], v[106:107], v[36:37], v[38:39] op_sel_hi:[1,0,0]
 v_pk_fma_f32 v[108:109], v[108:109], v[36:37], v[38:39] op_sel_hi:[1,0,0]
 v_pk_fma_f32 v[110:111], v[110:111], v[36:37], v[38:39] op_sel_hi:[1,0,0]
 v_cvt_pk_bf16_f32 v164, v104, v105
 v_cvt_pk_bf16_f32 v165, v106, v107
 s_waitcnt vmcnt(10)
 v_dot2_f32_bf16 v40, v200, v200, v40
 v_dot2_f32_bf16 v44, v200, s5, v44
 v_dot2_f32_bf16 v41, v201, v201, v41
 v_dot2_f32_bf16 v45, v201, s5, v45
 v_dot2_f32_bf16 v42, v202, v202, v42
 v_dot2_f32_bf16 v46, v202, s5, v46
 v_dot2_f32_bf16 v43, v203, v203, v43
 v_dot2_f32_bf16 v47, v203, s5, v47
 buffer_load_dwordx4 v[244:247], v22, s[12:15], s94 offen offset:768
 v_cvt_pk_bf16_f32 v166, v108, v109
 v_cvt_pk_bf16_f32 v167, v110, v111
 ds_write_b128 v19, v[164:167]
 v_add_u32 v19, s42, v19
 v_lshlrev_b32 v104, 16, v168
 v_and_b32 v105, 0xffff0000, v168
 v_lshlrev_b32 v106, 16, v169
 v_and_b32 v107, 0xffff0000, v169
 v_lshlrev_b32 v108, 16, v170
 v_and_b32 v109, 0xffff0000, v170
 v_lshlrev_b32 v110, 16, v171
 v_and_b32 v111, 0xffff0000, v171
 v_pk_fma_f32 v[104:105], v[104:105], v[36:37], v[38:39] op_sel_hi:[1,0,0]
 v_pk_fma_f32 v[106:107], v[106:107], v[36:37], v[38:39] op_sel_hi:[1,0,0]
 v_pk_fma_f32 v[108:109], v[108:109], v[36:37], v[38:39] op_sel_hi:[1,0,0]
 v_pk_fma_f32 v[110:111], v[110:111], v[36:37], v[38:39] op_sel_hi:[1,0,0]
 v_cvt_pk_bf16_f32 v168, v104, v105
 v_cvt_pk_bf16_f32 v169, v106, v107
 v_cvt_pk_bf16_f32 v170, v108, v109
 v_cvt_pk_bf16_f32 v171, v110, v111
 ds_write_b128 v19, v[168:171]
 s_waitcnt vmcnt(10)
 v_dot2_f32_bf16 v40, v204, v204, v40
 v_dot2_f32_bf16 v44, v204, s5, v44
 v_dot2_f32_bf16 v41, v205, v205, v41
 v_dot2_f32_bf16 v45, v205, s5, v45
 v_dot2_f32_bf16 v42, v206, v206, v42
 v_dot2_f32_bf16 v46, v206, s5, v46
 v_dot2_f32_bf16 v43, v207, v207, v43
 v_dot2_f32_bf16 v47, v207, s5, v47
 buffer_load_dwordx4 v[248:251], v22, s[12:15], s94 offen offset:896
 v_add_u32 v19, s42, v19
 v_lshlrev_b32 v104, 16, v172
 v_and_b32 v105, 0xffff0000, v172
 v_lshlrev_b32 v106, 16, v173
 v_and_b32 v107, 0xffff0000, v173
 v_lshlrev_b32 v108, 16, v174
 v_and_b32 v109, 0xffff0000, v174
 v_lshlrev_b32 v110, 16, v175
 v_and_b32 v111, 0xffff0000, v175
 v_pk_fma_f32 v[104:105], v[104:105], v[36:37], v[38:39] op_sel_hi:[1,0,0]
 v_pk_fma_f32 v[106:107], v[106:107], v[36:37], v[38:39] op_sel_hi:[1,0,0]
 v_pk_fma_f32 v[108:109], v[108:109], v[36:37], v[38:39] op_sel_hi:[1,0,0]
 v_pk_fma_f32 v[110:111], v[110:111], v[36:37], v[38:39] op_sel_hi:[1,0,0]
 v_cvt_pk_bf16_f32 v172, v104, v105
 v_cvt_pk_bf16_f32 v173, v106, v107
 v_cvt_pk_bf16_f32 v174, v108, v109
 v_cvt_pk_bf16_f32 v175, v110, v111
 ds_write_b128 v19, v[172:175]
 v_add_u32 v19, s42, v19
 v_lshlrev_b32 v104, 16, v176
 v_and_b32 v105, 0xffff0000, v176
 s_waitcnt vmcnt(10)
 v_dot2_f32_bf16 v40, v208, v208, v40
 v_dot2_f32_bf16 v44, v208, s5, v44
 v_dot2_f32_bf16 v41, v209, v209, v41
 v_dot2_f32_bf16 v45, v209, s5, v45
 v_dot2_f32_bf16 v42, v210, v210, v42
 v_dot2_f32_bf16 v46, v210, s5, v46
 v_dot2_f32_bf16 v43, v211, v211, v43
 v_dot2_f32_bf16 v47, v211, s5, v47
 buffer_load_dwordx4 v[252:255], v22, s[12:15], s94 offen offset:1024
 v_lshlrev_b32 v106, 16, v177
 v_and_b32 v107, 0xffff0000, v177
 v_lshlrev_b32 v108, 16, v178
 v_and_b32 v109, 0xffff0000, v178
 v_lshlrev_b32 v110, 16, v179
 v_and_b32 v111, 0xffff0000, v179
 v_pk_fma_f32 v[104:105], v[104:105], v[36:37], v[38:39] op_sel_hi:[1,0,0]
 v_pk_fma_f32 v[106:107], v[106:107], v[36:37], v[38:39] op_sel_hi:[1,0,0]
 v_pk_fma_f32 v[108:109], v[108:109], v[36:37], v[38:39] op_sel_hi:[1,0,0]
 v_pk_fma_f32 v[110:111], v[110:111], v[36:37], v[38:39] op_sel_hi:[1,0,0]
 v_cvt_pk_bf16_f32 v176, v104, v105
 v_cvt_pk_bf16_f32 v177, v106, v107
 v_cvt_pk_bf16_f32 v178, v108, v109
 v_cvt_pk_bf16_f32 v179, v110, v111
 ds_write_b128 v19, v[176:179]
 v_add_u32 v19, s42, v19
 v_lshlrev_b32 v104, 16, v180
 v_and_b32 v105, 0xffff0000, v180
 v_lshlrev_b32 v106, 16, v181
 v_and_b32 v107, 0xffff0000, v181
 v_lshlrev_b32 v108, 16, v182
 s_waitcnt vmcnt(10)
 v_dot2_f32_bf16 v40, v212, v212, v40
 v_dot2_f32_bf16 v44, v212, s5, v44
 v_dot2_f32_bf16 v41, v213, v213, v41
 v_dot2_f32_bf16 v45, v213, s5, v45
 v_dot2_f32_bf16 v42, v214, v214, v42
 v_dot2_f32_bf16 v46, v214, s5, v46
 v_dot2_f32_bf16 v43, v215, v215, v43
 v_dot2_f32_bf16 v47, v215, s5, v47
 s_add_u32 m0, s89, 0
 s_nop 0
 buffer_load_dwordx4 v4, s[16:19], s32 offen lds
 v_and_b32 v109, 0xffff0000, v182
 v_lshlrev_b32 v110, 16, v183
 v_and_b32 v111, 0xffff0000, v183
 v_pk_fma_f32 v[104:105], v[104:105], v[36:37], v[38:39] op_sel_hi:[1,0,0]
 v_pk_fma_f32 v[106:107], v[106:107], v[36:37], v[38:39] op_sel_hi:[1,0,0]
 v_pk_fma_f32 v[108:109], v[108:109], v[36:37], v[38:39] op_sel_hi:[1,0,0]
 v_pk_fma_f32 v[110:111], v[110:111], v[36:37], v[38:39] op_sel_hi:[1,0,0]
 v_cvt_pk_bf16_f32 v180, v104, v105
 v_cvt_pk_bf16_f32 v181, v106, v107
 v_cvt_pk_bf16_f32 v182, v108, v109
 v_cvt_pk_bf16_f32 v183, v110, v111
 ds_write_b128 v19, v[180:183]
 v_add_u32 v19, s42, v19
 s_waitcnt vmcnt(10)
 v_dot2_f32_bf16 v40, v216, v216, v40
 v_dot2_f32_bf16 v44, v216, s5, v44
 v_dot2_f32_bf16 v41, v217, v217, v41
 v_dot2_f32_bf16 v45, v217, s5, v45
 v_dot2_f32_bf16 v42, v218, v218, v42
 v_dot2_f32_bf16 v46, v218, s5, v46
 v_dot2_f32_bf16 v43, v219, v219, v43
 v_dot2_f32_bf16 v47, v219, s5, v47
 buffer_load_dwordx4 v5, s[16:19], s32 offen offset:1024 lds
 v_add_f32 v40, v40, v41
 v_add_f32 v42, v42, v43
 v_add_f32 v44, v44, v45
 v_add_f32 v46, v46, v47
 v_add_f32 v40, v40, v42
 v_add_f32 v44, v44, v46
 s_nop 0
 v_add_f32_dpp v40, v40, v40 quad_perm:[1,0,3,2] row_mask:0xf bank_mask:0xf
 v_add_f32_dpp v44, v44, v44 quad_perm:[1,0,3,2] row_mask:0xf bank_mask:0xf
 s_nop 0
 v_add_f32_dpp v40, v40, v40 quad_perm:[2,3,0,1] row_mask:0xf bank_mask:0xf
 v_add_f32_dpp v44, v44, v44 quad_perm:[2,3,0,1] row_mask:0xf bank_mask:0xf
 s_nop 0
 v_add_f32_dpp v40, v40, v40 row_half_mirror row_mask:0xf bank_mask:0xf
 v_add_f32_dpp v44, v44, v44 row_half_mirror row_mask:0xf bank_mask:0xf
 v_mul_f32 v44, s4, v44
 v_mul_f32 v40, s4, v40
 v_fma_f32 v40, -v44, v44, v40
 v_max_f32 v40, 0, v40
 v_add_f32 v40, 0x3727c5ac, v40
 v_rsq_f32 v48, v40
 s_nop 0
 v_mul_f32 v50, -v48, v44
 v_lshlrev_b32 v112, 16, v184
 s_waitcnt vmcnt(10)
 v_dot2_f32_bf16 v52, v220, v220, 0
 v_dot2_f32_bf16 v56, v220, s5, 0
 v_dot2_f32_bf16 v53, v221, v221, 0
 v_dot2_f32_bf16 v57, v221, s5, 0
 v_dot2_f32_bf16 v54, v222, v222, 0
 v_dot2_f32_bf16 v58, v222, s5, 0
 v_dot2_f32_bf16 v55, v223, v223, 0
 v_dot2_f32_bf16 v59, v223, s5, 0
 buffer_load_dwordx4 v6, s[16:19], s32 offen offset:2048 lds
 v_and_b32 v113, 0xffff0000, v184
 v_lshlrev_b32 v114, 16, v185
 v_and_b32 v115, 0xffff0000, v185
 v_lshlrev_b32 v116, 16, v186
 v_and_b32 v117, 0xffff0000, v186
 v_lshlrev_b32 v118, 16, v187
 v_and_b32 v119, 0xffff0000, v187
 v_pk_fma_f32 v[112:113], v[112:113], v[48:49], v[50:51] op_sel_hi:[1,0,0]
 v_pk_fma_f32 v[114:115], v[114:115], v[48:49], v[50:51] op_sel_hi:[1,0,0]
 v_pk_fma_f32 v[116:117], v[116:117], v[48:49], v[50:51] op_sel_hi:[1,0,0]
 v_pk_fma_f32 v[118:119], v[118:119], v[48:49], v[50:51] op_sel_hi:[1,0,0]
 v_cvt_pk_bf16_f32 v184, v112, v113
 v_cvt_pk_bf16_f32 v185, v114, v115
 v_cvt_pk_bf16_f32 v186, v116, v117
 v_cvt_pk_bf16_f32 v187, v118, v119
 ds_write_b128 v20, v[184:187] offset:0
 v_lshlrev_b32 v112, 16, v188
 v_and_b32 v113, 0xffff0000, v188
 v_lshlrev_b32 v114, 16, v189
 v_and_b32 v115, 0xffff0000, v189
 s_waitcnt vmcnt(10)
 v_dot2_f32_bf16 v52, v224, v224, v52
 v_dot2_f32_bf16 v56, v224, s5, v56
 v_dot2_f32_bf16 v53, v225, v225, v53
 v_dot2_f32_bf16 v57, v225, s5, v57
 v_dot2_f32_bf16 v54, v226, v226, v54
 v_dot2_f32_bf16 v58, v226, s5, v58
 v_dot2_f32_bf16 v55, v227, v227, v55
 v_dot2_f32_bf16 v59, v227, s5, v59
 s_add_u32 m0, s89, 12288
 s_add_u32 s32, s32, 331776
 buffer_load_dwordx4 v4, s[16:19], s32 offen lds
 v_lshlrev_b32 v116, 16, v190
 v_and_b32 v117, 0xffff0000, v190
 v_lshlrev_b32 v118, 16, v191
 v_and_b32 v119, 0xffff0000, v191
 v_pk_fma_f32 v[112:113], v[112:113], v[48:49], v[50:51] op_sel_hi:[1,0,0]
 v_pk_fma_f32 v[114:115], v[114:115], v[48:49], v[50:51] op_sel_hi:[1,0,0]
 v_pk_fma_f32 v[116:117], v[116:117], v[48:49], v[50:51] op_sel_hi:[1,0,0]
 v_pk_fma_f32 v[118:119], v[118:119], v[48:49], v[50:51] op_sel_hi:[1,0,0]
 v_cvt_pk_bf16_f32 v188, v112, v113
 v_cvt_pk_bf16_f32 v189, v114, v115
 v_cvt_pk_bf16_f32 v190, v116, v117
 v_cvt_pk_bf16_f32 v191, v118, v119
 ds_write_b128 v20, v[188:191] offset:10240
 v_lshlrev_b32 v112, 16, v192
 v_and_b32 v113, 0xffff0000, v192
 v_lshlrev_b32 v114, 16, v193
 v_and_b32 v115, 0xffff0000, v193
 v_lshlrev_b32 v116, 16, v194
 v_and_b32 v117, 0xffff0000, v194
 v_lshlrev_b32 v118, 16, v195
 s_waitcnt vmcnt(10)
 v_dot2_f32_bf16 v52, v228, v228, v52
 v_dot2_f32_bf16 v56, v228, s5, v56
 v_dot2_f32_bf16 v53, v229, v229, v53
 v_dot2_f32_bf16 v57, v229, s5, v57
 v_dot2_f32_bf16 v54, v230, v230, v54
 v_dot2_f32_bf16 v58, v230, s5, v58
 v_dot2_f32_bf16 v55, v231, v231, v55
 v_dot2_f32_bf16 v59, v231, s5, v59
 buffer_load_dwordx4 v5, s[16:19], s32 offen offset:1024 lds
 v_and_b32 v119, 0xffff0000, v195
 v_pk_fma_f32 v[112:113], v[112:113], v[48:49], v[50:51] op_sel_hi:[1,0,0]
 v_pk_fma_f32 v[114:115], v[114:115], v[48:49], v[50:51] op_sel_hi:[1,0,0]
 v_pk_fma_f32 v[116:117], v[116:117], v[48:49], v[50:51] op_sel_hi:[1,0,0]
 v_pk_fma_f32 v[118:119], v[118:119], v[48:49], v[50:51] op_sel_hi:[1,0,0]
 v_cvt_pk_bf16_f32 v192, v112, v113
 v_cvt_pk_bf16_f32 v193, v114, v115
 v_cvt_pk_bf16_f32 v194, v116, v117
 v_cvt_pk_bf16_f32 v195, v118, v119
 ds_write_b128 v20, v[192:195] offset:20480
 v_lshlrev_b32 v112, 16, v196
 v_and_b32 v113, 0xffff0000, v196
 v_lshlrev_b32 v114, 16, v197
 v_and_b32 v115, 0xffff0000, v197
 v_lshlrev_b32 v116, 16, v198
 v_and_b32 v117, 0xffff0000, v198
 v_lshlrev_b32 v118, 16, v199
 v_and_b32 v119, 0xffff0000, v199
 v_pk_fma_f32 v[112:113], v[112:113], v[48:49], v[50:51] op_sel_hi:[1,0,0]
 v_pk_fma_f32 v[114:115], v[114:115], v[48:49], v[50:51] op_sel_hi:[1,0,0]
 s_waitcnt vmcnt(10)
 v_dot2_f32_bf16 v52, v232, v232, v52
 v_dot2_f32_bf16 v56, v232, s5, v56
 v_dot2_f32_bf16 v53, v233, v233, v53
 v_dot2_f32_bf16 v57, v233, s5, v57
 v_dot2_f32_bf16 v54, v234, v234, v54
 v_dot2_f32_bf16 v58, v234, s5, v58
 v_dot2_f32_bf16 v55, v235, v235, v55
 v_dot2_f32_bf16 v59, v235, s5, v59
 buffer_load_dwordx4 v6, s[16:19], s32 offen offset:2048 lds
 v_pk_fma_f32 v[116:117], v[116:117], v[48:49], v[50:51] op_sel_hi:[1,0,0]
 v_pk_fma_f32 v[118:119], v[118:119], v[48:49], v[50:51] op_sel_hi:[1,0,0]
 v_cvt_pk_bf16_f32 v196, v112, v113
 v_cvt_pk_bf16_f32 v197, v114, v115
 v_cvt_pk_bf16_f32 v198, v116, v117
 v_cvt_pk_bf16_f32 v199, v118, v119
 ds_write_b128 v20, v[196:199] offset:30720
 v_lshlrev_b32 v112, 16, v200
 v_and_b32 v113, 0xffff0000, v200
 v_lshlrev_b32 v114, 16, v201
 v_and_b32 v115, 0xffff0000, v201
 v_lshlrev_b32 v116, 16, v202
 v_and_b32 v117, 0xffff0000, v202
 v_lshlrev_b32 v118, 16, v203
 v_and_b32 v119, 0xffff0000, v203
 v_pk_fma_f32 v[112:113], v[112:113], v[48:49], v[50:51] op_sel_hi:[1,0,0]
 v_pk_fma_f32 v[114:115], v[114:115], v[48:49], v[50:51] op_sel_hi:[1,0,0]
 v_pk_fma_f32 v[116:117], v[116:117], v[48:49], v[50:51] op_sel_hi:[1,0,0]
 v_pk_fma_f32 v[118:119], v[118:119], v[48:49], v[50:51] op_sel_hi:[1,0,0]
 v_cvt_pk_bf16_f32 v200, v112, v113
 s_waitcnt vmcnt(10)
 v_dot2_f32_bf16 v52, v236, v236, v52
 v_dot2_f32_bf16 v56, v236, s5, v56
 v_dot2_f32_bf16 v53, v237, v237, v53
 v_dot2_f32_bf16 v57, v237, s5, v57
 v_dot2_f32_bf16 v54, v238, v238, v54
 v_dot2_f32_bf16 v58, v238, s5, v58
 v_dot2_f32_bf16 v55, v239, v239, v55
 v_dot2_f32_bf16 v59, v239, s5, v59
 s_add_u32 m0, s89, 24576
 s_add_u32 s32, s32, 331776
 buffer_load_dwordx4 v4, s[16:19], s32 offen lds
 v_cvt_pk_bf16_f32 v201, v114, v115
 v_cvt_pk_bf16_f32 v202, v116, v117
 v_cvt_pk_bf16_f32 v203, v118, v119
 ds_write_b128 v20, v[200:203] offset:40960
 v_lshlrev_b32 v112, 16, v204
 v_and_b32 v113, 0xffff0000, v204
 v_lshlrev_b32 v114, 16, v205
 v_and_b32 v115, 0xffff0000, v205
 v_lshlrev_b32 v116, 16, v206
 v_and_b32 v117, 0xffff0000, v206
 v_lshlrev_b32 v118, 16, v207
 v_and_b32 v119, 0xffff0000, v207
 v_pk_fma_f32 v[112:113], v[112:113], v[48:49], v[50:51] op_sel_hi:[1,0,0]
 v_pk_fma_f32 v[114:115], v[114:115], v[48:49], v[50:51] op_sel_hi:[1,0,0]
 v_pk_fma_f32 v[116:117], v[116:117], v[48:49], v[50:51] op_sel_hi:[1,0,0]
 v_pk_fma_f32 v[118:119], v[118:119], v[48:49], v[50:51] op_sel_hi:[1,0,0]
 v_cvt_pk_bf16_f32 v204, v112, v113
 v_cvt_pk_bf16_f32 v205, v114, v115
 v_cvt_pk_bf16_f32 v206, v116, v117
 v_cvt_pk_bf16_f32 v207, v118, v119
 s_waitcnt vmcnt(10)
 v_dot2_f32_bf16 v52, v240, v240, v52
 v_dot2_f32_bf16 v56, v240, s5, v56
 v_dot2_f32_bf16 v53, v241, v241, v53
 v_dot2_f32_bf16 v57, v241, s5, v57
 v_dot2_f32_bf16 v54, v242, v242, v54
 v_dot2_f32_bf16 v58, v242, s5, v58
 v_dot2_f32_bf16 v55, v243, v243, v55
 v_dot2_f32_bf16 v59, v243, s5, v59
 buffer_load_dwordx4 v5, s[16:19], s32 offen offset:1024 lds
 ds_write_b128 v20, v[204:207] offset:51200
 v_lshlrev_b32 v112, 16, v208
 v_and_b32 v113, 0xffff0000, v208
 v_lshlrev_b32 v114, 16, v209
 v_and_b32 v115, 0xffff0000, v209
 v_lshlrev_b32 v116, 16, v210
 v_and_b32 v117, 0xffff0000, v210
 v_lshlrev_b32 v118, 16, v211
 v_and_b32 v119, 0xffff0000, v211
 v_pk_fma_f32 v[112:113], v[112:113], v[48:49], v[50:51] op_sel_hi:[1,0,0]
 v_pk_fma_f32 v[114:115], v[114:115], v[48:49], v[50:51] op_sel_hi:[1,0,0]
 v_pk_fma_f32 v[116:117], v[116:117], v[48:49], v[50:51] op_sel_hi:[1,0,0]
 v_pk_fma_f32 v[118:119], v[118:119], v[48:49], v[50:51] op_sel_hi:[1,0,0]
 v_cvt_pk_bf16_f32 v208, v112, v113
 v_cvt_pk_bf16_f32 v209, v114, v115
 v_cvt_pk_bf16_f32 v210, v116, v117
 v_cvt_pk_bf16_f32 v211, v118, v119
 ds_write_b128 v21, v[208:211] offset:0
 v_lshlrev_b32 v112, 16, v212
 v_and_b32 v113, 0xffff0000, v212
 s_waitcnt vmcnt(10)
 v_dot2_f32_bf16 v52, v244, v244, v52
 v_dot2_f32_bf16 v56, v244, s5, v56
 v_dot2_f32_bf16 v53, v245, v245, v53
 v_dot2_f32_bf16 v57, v245, s5, v57
 v_dot2_f32_bf16 v54, v246, v246, v54
 v_dot2_f32_bf16 v58, v246, s5, v58
 v_dot2_f32_bf16 v55, v247, v247, v55
 v_dot2_f32_bf16 v59, v247, s5, v59
 buffer_load_dwordx4 v6, s[16:19], s32 offen offset:2048 lds
 v_lshlrev_b32 v114, 16, v213
 v_and_b32 v115, 0xffff0000, v213
 v_lshlrev_b32 v116, 16, v214
 v_and_b32 v117, 0xffff0000, v214
 v_lshlrev_b32 v118, 16, v215
 v_and_b32 v119, 0xffff0000, v215
 v_pk_fma_f32 v[112:113], v[112:113], v[48:49], v[50:51] op_sel_hi:[1,0,0]
 v_pk_fma_f32 v[114:115], v[114:115], v[48:49], v[50:51] op_sel_hi:[1,0,0]
 v_pk_fma_f32 v[116:117], v[116:117], v[48:49], v[50:51] op_sel_hi:[1,0,0]
 v_pk_fma_f32 v[118:119], v[118:119], v[48:49], v[50:51] op_sel_hi:[1,0,0]
 v_cvt_pk_bf16_f32 v212, v112, v113
 v_cvt_pk_bf16_f32 v213, v114, v115
 v_cvt_pk_bf16_f32 v214, v116, v117
 v_cvt_pk_bf16_f32 v215, v118, v119
 ds_write_b128 v21, v[212:215] offset:10240
 v_lshlrev_b32 v112, 16, v216
 v_and_b32 v113, 0xffff0000, v216
 v_lshlrev_b32 v114, 16, v217
 v_and_b32 v115, 0xffff0000, v217
 v_lshlrev_b32 v116, 16, v218
 s_waitcnt vmcnt(10)
 v_dot2_f32_bf16 v52, v248, v248, v52
 v_dot2_f32_bf16 v56, v248, s5, v56
 v_dot2_f32_bf16 v53, v249, v249, v53
 v_dot2_f32_bf16 v57, v249, s5, v57
 v_dot2_f32_bf16 v54, v250, v250, v54
 v_dot2_f32_bf16 v58, v250, s5, v58
 v_dot2_f32_bf16 v55, v251, v251, v55
 v_dot2_f32_bf16 v59, v251, s5, v59
 s_add_u32 m0, s89, 36864
 s_add_u32 s32, s32, 331776
 buffer_load_dwordx4 v4, s[16:19], s32 offen lds
 v_and_b32 v117, 0xffff0000, v218
 v_lshlrev_b32 v118, 16, v219
 v_and_b32 v119, 0xffff0000, v219
 v_pk_fma_f32 v[112:113], v[112:113], v[48:49], v[50:51] op_sel_hi:[1,0,0]
 v_pk_fma_f32 v[114:115], v[114:115], v[48:49], v[50:51] op_sel_hi:[1,0,0]
 v_pk_fma_f32 v[116:117], v[116:117], v[48:49], v[50:51] op_sel_hi:[1,0,0]
 v_pk_fma_f32 v[118:119], v[118:119], v[48:49], v[50:51] op_sel_hi:[1,0,0]
 v_cvt_pk_bf16_f32 v216, v112, v113
 v_cvt_pk_bf16_f32 v217, v114, v115
 v_cvt_pk_bf16_f32 v218, v116, v117
 v_cvt_pk_bf16_f32 v219, v118, v119
 ds_write_b128 v21, v[216:219] offset:20480
 s_waitcnt vmcnt(10)
 v_dot2_f32_bf16 v52, v252, v252, v52
 v_dot2_f32_bf16 v56, v252, s5, v56
 v_dot2_f32_bf16 v53, v253, v253, v53
 v_dot2_f32_bf16 v57, v253, s5, v57
 v_dot2_f32_bf16 v54, v254, v254, v54
 v_dot2_f32_bf16 v58, v254, s5, v58
 v_dot2_f32_bf16 v55, v255, v255, v55
 v_dot2_f32_bf16 v59, v255, s5, v59
 buffer_load_dwordx4 v5, s[16:19], s32 offen offset:1024 lds
 v_add_f32 v52, v52, v53
 v_add_f32 v54, v54, v55
 v_add_f32 v56, v56, v57
 v_add_f32 v58, v58, v59
 v_add_f32 v52, v52, v54
 v_add_f32 v56, v56, v58
 s_nop 0
 v_add_f32_dpp v52, v52, v52 quad_perm:[1,0,3,2] row_mask:0xf bank_mask:0xf
 v_add_f32_dpp v56, v56, v56 quad_perm:[1,0,3,2] row_mask:0xf bank_mask:0xf
 s_nop 0
 v_add_f32_dpp v52, v52, v52 quad_perm:[2,3,0,1] row_mask:0xf bank_mask:0xf
 v_add_f32_dpp v56, v56, v56 quad_perm:[2,3,0,1] row_mask:0xf bank_mask:0xf
 s_nop 0
 v_add_f32_dpp v52, v52, v52 row_half_mirror row_mask:0xf bank_mask:0xf
 v_add_f32_dpp v56, v56, v56 row_half_mirror row_mask:0xf bank_mask:0xf
 v_mul_f32 v56, s4, v56
 v_mul_f32 v52, s4, v52
 v_fma_f32 v52, -v56, v56, v52
 v_max_f32 v52, 0, v52
 v_add_f32 v52, 0x3727c5ac, v52
 v_rsq_f32 v60, v52
 s_nop 0
 v_mul_f32 v62, -v60, v56
 v_lshlrev_b32 v120, 16, v220
 v_and_b32 v121, 0xffff0000, v220
 v_lshlrev_b32 v122, 16, v221
 v_and_b32 v123, 0xffff0000, v221
 v_lshlrev_b32 v124, 16, v222
 v_and_b32 v125, 0xffff0000, v222
 v_lshlrev_b32 v126, 16, v223
 v_and_b32 v127, 0xffff0000, v223
 v_pk_fma_f32 v[120:121], v[120:121], v[60:61], v[62:63] op_sel_hi:[1,0,0]
 v_pk_fma_f32 v[122:123], v[122:123], v[60:61], v[62:63] op_sel_hi:[1,0,0]
 v_pk_fma_f32 v[124:125], v[124:125], v[60:61], v[62:63] op_sel_hi:[1,0,0]
 v_pk_fma_f32 v[126:127], v[126:127], v[60:61], v[62:63] op_sel_hi:[1,0,0]
 v_cvt_pk_bf16_f32 v220, v120, v121
 v_cvt_pk_bf16_f32 v221, v122, v123
 v_cvt_pk_bf16_f32 v222, v124, v125
 v_cvt_pk_bf16_f32 v223, v126, v127
 ds_write_b128 v20, v[220:223] offset:512
 v_lshlrev_b32 v120, 16, v224
 v_and_b32 v121, 0xffff0000, v224
 v_lshlrev_b32 v122, 16, v225
 v_and_b32 v123, 0xffff0000, v225
 v_lshlrev_b32 v124, 16, v226
 v_and_b32 v125, 0xffff0000, v226
 v_lshlrev_b32 v126, 16, v227
 v_and_b32 v127, 0xffff0000, v227
 v_pk_fma_f32 v[120:121], v[120:121], v[60:61], v[62:63] op_sel_hi:[1,0,0]
 v_pk_fma_f32 v[122:123], v[122:123], v[60:61], v[62:63] op_sel_hi:[1,0,0]
 v_pk_fma_f32 v[124:125], v[124:125], v[60:61], v[62:63] op_sel_hi:[1,0,0]
 v_pk_fma_f32 v[126:127], v[126:127], v[60:61], v[62:63] op_sel_hi:[1,0,0]
 v_cvt_pk_bf16_f32 v224, v120, v121
 v_cvt_pk_bf16_f32 v225, v122, v123
 v_cvt_pk_bf16_f32 v226, v124, v125
 v_cvt_pk_bf16_f32 v227, v126, v127
 ds_write_b128 v20, v[224:227] offset:10752
 v_lshlrev_b32 v120, 16, v228
 v_and_b32 v121, 0xffff0000, v228
 v_lshlrev_b32 v122, 16, v229
 v_and_b32 v123, 0xffff0000, v229
 v_lshlrev_b32 v124, 16, v230
 v_and_b32 v125, 0xffff0000, v230
 v_lshlrev_b32 v126, 16, v231
 v_and_b32 v127, 0xffff0000, v231
 v_pk_fma_f32 v[120:121], v[120:121], v[60:61], v[62:63] op_sel_hi:[1,0,0]
 v_pk_fma_f32 v[122:123], v[122:123], v[60:61], v[62:63] op_sel_hi:[1,0,0]
 v_pk_fma_f32 v[124:125], v[124:125], v[60:61], v[62:63] op_sel_hi:[1,0,0]
 v_pk_fma_f32 v[126:127], v[126:127], v[60:61], v[62:63] op_sel_hi:[1,0,0]
 v_cvt_pk_bf16_f32 v228, v120, v121
 v_cvt_pk_bf16_f32 v229, v122, v123
 v_cvt_pk_bf16_f32 v230, v124, v125
 v_cvt_pk_bf16_f32 v231, v126, v127
 ds_write_b128 v20, v[228:231] offset:20992
 v_lshlrev_b32 v120, 16, v232
 v_and_b32 v121, 0xffff0000, v232
 v_lshlrev_b32 v122, 16, v233
 v_and_b32 v123, 0xffff0000, v233
 v_lshlrev_b32 v124, 16, v234
 v_and_b32 v125, 0xffff0000, v234
 v_lshlrev_b32 v126, 16, v235
 v_and_b32 v127, 0xffff0000, v235
 v_pk_fma_f32 v[120:121], v[120:121], v[60:61], v[62:63] op_sel_hi:[1,0,0]
 v_pk_fma_f32 v[122:123], v[122:123], v[60:61], v[62:63] op_sel_hi:[1,0,0]
 v_pk_fma_f32 v[124:125], v[124:125], v[60:61], v[62:63] op_sel_hi:[1,0,0]
 v_pk_fma_f32 v[126:127], v[126:127], v[60:61], v[62:63] op_sel_hi:[1,0,0]
 v_cvt_pk_bf16_f32 v232, v120, v121
 v_cvt_pk_bf16_f32 v233, v122, v123
 v_cvt_pk_bf16_f32 v234, v124, v125
 v_cvt_pk_bf16_f32 v235, v126, v127
 buffer_load_dwordx4 v6, s[16:19], s32 offen offset:2048 lds
 ds_write_b128 v20, v[232:235] offset:31232
 v_lshlrev_b32 v120, 16, v236
 v_and_b32 v121, 0xffff0000, v236
 v_lshlrev_b32 v122, 16, v237
 v_and_b32 v123, 0xffff0000, v237
 v_lshlrev_b32 v124, 16, v238
 v_and_b32 v125, 0xffff0000, v238
 v_lshlrev_b32 v126, 16, v239
 v_and_b32 v127, 0xffff0000, v239
 v_pk_fma_f32 v[120:121], v[120:121], v[60:61], v[62:63] op_sel_hi:[1,0,0]
 v_pk_fma_f32 v[122:123], v[122:123], v[60:61], v[62:63] op_sel_hi:[1,0,0]
 v_pk_fma_f32 v[124:125], v[124:125], v[60:61], v[62:63] op_sel_hi:[1,0,0]
 v_pk_fma_f32 v[126:127], v[126:127], v[60:61], v[62:63] op_sel_hi:[1,0,0]
 v_cvt_pk_bf16_f32 v236, v120, v121
 v_cvt_pk_bf16_f32 v237, v122, v123
 v_cvt_pk_bf16_f32 v238, v124, v125
 v_cvt_pk_bf16_f32 v239, v126, v127
 ds_write_b128 v20, v[236:239] offset:41472
 v_lshlrev_b32 v120, 16, v240
 v_and_b32 v121, 0xffff0000, v240
 v_lshlrev_b32 v122, 16, v241
 v_and_b32 v123, 0xffff0000, v241
 v_lshlrev_b32 v124, 16, v242
 v_and_b32 v125, 0xffff0000, v242
 v_lshlrev_b32 v126, 16, v243
 v_and_b32 v127, 0xffff0000, v243
 v_pk_fma_f32 v[120:121], v[120:121], v[60:61], v[62:63] op_sel_hi:[1,0,0]
 v_pk_fma_f32 v[122:123], v[122:123], v[60:61], v[62:63] op_sel_hi:[1,0,0]
 v_pk_fma_f32 v[124:125], v[124:125], v[60:61], v[62:63] op_sel_hi:[1,0,0]
 v_pk_fma_f32 v[126:127], v[126:127], v[60:61], v[62:63] op_sel_hi:[1,0,0]
 v_cvt_pk_bf16_f32 v240, v120, v121
 v_cvt_pk_bf16_f32 v241, v122, v123
 v_cvt_pk_bf16_f32 v242, v124, v125
 v_cvt_pk_bf16_f32 v243, v126, v127
 ds_write_b128 v20, v[240:243] offset:51712
 v_lshlrev_b32 v120, 16, v244
 v_and_b32 v121, 0xffff0000, v244
 v_lshlrev_b32 v122, 16, v245
 v_and_b32 v123, 0xffff0000, v245
 v_lshlrev_b32 v124, 16, v246
 v_and_b32 v125, 0xffff0000, v246
 v_lshlrev_b32 v126, 16, v247
 v_and_b32 v127, 0xffff0000, v247
 v_pk_fma_f32 v[120:121], v[120:121], v[60:61], v[62:63] op_sel_hi:[1,0,0]
 v_pk_fma_f32 v[122:123], v[122:123], v[60:61], v[62:63] op_sel_hi:[1,0,0]
 v_pk_fma_f32 v[124:125], v[124:125], v[60:61], v[62:63] op_sel_hi:[1,0,0]
 v_pk_fma_f32 v[126:127], v[126:127], v[60:61], v[62:63] op_sel_hi:[1,0,0]
 v_cvt_pk_bf16_f32 v244, v120, v121
 v_cvt_pk_bf16_f32 v245, v122, v123
 v_cvt_pk_bf16_f32 v246, v124, v125
 v_cvt_pk_bf16_f32 v247, v126, v127
 ds_write_b128 v21, v[244:247] offset:512
 v_lshlrev_b32 v120, 16, v248
 v_and_b32 v121, 0xffff0000, v248
 v_lshlrev_b32 v122, 16, v249
 v_and_b32 v123, 0xffff0000, v249
 v_lshlrev_b32 v124, 16, v250
 v_and_b32 v125, 0xffff0000, v250
 v_lshlrev_b32 v126, 16, v251
 v_and_b32 v127, 0xffff0000, v251
 v_pk_fma_f32 v[120:121], v[120:121], v[60:61], v[62:63] op_sel_hi:[1,0,0]
 v_pk_fma_f32 v[122:123], v[122:123], v[60:61], v[62:63] op_sel_hi:[1,0,0]
 v_pk_fma_f32 v[124:125], v[124:125], v[60:61], v[62:63] op_sel_hi:[1,0,0]
 v_pk_fma_f32 v[126:127], v[126:127], v[60:61], v[62:63] op_sel_hi:[1,0,0]
 v_cvt_pk_bf16_f32 v248, v120, v121
 v_cvt_pk_bf16_f32 v249, v122, v123
 v_cvt_pk_bf16_f32 v250, v124, v125
 v_cvt_pk_bf16_f32 v251, v126, v127
 ds_write_b128 v21, v[248:251] offset:10752
 v_lshlrev_b32 v120, 16, v252
 v_and_b32 v121, 0xffff0000, v252
 v_lshlrev_b32 v122, 16, v253
 v_and_b32 v123, 0xffff0000, v253
 v_lshlrev_b32 v124, 16, v254
 v_and_b32 v125, 0xffff0000, v254
 v_lshlrev_b32 v126, 16, v255
 v_and_b32 v127, 0xffff0000, v255
 v_pk_fma_f32 v[120:121], v[120:121], v[60:61], v[62:63] op_sel_hi:[1,0,0]
 v_pk_fma_f32 v[122:123], v[122:123], v[60:61], v[62:63] op_sel_hi:[1,0,0]
 v_pk_fma_f32 v[124:125], v[124:125], v[60:61], v[62:63] op_sel_hi:[1,0,0]
 v_pk_fma_f32 v[126:127], v[126:127], v[60:61], v[62:63] op_sel_hi:[1,0,0]
 v_cvt_pk_bf16_f32 v252, v120, v121
 v_cvt_pk_bf16_f32 v253, v122, v123
 v_cvt_pk_bf16_f32 v254, v124, v125
 v_cvt_pk_bf16_f32 v255, v126, v127
 ds_write_b128 v21, v[252:255] offset:20992
 s_mov_b32 s40, 0x11111111
 s_mov_b32 s41, 0x11111111
 s_mov_b32 s42, 0x33333333
 s_mov_b32 s43, 0x33333333
 s_mov_b32 s44, 0x77777777
 s_mov_b32 s45, 0x77777777
 s_mov_b32 s50, 0x3eae1a93
 s_mov_b32 s51, 0x3eae1a93
 s_mov_b32 s54, 67584
 s_lshl_b32 s39, s28, 4
 s_mov_b32 s34, 1
 s_mov_b32 s53, 0
 s_mov_b32 s33, -4
 s_mov_b32 s91, 1
 s_mov_b32 s92, 12288
 v_add_u32 v15, 12288, v2
 s_mov_b32 s93, s89
 s_cmp_eq_u32 s29, 0
 s_cselect_b32 s31, 8, 0
 v_cmp_gt_u32 vcc, s31, v0
 v_mov_b32 v14, 0xf149
 v_min_u32 v13, 95, v0
 v_cndmask_b32 v14, 0, v14, vcc
 v_mul_u32_u24 v13, 280, v13
 v_add_u32 v13, 94500, v13
 s_waitcnt vmcnt(9) lgkmcnt(0)
 s_barrier
 ds_read_b64_tr_b16 v[52:53], v2 offset:0
 ds_read_b64_tr_b16 v[54:55], v2 offset:512
 ds_read_b64_tr_b16 v[56:57], v2 offset:1024
 ds_read_b64_tr_b16 v[58:59], v2 offset:1536
 ds_read_b64_tr_b16 v[60:61], v2 offset:2048
 ds_read_b64_tr_b16 v[62:63], v2 offset:2560
 ds_read_b128 a[0:3], v24 offset:0
 ds_read_b128 a[20:23], v24 offset:5120
 ds_read_b128 a[40:43], v24 offset:10240
 ds_read_b128 a[4:7], v24 offset:1024
 ds_read_b128 a[24:27], v24 offset:6144
 ds_read_b128 a[44:47], v24 offset:11264
 ds_read_b128 a[8:11], v24 offset:2048
 ds_read_b128 a[28:31], v24 offset:7168
 ds_read_b128 a[48:51], v24 offset:12288
 ds_read_b128 a[12:15], v24 offset:3072
 ds_read_b128 a[32:35], v24 offset:8192
 ds_read_b128 a[52:55], v24 offset:13312
 ds_read_b128 a[16:19], v24 offset:4096
 ds_read_b128 a[36:39], v24 offset:9216
 ds_read_b128 a[56:59], v24 offset:14336
 s_waitcnt vmcnt(6) lgkmcnt(0)
 s_barrier
 v_mfma_f32_16x16x32_bf16 v[28:31], v[52:55], a[0:3], 0
 s_mov_b32 m0, s93
 ds_read_b128 v[76:79], v3 offset:0
 ds_read_b128 a[60:63], v24 offset:15360
 v_mfma_f32_16x16x32_bf16 v[28:31], v[56:59], a[20:23], v[28:31]
 s_add_u32 s32, s32, 331776
 ds_read_b128 v[80:83], v3 offset:1024
 ds_read_b128 a[80:83], v24 offset:20480
 v_mfma_f32_16x16x32_bf16 v[28:31], v[60:63], a[40:43], v[28:31]
 buffer_load_dwordx4 v4, s[16:19], s32 offen lds
 v_mfma_f32_16x16x32_bf16 v[32:35], v[52:55], a[4:7], 0
 s_add_u32 s93, s89, s92
 ds_read_b128 v[84:87], v3 offset:2048
 ds_read_b128 a[100:103], v24 offset:25600
 v_mfma_f32_16x16x32_bf16 v[32:35], v[56:59], a[24:27], v[32:35]
 s_add_u32 s91, s91, 1
 ds_read_b64_tr_b16 v[64:65], v15 offset:0
 ds_read_b128 a[64:67], v24 offset:16384
 v_mfma_f32_16x16x32_bf16 v[32:35], v[60:63], a[44:47], v[32:35]
 s_and_b32 s91, s91, 3
 ds_read_b64_tr_b16 v[66:67], v15 offset:512
 ds_read_b128 a[84:87], v24 offset:21504
 v_mfma_f32_16x16x32_bf16 v[36:39], v[52:55], a[8:11], 0
 s_mul_i32 s92, s91, 12288
 ds_read_b64_tr_b16 v[68:69], v15 offset:1024
 ds_read_b128 a[104:107], v24 offset:26624
 v_mfma_f32_16x16x32_bf16 v[36:39], v[56:59], a[28:31], v[36:39]
 ds_read_b64_tr_b16 v[70:71], v15 offset:1536
 ds_read_b128 a[68:71], v24 offset:17408
 v_mfma_f32_16x16x32_bf16 v[36:39], v[60:63], a[48:51], v[36:39]
 buffer_load_dwordx4 v5, s[16:19], s32 offen offset:1024 lds
 v_mfma_f32_16x16x32_bf16 v[40:43], v[52:55], a[12:15], 0
 ds_read_b64_tr_b16 v[72:73], v15 offset:2048
 ds_read_b128 a[88:91], v24 offset:22528
 v_mfma_f32_16x16x32_bf16 v[40:43], v[56:59], a[32:35], v[40:43]
 ds_read_b64_tr_b16 v[74:75], v15 offset:2560
 ds_read_b128 a[108:111], v24 offset:27648
 v_add_u32 v15, s92, v2
 v_mfma_f32_16x16x32_bf16 v[40:43], v[60:63], a[52:55], v[40:43]
 ds_read_b128 a[72:75], v24 offset:18432
 ds_read_b128 a[92:95], v24 offset:23552
 v_mfma_f32_16x16x32_bf16 v[44:47], v[52:55], a[16:19], 0
 ds_read_b128 a[112:115], v24 offset:28672
 ds_read_b128 a[76:79], v24 offset:19456
 v_mfma_f32_16x16x32_bf16 v[44:47], v[56:59], a[36:39], v[44:47]
 s_waitcnt lgkmcnt(15)
 ds_read_b128 a[96:99], v24 offset:24576
 ds_read_b128 a[116:119], v24 offset:29696
 v_mfma_f32_16x16x32_bf16 v[44:47], v[60:63], a[56:59], v[44:47]
 buffer_load_dwordx4 v6, s[16:19], s32 offen offset:2048 lds
 v_mfma_f32_16x16x32_bf16 v[48:51], v[52:55], v[76:79], 0
 v_mfma_f32_16x16x32_bf16 v[48:51], v[56:59], v[80:83], v[48:51]
 s_waitcnt vmcnt(6) lgkmcnt(0)
 v_mfma_f32_16x16x32_bf16 v[48:51], v[60:63], v[84:87], v[48:51]
 s_barrier
 v_mfma_f32_16x16x32_bf16 v[28:31], v[64:67], a[60:63], v[28:31]
 s_mov_b32 m0, s93
 ds_read_b128 v[76:79], v3 offset:3072
 ds_read_b128 a[120:123], v24 offset:30720
 v_mfma_f32_16x16x32_bf16 v[28:31], v[68:71], a[80:83], v[28:31]
 s_add_u32 s32, s32, 331776
 ds_read_b128 v[80:83], v3 offset:4096
 ds_read_b128 a[140:143], v24 offset:35840
 v_mfma_f32_16x16x32_bf16 v[28:31], v[72:75], a[100:103], v[28:31]
 buffer_load_dwordx4 v4, s[16:19], s32 offen lds
 v_mfma_f32_16x16x32_bf16 v[32:35], v[64:67], a[64:67], v[32:35]
 s_add_u32 s93, s89, s92
 ds_read_b128 v[84:87], v3 offset:5120
 ds_read_b128 a[160:163], v24 offset:40960
 v_mfma_f32_16x16x32_bf16 v[32:35], v[68:71], a[84:87], v[32:35]
 s_add_u32 s91, s91, 1
 ds_read_b64_tr_b16 v[52:53], v15 offset:0
 ds_read_b128 a[124:127], v24 offset:31744
 v_mfma_f32_16x16x32_bf16 v[32:35], v[72:75], a[104:107], v[32:35]
 s_and_b32 s91, s91, 3
 ds_read_b64_tr_b16 v[54:55], v15 offset:512
 ds_read_b128 a[144:147], v24 offset:36864
 v_mfma_f32_16x16x32_bf16 v[36:39], v[64:67], a[68:71], v[36:39]
 s_mul_i32 s92, s91, 12288
 ds_read_b64_tr_b16 v[56:57], v15 offset:1024
 ds_read_b128 a[164:167], v24 offset:41984
 v_mfma_f32_16x16x32_bf16 v[36:39], v[68:71], a[88:91], v[36:39]
 ds_read_b64_tr_b16 v[58:59], v15 offset:1536
 ds_read_b128 a[128:131], v24 offset:32768
 v_readlane_b32 s90, v12, s34
 v_mfma_f32_16x16x32_bf16 v[36:39], v[72:75], a[108:111], v[36:39]
 buffer_load_dwordx4 v5, s[16:19], s32 offen offset:1024 lds
 v_mfma_f32_16x16x32_bf16 v[40:43], v[64:67], a[72:75], v[40:43]
 ds_read_b64_tr_b16 v[60:61], v15 offset:2048
 ds_read_b128 a[148:151], v24 offset:37888
 v_mfma_f32_16x16x32_bf16 v[40:43], v[68:71], a[92:95], v[40:43]
 s_lshr_b32 s31, s90, 16
 ds_read_b64_tr_b16 v[62:63], v15 offset:2560
 ds_read_b128 a[168:171], v24 offset:43008
 v_add_u32 v15, s92, v2
 v_mfma_f32_16x16x32_bf16 v[40:43], v[72:75], a[112:115], v[40:43]
 ds_read_b128 a[132:135], v24 offset:33792
 ds_read_b128 a[152:155], v24 offset:38912
 v_mfma_f32_16x16x32_bf16 v[44:47], v[64:67], a[76:79], v[44:47]
 s_add_u32 s34, s34, 1
 ds_read_b128 a[172:175], v24 offset:44032
 ds_read_b128 a[136:139], v24 offset:34816
 v_mfma_f32_16x16x32_bf16 v[44:47], v[68:71], a[96:99], v[44:47]
 s_waitcnt lgkmcnt(15)
 ds_read_b128 a[156:159], v24 offset:39936
 ds_read_b128 a[176:179], v24 offset:45056
 v_mfma_f32_16x16x32_bf16 v[44:47], v[72:75], a[116:119], v[44:47]
 buffer_load_dwordx4 v6, s[16:19], s32 offen offset:2048 lds
 v_mfma_f32_16x16x32_bf16 v[48:51], v[64:67], v[76:79], v[48:51]
 v_mfma_f32_16x16x32_bf16 v[48:51], v[68:71], v[80:83], v[48:51]
 s_waitcnt vmcnt(6) lgkmcnt(0)
 v_mad_u32_u24 v4, v8, s31, v7
 v_mfma_f32_16x16x32_bf16 v[48:51], v[72:75], v[84:87], v[48:51]
 s_barrier
 v_add_u32 v5, 109568, v4
 v_add_u32 v6, 219136, v4
 v_mfma_f32_16x16x32_bf16 v[28:31], v[52:55], a[120:123], v[28:31]
 s_mov_b32 m0, s93
 ds_read_b128 v[76:79], v3 offset:6144
 ds_read_b128 a[180:183], v24 offset:46080
 v_mfma_f32_16x16x32_bf16 v[28:31], v[56:59], a[140:143], v[28:31]
 s_and_b32 s32, s90, 0xffff
 ds_read_b128 v[80:83], v3 offset:7168
 ds_read_b128 a[200:203], v24 offset:51200
 v_mfma_f32_16x16x32_bf16 v[28:31], v[60:63], a[160:163], v[28:31]
 buffer_load_dwordx4 v4, s[16:19], s32 offen lds
 v_mfma_f32_16x16x32_bf16 v[32:35], v[52:55], a[124:127], v[32:35]
 s_add_u32 s93, s89, s92
 ds_read_b128 v[84:87], v3 offset:8192
 ds_read_b128 a[220:223], v24 offset:56320
 v_mfma_f32_16x16x32_bf16 v[32:35], v[56:59], a[144:147], v[32:35]
 s_add_u32 s91, s91, 1
 ds_read_b64_tr_b16 v[64:65], v15 offset:0
 ds_read_b128 a[184:187], v24 offset:47104
 v_mfma_f32_16x16x32_bf16 v[32:35], v[60:63], a[164:167], v[32:35]
 s_and_b32 s91, s91, 3
 ds_read_b64_tr_b16 v[66:67], v15 offset:512
 ds_read_b128 a[204:207], v24 offset:52224
 v_mfma_f32_16x16x32_bf16 v[36:39], v[52:55], a[128:131], v[36:39]
 s_mul_i32 s92, s91, 12288
 ds_read_b64_tr_b16 v[68:69], v15 offset:1024
 ds_read_b128 a[224:227], v24 offset:57344
 v_mfma_f32_16x16x32_bf16 v[36:39], v[56:59], a[148:151], v[36:39]
 ds_read_b64_tr_b16 v[70:71], v15 offset:1536
 ds_read_b128 a[188:191], v24 offset:48128
 v_mfma_f32_16x16x32_bf16 v[36:39], v[60:63], a[168:171], v[36:39]
 buffer_load_dwordx4 v5, s[16:19], s32 offen offset:1024 lds
 v_mfma_f32_16x16x32_bf16 v[40:43], v[52:55], a[132:135], v[40:43]
 ds_read_b64_tr_b16 v[72:73], v15 offset:2048
 ds_read_b128 a[208:211], v24 offset:53248
 v_mfma_f32_16x16x32_bf16 v[40:43], v[56:59], a[152:155], v[40:43]
 ds_read_b64_tr_b16 v[74:75], v15 offset:2560
 ds_read_b128 a[228:231], v24 offset:58368
 v_add_u32 v15, s92, v2
 v_mfma_f32_16x16x32_bf16 v[40:43], v[60:63], a[172:175], v[40:43]
 ds_read_b128 a[192:195], v24 offset:49152
 ds_read_b128 a[212:215], v24 offset:54272
 v_mfma_f32_16x16x32_bf16 v[44:47], v[52:55], a[136:139], v[44:47]
 ds_read_b128 a[232:235], v24 offset:59392
 ds_read_b128 a[196:199], v24 offset:50176
 v_mfma_f32_16x16x32_bf16 v[44:47], v[56:59], a[156:159], v[44:47]
 s_waitcnt lgkmcnt(15)
 ds_read_b128 a[216:219], v24 offset:55296
 ds_read_b128 a[236:239], v24 offset:60416
 v_mfma_f32_16x16x32_bf16 v[44:47], v[60:63], a[176:179], v[44:47]
 buffer_load_dwordx4 v6, s[16:19], s32 offen offset:2048 lds
 v_mfma_f32_16x16x32_bf16 v[48:51], v[52:55], v[76:79], v[48:51]
 v_mfma_f32_16x16x32_bf16 v[48:51], v[56:59], v[80:83], v[48:51]
 s_waitcnt vmcnt(6) lgkmcnt(0)
 v_mfma_f32_16x16x32_bf16 v[48:51], v[60:63], v[84:87], v[48:51]
 s_barrier
 v_mfma_f32_16x16x32_bf16 v[28:31], v[64:67], a[180:183], v[28:31]
 s_mov_b32 m0, s93
 ds_read_b128 v[76:79], v3 offset:9216
 ds_read_b128 a[240:243], v25 offset:0
 v_mfma_f32_16x16x32_bf16 v[28:31], v[68:71], a[200:203], v[28:31]
 s_add_u32 s32, s32, 331776
 ds_read_b128 v[80:83], v3 offset:10240
 ds_read_b128 v[156:159], v25 offset:5120
 v_mfma_f32_16x16x32_bf16 v[28:31], v[72:75], a[220:223], v[28:31]
 buffer_load_dwordx4 v4, s[16:19], s32 offen lds
 v_mfma_f32_16x16x32_bf16 v[32:35], v[64:67], a[184:187], v[32:35]
 s_add_u32 s93, s89, s92
 ds_read_b128 v[84:87], v3 offset:11264
 ds_read_b128 v[176:179], v25 offset:10240
 v_mfma_f32_16x16x32_bf16 v[32:35], v[68:71], a[204:207], v[32:35]
 s_add_u32 s91, s91, 1
 ds_read_b64_tr_b16 v[52:53], v15 offset:0
 ds_read_b128 a[244:247], v25 offset:1024
 v_mfma_f32_16x16x32_bf16 v[32:35], v[72:75], a[224:227], v[32:35]
 s_and_b32 s91, s91, 3
 ds_read_b64_tr_b16 v[54:55], v15 offset:512
 ds_read_b128 v[160:163], v25 offset:6144
 v_mfma_f32_16x16x32_bf16 v[36:39], v[64:67], a[188:191], v[36:39]
 s_mul_i32 s92, s91, 12288
 ds_read_b64_tr_b16 v[56:57], v15 offset:1024
 ds_read_b128 v[180:183], v25 offset:11264
 v_mfma_f32_16x16x32_bf16 v[36:39], v[68:71], a[208:211], v[36:39]
 ds_read_b64_tr_b16 v[58:59], v15 offset:1536
 ds_read_b128 a[248:251], v25 offset:2048
 v_mfma_f32_16x16x32_bf16 v[36:39], v[72:75], a[228:231], v[36:39]
 buffer_load_dwordx4 v5, s[16:19], s32 offen offset:1024 lds
 v_mfma_f32_16x16x32_bf16 v[40:43], v[64:67], a[192:195], v[40:43]
 ds_read_b64_tr_b16 v[60:61], v15 offset:2048
 ds_read_b128 v[164:167], v25 offset:7168
 v_mfma_f32_16x16x32_bf16 v[40:43], v[68:71], a[212:215], v[40:43]
 ds_read_b64_tr_b16 v[62:63], v15 offset:2560
 ds_read_b128 v[184:187], v25 offset:12288
 v_add_u32 v15, s92, v2
 v_mfma_f32_16x16x32_bf16 v[40:43], v[72:75], a[232:235], v[40:43]
 ds_read_b128 a[252:255], v25 offset:3072
 ds_read_b128 v[168:171], v25 offset:8192
 v_mfma_f32_16x16x32_bf16 v[44:47], v[64:67], a[196:199], v[44:47]
 ds_read_b128 v[188:191], v25 offset:13312
 ds_read_b128 v[152:155], v25 offset:4096
 v_mfma_f32_16x16x32_bf16 v[44:47], v[68:71], a[216:219], v[44:47]
 s_waitcnt lgkmcnt(15)
 ds_read_b128 v[172:175], v25 offset:9216
 ds_read_b128 v[192:195], v25 offset:14336
 v_mfma_f32_16x16x32_bf16 v[44:47], v[72:75], a[236:239], v[44:47]
 buffer_load_dwordx4 v6, s[16:19], s32 offen offset:2048 lds
 v_mfma_f32_16x16x32_bf16 v[48:51], v[64:67], v[76:79], v[48:51]
 v_mfma_f32_16x16x32_bf16 v[48:51], v[68:71], v[80:83], v[48:51]
 s_waitcnt vmcnt(6) lgkmcnt(0)
 v_mfma_f32_16x16x32_bf16 v[48:51], v[72:75], v[84:87], v[48:51]
 s_barrier
 v_mfma_f32_16x16x32_bf16 v[28:31], v[52:55], a[240:243], v[28:31]
 s_mov_b32 m0, s93
 ds_read_b128 v[76:79], v3 offset:12288
 ds_read_b128 v[196:199], v25 offset:15360
 v_mfma_f32_16x16x32_bf16 v[28:31], v[56:59], v[156:159], v[28:31]
 s_add_u32 s32, s32, 331776
 ds_read_b128 v[80:83], v3 offset:13312
 ds_read_b128 v[216:219], v25 offset:20480
 v_mfma_f32_16x16x32_bf16 v[28:31], v[60:63], v[176:179], v[28:31]
 buffer_load_dwordx4 v4, s[16:19], s32 offen lds
 v_mfma_f32_16x16x32_bf16 v[32:35], v[52:55], a[244:247], v[32:35]
 s_add_u32 s93, s89, s92
 ds_read_b128 v[84:87], v3 offset:14336
 ds_read_b128 v[236:239], v25 offset:25600
 v_mfma_f32_16x16x32_bf16 v[32:35], v[56:59], v[160:163], v[32:35]
 s_add_u32 s91, s91, 1
 ds_read_b64_tr_b16 v[64:65], v15 offset:0
 ds_read_b128 v[200:203], v25 offset:16384
 v_mfma_f32_16x16x32_bf16 v[32:35], v[60:63], v[180:183], v[32:35]
 s_and_b32 s91, s91, 3
 ds_read_b64_tr_b16 v[66:67], v15 offset:512
 ds_read_b128 v[220:223], v25 offset:21504
 v_mfma_f32_16x16x32_bf16 v[36:39], v[52:55], a[248:251], v[36:39]
 s_mul_i32 s92, s91, 12288
 ds_read_b64_tr_b16 v[68:69], v15 offset:1024
 ds_read_b128 v[240:243], v25 offset:26624
 v_mfma_f32_16x16x32_bf16 v[36:39], v[56:59], v[164:167], v[36:39]
 ds_read_b64_tr_b16 v[70:71], v15 offset:1536
 ds_read_b128 v[204:207], v25 offset:17408
 v_mfma_f32_16x16x32_bf16 v[36:39], v[60:63], v[184:187], v[36:39]
 buffer_load_dwordx4 v5, s[16:19], s32 offen offset:1024 lds
 v_mfma_f32_16x16x32_bf16 v[40:43], v[52:55], a[252:255], v[40:43]
 ds_read_b64_tr_b16 v[72:73], v15 offset:2048
 ds_read_b128 v[224:227], v25 offset:22528
 v_mfma_f32_16x16x32_bf16 v[40:43], v[56:59], v[168:171], v[40:43]
 ds_read_b64_tr_b16 v[74:75], v15 offset:2560
 ds_read_b128 v[244:247], v25 offset:27648
 v_add_u32 v15, s92, v2
 v_mfma_f32_16x16x32_bf16 v[40:43], v[60:63], v[188:191], v[40:43]
 ds_read_b128 v[208:211], v25 offset:18432
 ds_read_b128 v[228:231], v25 offset:23552
 v_mfma_f32_16x16x32_bf16 v[44:47], v[52:55], v[152:155], v[44:47]
 ds_read_b128 v[248:251], v25 offset:28672
 ds_read_b128 v[212:215], v25 offset:19456
 v_mfma_f32_16x16x32_bf16 v[44:47], v[56:59], v[172:175], v[44:47]
 s_waitcnt lgkmcnt(15)
 ds_read_b128 v[232:235], v25 offset:24576
 ds_read_b128 v[252:255], v25 offset:29696
 v_mfma_f32_16x16x32_bf16 v[44:47], v[60:63], v[192:195], v[44:47]
 buffer_load_dwordx4 v6, s[16:19], s32 offen offset:2048 lds
 v_mfma_f32_16x16x32_bf16 v[48:51], v[52:55], v[76:79], v[48:51]
 v_mfma_f32_16x16x32_bf16 v[48:51], v[56:59], v[80:83], v[48:51]
 s_waitcnt vmcnt(6) lgkmcnt(0)
 v_mfma_f32_16x16x32_bf16 v[48:51], v[60:63], v[84:87], v[48:51]
 s_barrier
 v_mfma_f32_16x16x32_bf16 v[28:31], v[64:67], v[196:199], v[28:31]
 s_mov_b32 m0, s93
 ds_read_b128 v[76:79], v3 offset:15360
 ds_write_b32 v13, v14 offset:0
 v_mfma_f32_16x16x32_bf16 v[28:31], v[68:71], v[216:219], v[28:31]
 s_add_u32 s32, s32, 331776
 ds_read_b128 v[80:83], v3 offset:16384
 ds_write_b32 v13, v14 offset:40
 v_mfma_f32_16x16x32_bf16 v[28:31], v[72:75], v[236:239], v[28:31]
 buffer_load_dwordx4 v4, s[16:19], s32 offen lds
 v_mfma_f32_16x16x32_bf16 v[32:35], v[64:67], v[200:203], v[32:35]
 s_add_u32 s93, s89, s92
 ds_read_b128 v[84:87], v3 offset:17408
 ds_write_b32 v13, v14 offset:80
 v_mfma_f32_16x16x32_bf16 v[32:35], v[68:71], v[220:223], v[32:35]
 s_add_u32 s91, s91, 1
 ds_read_b64_tr_b16 v[52:53], v15 offset:0
 ds_write_b32 v13, v14 offset:120
 v_mfma_f32_16x16x32_bf16 v[32:35], v[72:75], v[240:243], v[32:35]
 s_and_b32 s91, s91, 3
 ds_read_b64_tr_b16 v[54:55], v15 offset:512
 ds_write_b32 v13, v14 offset:160
 v_mfma_f32_16x16x32_bf16 v[36:39], v[64:67], v[204:207], v[36:39]
 s_mul_i32 s92, s91, 12288
 ds_read_b64_tr_b16 v[56:57], v15 offset:1024
 ds_write_b32 v13, v14 offset:200
 v_mfma_f32_16x16x32_bf16 v[36:39], v[68:71], v[224:227], v[36:39]
 ds_read_b64_tr_b16 v[58:59], v15 offset:1536
 ds_write_b32 v13, v14 offset:240
 v_mfma_f32_16x16x32_bf16 v[36:39], v[72:75], v[244:247], v[36:39]
 buffer_load_dwordx4 v5, s[16:19], s32 offen offset:1024 lds
 v_mfma_f32_16x16x32_bf16 v[40:43], v[64:67], v[208:211], v[40:43]
 ds_read_b64_tr_b16 v[60:61], v15 offset:2048
 v_readlane_b32 s47, v9, s53
 v_mfma_f32_16x16x32_bf16 v[40:43], v[68:71], v[228:231], v[40:43]
 s_add_u32 s53, s53, 1
 ds_read_b64_tr_b16 v[62:63], v15 offset:2560
 v_add_u32 v15, s92, v2
 v_mfma_f32_16x16x32_bf16 v[40:43], v[72:75], v[248:251], v[40:43]
 s_and_b32 s35, s47, 0xffff
 v_add_u32 v10, s35, v17
 v_cvt_pk_bf16_f32 v88, v28, v29
 v_mfma_f32_16x16x32_bf16 v[44:47], v[64:67], v[212:215], v[44:47]
 s_lshr_b32 s47, s47, 16
 ds_read_b64 v[10:11], v10
 v_cvt_pk_bf16_f32 v89, v30, v31
 v_mfma_f32_16x16x32_bf16 v[44:47], v[68:71], v[232:235], v[44:47]
 s_waitcnt lgkmcnt(12)
 v_cvt_pk_bf16_f32 v90, v32, v33
 v_cvt_pk_bf16_f32 v91, v34, v35
 v_mfma_f32_16x16x32_bf16 v[44:47], v[72:75], v[252:255], v[44:47]
 buffer_load_dwordx4 v6, s[16:19], s32 offen offset:2048 lds
 v_mfma_f32_16x16x32_bf16 v[48:51], v[64:67], v[76:79], v[48:51]
 v_cvt_pk_bf16_f32 v92, v36, v37
 v_cvt_pk_bf16_f32 v93, v38, v39
 v_mfma_f32_16x16x32_bf16 v[48:51], v[68:71], v[80:83], v[48:51]
 s_waitcnt vmcnt(6) lgkmcnt(1)
 v_cvt_pk_bf16_f32 v94, v40, v41
 v_cvt_pk_bf16_f32 v95, v42, v43
 v_mfma_f32_16x16x32_bf16 v[48:51], v[72:75], v[84:87], v[48:51]
 s_barrier
 v_mfma_f32_16x16x32_bf16 v[28:31], v[52:55], a[0:3], 0
 s_mov_b32 m0, s93
 ds_read_b128 v[76:79], v3 offset:0
 v_cvt_pk_bf16_f32 v96, v44, v45
 v_cvt_pk_bf16_f32 v97, v46, v47
 v_mfma_f32_16x16x32_bf16 v[28:31], v[56:59], a[20:23], v[28:31]
 s_add_u32 s32, s32, 331776
 ds_read_b128 v[80:83], v3 offset:1024
 v_mfma_f32_16x16x32_bf16 v[28:31], v[60:63], a[40:43], v[28:31]
 buffer_load_dwordx4 v4, s[16:19], s32 offen lds
 v_mfma_f32_16x16x32_bf16 v[32:35], v[52:55], a[4:7], 0
 s_add_u32 s93, s89, s92
 ds_read_b128 v[84:87], v3 offset:2048
 v_cvt_pk_bf16_f32 v98, v48, v49
 v_cvt_pk_bf16_f32 v99, v50, v51
 v_mfma_f32_16x16x32_bf16 v[32:35], v[56:59], a[24:27], v[32:35]
 s_add_u32 s91, s91, 1
 ds_read_b64_tr_b16 v[64:65], v15 offset:0
 v_mfma_f32_16x16x32_bf16 v[32:35], v[60:63], a[44:47], v[32:35]
 s_and_b32 s91, s91, 3
 ds_read_b64_tr_b16 v[66:67], v15 offset:512
 v_mfma_f32_16x16x32_bf16 v[36:39], v[52:55], a[8:11], 0
 s_mul_i32 s92, s91, 12288
 ds_read_b64_tr_b16 v[68:69], v15 offset:1024
 v_mfma_f32_16x16x32_bf16 v[36:39], v[56:59], a[28:31], v[36:39]
 ds_read_b64_tr_b16 v[70:71], v15 offset:1536
 v_mfma_f32_16x16x32_bf16 v[36:39], v[60:63], a[48:51], v[36:39]
 buffer_load_dwordx4 v5, s[16:19], s32 offen offset:1024 lds
 v_mfma_f32_16x16x32_bf16 v[40:43], v[52:55], a[12:15], 0
 ds_read_b64_tr_b16 v[72:73], v15 offset:2048
 v_mfma_f32_16x16x32_bf16 v[40:43], v[56:59], a[32:35], v[40:43]
 ds_read_b64_tr_b16 v[74:75], v15 offset:2560
 v_add_u32 v15, s92, v2
 v_mfma_f32_16x16x32_bf16 v[40:43], v[60:63], a[52:55], v[40:43]
 v_mfma_f32_16x16x32_bf16 v[44:47], v[52:55], a[16:19], 0
 v_mfma_f32_16x16x32_bf16 v[44:47], v[56:59], a[36:39], v[44:47]
 s_waitcnt lgkmcnt(6)
 v_mfma_f32_16x16x32_bf16 v[44:47], v[60:63], a[56:59], v[44:47]
 buffer_load_dwordx4 v6, s[16:19], s32 offen offset:2048 lds
 v_mfma_f32_16x16x32_bf16 v[48:51], v[52:55], v[76:79], 0
 v_mfma_f32_16x16x32_bf16 v[48:51], v[56:59], v[80:83], v[48:51]
 s_waitcnt vmcnt(6) lgkmcnt(0)
 v_mfma_f32_16x16x32_bf16 v[48:51], v[60:63], v[84:87], v[48:51]
 s_barrier
 v_mfma_f32_16x16x32_bf16 v[28:31], v[64:67], a[60:63], v[28:31]
 s_mov_b32 m0, s93
 ds_read_b128 v[76:79], v3 offset:3072
 v_add3_u32 v10, v10, s47, v16
 v_add3_u32 v11, v11, s47, v16
 v_mfma_f32_16x16x32_bf16 v[28:31], v[68:71], a[80:83], v[28:31]
 s_add_u32 s32, s32, 331776
 ds_read_b128 v[80:83], v3 offset:4096
 v_mfma_f32_16x16x32_bf16 v[28:31], v[72:75], a[100:103], v[28:31]
 buffer_load_dwordx4 v4, s[16:19], s32 offen lds
 v_mfma_f32_16x16x32_bf16 v[32:35], v[64:67], a[64:67], v[32:35]
 s_add_u32 s93, s89, s92
 ds_read_b128 v[84:87], v3 offset:5120
 v_mfma_f32_16x16x32_bf16 v[32:35], v[68:71], a[84:87], v[32:35]
 s_add_u32 s91, s91, 1
 ds_read_b64_tr_b16 v[52:53], v15 offset:0
 v_mfma_f32_16x16x32_bf16 v[32:35], v[72:75], a[104:107], v[32:35]
 s_and_b32 s91, s91, 3
 ds_read_b64_tr_b16 v[54:55], v15 offset:512
 v_mfma_f32_16x16x32_bf16 v[36:39], v[64:67], a[68:71], v[36:39]
 s_mul_i32 s92, s91, 12288
 ds_read_b64_tr_b16 v[56:57], v15 offset:1024
 v_mfma_f32_16x16x32_bf16 v[36:39], v[68:71], a[88:91], v[36:39]
 ds_read_b64_tr_b16 v[58:59], v15 offset:1536
 v_readlane_b32 s90, v12, s34
 v_mfma_f32_16x16x32_bf16 v[36:39], v[72:75], a[108:111], v[36:39]
 buffer_load_dwordx4 v5, s[16:19], s32 offen offset:1024 lds
 v_mfma_f32_16x16x32_bf16 v[40:43], v[64:67], a[72:75], v[40:43]
 ds_read_b64_tr_b16 v[60:61], v15 offset:2048
 v_mfma_f32_16x16x32_bf16 v[40:43], v[68:71], a[92:95], v[40:43]
 s_lshr_b32 s31, s90, 16
 ds_read_b64_tr_b16 v[62:63], v15 offset:2560
 v_add_u32 v15, s92, v2
 v_mfma_f32_16x16x32_bf16 v[40:43], v[72:75], a[112:115], v[40:43]
 ds_write_b32 v10, v88 offset:0
 v_mfma_f32_16x16x32_bf16 v[44:47], v[64:67], a[76:79], v[44:47]
 s_add_u32 s34, s34, 1
 ds_write_b32 v11, v89 offset:0
 v_mfma_f32_16x16x32_bf16 v[44:47], v[68:71], a[96:99], v[44:47]
 s_waitcnt lgkmcnt(8)
 ds_write_b32 v10, v90 offset:4480
 v_mfma_f32_16x16x32_bf16 v[44:47], v[72:75], a[116:119], v[44:47]
 buffer_load_dwordx4 v6, s[16:19], s32 offen offset:2048 lds
 v_mfma_f32_16x16x32_bf16 v[48:51], v[64:67], v[76:79], v[48:51]
 v_mfma_f32_16x16x32_bf16 v[48:51], v[68:71], v[80:83], v[48:51]
 s_waitcnt vmcnt(6) lgkmcnt(3)
 v_mad_u32_u24 v4, v8, s31, v7
 v_mfma_f32_16x16x32_bf16 v[48:51], v[72:75], v[84:87], v[48:51]
 s_barrier
 v_add_u32 v5, 109568, v4
 v_add_u32 v6, 219136, v4
 v_mfma_f32_16x16x32_bf16 v[28:31], v[52:55], a[120:123], v[28:31]
 s_mov_b32 m0, s93
 ds_read_b128 v[76:79], v3 offset:6144
 v_mfma_f32_16x16x32_bf16 v[28:31], v[56:59], a[140:143], v[28:31]
 s_and_b32 s32, s90, 0xffff
 ds_read_b128 v[80:83], v3 offset:7168
 v_mfma_f32_16x16x32_bf16 v[28:31], v[60:63], a[160:163], v[28:31]
 buffer_load_dwordx4 v4, s[16:19], s32 offen lds
 v_mfma_f32_16x16x32_bf16 v[32:35], v[52:55], a[124:127], v[32:35]
 s_add_u32 s93, s89, s92
 ds_read_b128 v[84:87], v3 offset:8192
 v_mfma_f32_16x16x32_bf16 v[32:35], v[56:59], a[144:147], v[32:35]
 s_add_u32 s91, s91, 1
 ds_read_b64_tr_b16 v[64:65], v15 offset:0
 v_mfma_f32_16x16x32_bf16 v[32:35], v[60:63], a[164:167], v[32:35]
 s_and_b32 s91, s91, 3
 ds_read_b64_tr_b16 v[66:67], v15 offset:512
 v_mfma_f32_16x16x32_bf16 v[36:39], v[52:55], a[128:131], v[36:39]
 s_mul_i32 s92, s91, 12288
 ds_read_b64_tr_b16 v[68:69], v15 offset:1024
 v_mfma_f32_16x16x32_bf16 v[36:39], v[56:59], a[148:151], v[36:39]
 ds_read_b64_tr_b16 v[70:71], v15 offset:1536
 v_mfma_f32_16x16x32_bf16 v[36:39], v[60:63], a[168:171], v[36:39]
 buffer_load_dwordx4 v5, s[16:19], s32 offen offset:1024 lds
 v_mfma_f32_16x16x32_bf16 v[40:43], v[52:55], a[132:135], v[40:43]
 ds_read_b64_tr_b16 v[72:73], v15 offset:2048
 v_mfma_f32_16x16x32_bf16 v[40:43], v[56:59], a[152:155], v[40:43]
 ds_read_b64_tr_b16 v[74:75], v15 offset:2560
 v_add_u32 v15, s92, v2
 v_mfma_f32_16x16x32_bf16 v[40:43], v[60:63], a[172:175], v[40:43]
 ds_write_b32 v11, v91 offset:4480
 v_mfma_f32_16x16x32_bf16 v[44:47], v[52:55], a[136:139], v[44:47]
 ds_write_b32 v10, v92 offset:8960
 v_mfma_f32_16x16x32_bf16 v[44:47], v[56:59], a[156:159], v[44:47]
 s_waitcnt lgkmcnt(8)
 ds_write_b32 v11, v93 offset:8960
 v_mfma_f32_16x16x32_bf16 v[44:47], v[60:63], a[176:179], v[44:47]
 buffer_load_dwordx4 v6, s[16:19], s32 offen offset:2048 lds
 v_mfma_f32_16x16x32_bf16 v[48:51], v[52:55], v[76:79], v[48:51]
 v_mfma_f32_16x16x32_bf16 v[48:51], v[56:59], v[80:83], v[48:51]
 s_waitcnt vmcnt(6) lgkmcnt(3)
 v_mfma_f32_16x16x32_bf16 v[48:51], v[60:63], v[84:87], v[48:51]
 s_barrier
 v_mfma_f32_16x16x32_bf16 v[28:31], v[64:67], a[180:183], v[28:31]
 s_mov_b32 m0, s93
 ds_read_b128 v[76:79], v3 offset:9216
 v_mfma_f32_16x16x32_bf16 v[28:31], v[68:71], a[200:203], v[28:31]
 s_add_u32 s32, s32, 331776
 ds_read_b128 v[80:83], v3 offset:10240
 v_mfma_f32_16x16x32_bf16 v[28:31], v[72:75], a[220:223], v[28:31]
 buffer_load_dwordx4 v4, s[16:19], s32 offen lds
 v_mfma_f32_16x16x32_bf16 v[32:35], v[64:67], a[184:187], v[32:35]
 s_add_u32 s93, s89, s92
 ds_read_b128 v[84:87], v3 offset:11264
 v_mfma_f32_16x16x32_bf16 v[32:35], v[68:71], a[204:207], v[32:35]
 s_add_u32 s91, s91, 1
 ds_read_b64_tr_b16 v[52:53], v15 offset:0
 v_mfma_f32_16x16x32_bf16 v[32:35], v[72:75], a[224:227], v[32:35]
 s_and_b32 s91, s91, 3
 ds_read_b64_tr_b16 v[54:55], v15 offset:512
 v_mfma_f32_16x16x32_bf16 v[36:39], v[64:67], a[188:191], v[36:39]
 s_mul_i32 s92, s91, 12288
 ds_read_b64_tr_b16 v[56:57], v15 offset:1024
 v_mfma_f32_16x16x32_bf16 v[36:39], v[68:71], a[208:211], v[36:39]
 ds_read_b64_tr_b16 v[58:59], v15 offset:1536
 v_mfma_f32_16x16x32_bf16 v[36:39], v[72:75], a[228:231], v[36:39]
 buffer_load_dwordx4 v5, s[16:19], s32 offen offset:1024 lds
 v_mfma_f32_16x16x32_bf16 v[40:43], v[64:67], a[192:195], v[40:43]
 ds_read_b64_tr_b16 v[60:61], v15 offset:2048
 v_mfma_f32_16x16x32_bf16 v[40:43], v[68:71], a[212:215], v[40:43]
 ds_read_b64_tr_b16 v[62:63], v15 offset:2560
 v_add_u32 v15, s92, v2
 v_mfma_f32_16x16x32_bf16 v[40:43], v[72:75], a[232:235], v[40:43]
 ds_write_b32 v10, v94 offset:13440
 v_mfma_f32_16x16x32_bf16 v[44:47], v[64:67], a[196:199], v[44:47]
 ds_write_b32 v11, v95 offset:13440
 v_mfma_f32_16x16x32_bf16 v[44:47], v[68:71], a[216:219], v[44:47]
 s_waitcnt lgkmcnt(8)
 ds_write_b32 v10, v96 offset:17920
 v_mfma_f32_16x16x32_bf16 v[44:47], v[72:75], a[236:239], v[44:47]
 buffer_load_dwordx4 v6, s[16:19], s32 offen offset:2048 lds
 v_mfma_f32_16x16x32_bf16 v[48:51], v[64:67], v[76:79], v[48:51]
 v_mfma_f32_16x16x32_bf16 v[48:51], v[68:71], v[80:83], v[48:51]
 s_waitcnt vmcnt(6) lgkmcnt(3)
 v_mfma_f32_16x16x32_bf16 v[48:51], v[72:75], v[84:87], v[48:51]
 s_barrier
 v_mfma_f32_16x16x32_bf16 v[28:31], v[52:55], a[240:243], v[28:31]
 s_mov_b32 m0, s93
 ds_read_b128 v[76:79], v3 offset:12288
 v_mfma_f32_16x16x32_bf16 v[28:31], v[56:59], v[156:159], v[28:31]
 s_add_u32 s32, s32, 331776
 ds_read_b128 v[80:83], v3 offset:13312
 v_mfma_f32_16x16x32_bf16 v[28:31], v[60:63], v[176:179], v[28:31]
 buffer_load_dwordx4 v4, s[16:19], s32 offen lds
 v_mfma_f32_16x16x32_bf16 v[32:35], v[52:55], a[244:247], v[32:35]
 s_add_u32 s93, s89, s92
 ds_read_b128 v[84:87], v3 offset:14336
 v_mfma_f32_16x16x32_bf16 v[32:35], v[56:59], v[160:163], v[32:35]
 s_add_u32 s91, s91, 1
 ds_read_b64_tr_b16 v[64:65], v15 offset:0
 v_mfma_f32_16x16x32_bf16 v[32:35], v[60:63], v[180:183], v[32:35]
 s_and_b32 s91, s91, 3
 ds_read_b64_tr_b16 v[66:67], v15 offset:512
 v_mfma_f32_16x16x32_bf16 v[36:39], v[52:55], a[248:251], v[36:39]
 s_mul_i32 s92, s91, 12288
 ds_read_b64_tr_b16 v[68:69], v15 offset:1024
 v_mfma_f32_16x16x32_bf16 v[36:39], v[56:59], v[164:167], v[36:39]
 ds_read_b64_tr_b16 v[70:71], v15 offset:1536
 v_mfma_f32_16x16x32_bf16 v[36:39], v[60:63], v[184:187], v[36:39]
 buffer_load_dwordx4 v5, s[16:19], s32 offen offset:1024 lds
 v_mfma_f32_16x16x32_bf16 v[40:43], v[52:55], a[252:255], v[40:43]
 ds_read_b64_tr_b16 v[72:73], v15 offset:2048
 v_mfma_f32_16x16x32_bf16 v[40:43], v[56:59], v[168:171], v[40:43]
 ds_read_b64_tr_b16 v[74:75], v15 offset:2560
 v_add_u32 v15, s92, v2
 v_mfma_f32_16x16x32_bf16 v[40:43], v[60:63], v[188:191], v[40:43]
 ds_write_b32 v11, v97 offset:17920
 v_mfma_f32_16x16x32_bf16 v[44:47], v[52:55], v[152:155], v[44:47]
 ds_write_b32 v10, v98 offset:22400
 v_mfma_f32_16x16x32_bf16 v[44:47], v[56:59], v[172:175], v[44:47]
 s_waitcnt lgkmcnt(8)
 ds_write_b32 v11, v99 offset:22400
 v_mfma_f32_16x16x32_bf16 v[44:47], v[60:63], v[192:195], v[44:47]
 buffer_load_dwordx4 v6, s[16:19], s32 offen offset:2048 lds
 v_mfma_f32_16x16x32_bf16 v[48:51], v[52:55], v[76:79], v[48:51]
 v_mfma_f32_16x16x32_bf16 v[48:51], v[56:59], v[80:83], v[48:51]
 s_waitcnt vmcnt(6) lgkmcnt(3)
 v_mfma_f32_16x16x32_bf16 v[48:51], v[60:63], v[84:87], v[48:51]
 s_barrier
 v_mfma_f32_16x16x32_bf16 v[28:31], v[64:67], v[196:199], v[28:31]
 s_mov_b32 m0, s93
 ds_read_b128 v[76:79], v3 offset:15360
 v_mfma_f32_16x16x32_bf16 v[28:31], v[68:71], v[216:219], v[28:31]
 s_add_u32 s32, s32, 331776
 ds_read_b128 v[80:83], v3 offset:16384
 v_mfma_f32_16x16x32_bf16 v[28:31], v[72:75], v[236:239], v[28:31]
 buffer_load_dwordx4 v4, s[16:19], s32 offen lds
 v_mfma_f32_16x16x32_bf16 v[32:35], v[64:67], v[200:203], v[32:35]
 s_add_u32 s93, s89, s92
 ds_read_b128 v[84:87], v3 offset:17408
 v_mfma_f32_16x16x32_bf16 v[32:35], v[68:71], v[220:223], v[32:35]
 s_add_u32 s91, s91, 1
 ds_read_b64_tr_b16 v[52:53], v15 offset:0
 v_mfma_f32_16x16x32_bf16 v[32:35], v[72:75], v[240:243], v[32:35]
 s_and_b32 s91, s91, 3
 ds_read_b64_tr_b16 v[54:55], v15 offset:512
 v_mfma_f32_16x16x32_bf16 v[36:39], v[64:67], v[204:207], v[36:39]
 s_mul_i32 s92, s91, 12288
 ds_read_b64_tr_b16 v[56:57], v15 offset:1024
 v_mfma_f32_16x16x32_bf16 v[36:39], v[68:71], v[224:227], v[36:39]
 ds_read_b64_tr_b16 v[58:59], v15 offset:1536
L_q:
 v_mfma_f32_16x16x32_bf16 v[36:39], v[72:75], v[244:247], v[36:39]
 buffer_load_dwordx4 v5, s[16:19], s32 offen offset:1024 lds
 v_mfma_f32_16x16x32_bf16 v[40:43], v[64:67], v[208:211], v[40:43]
 ds_read_b64_tr_b16 v[60:61], v15 offset:2048
 v_readlane_b32 s47, v9, s53
 v_mfma_f32_16x16x32_bf16 v[40:43], v[68:71], v[228:231], v[40:43]
 s_add_u32 s53, s53, 1
 ds_read_b64_tr_b16 v[62:63], v15 offset:2560
 v_add_u32 v15, s92, v2
 v_mfma_f32_16x16x32_bf16 v[40:43], v[72:75], v[248:251], v[40:43]
 s_and_b32 s35, s47, 0xffff
 v_add_u32 v10, s35, v17
 v_cvt_pk_bf16_f32 v88, v28, v29
 v_mfma_f32_16x16x32_bf16 v[44:47], v[64:67], v[212:215], v[44:47]
 s_lshr_b32 s47, s47, 16
 ds_read_b64 v[10:11], v10
 v_cvt_pk_bf16_f32 v89, v30, v31
 v_mfma_f32_16x16x32_bf16 v[44:47], v[68:71], v[232:235], v[44:47]
 s_waitcnt lgkmcnt(7)
 v_cvt_pk_bf16_f32 v90, v32, v33
 v_cvt_pk_bf16_f32 v91, v34, v35
 v_mfma_f32_16x16x32_bf16 v[44:47], v[72:75], v[252:255], v[44:47]
 buffer_load_dwordx4 v6, s[16:19], s32 offen offset:2048 lds
 v_mfma_f32_16x16x32_bf16 v[48:51], v[64:67], v[76:79], v[48:51]
 v_cvt_pk_bf16_f32 v92, v36, v37
 v_cvt_pk_bf16_f32 v93, v38, v39
 v_mfma_f32_16x16x32_bf16 v[48:51], v[68:71], v[80:83], v[48:51]
 s_waitcnt vmcnt(6) lgkmcnt(1)
 v_cvt_pk_bf16_f32 v94, v40, v41
 v_cvt_pk_bf16_f32 v95, v42, v43
 v_mfma_f32_16x16x32_bf16 v[48:51], v[72:75], v[84:87], v[48:51]
 s_barrier
 v_lshrrev_b32 v24, 2, v1
 v_add_u32 v24, s39, v24
 v_mfma_f32_16x16x32_bf16 v[28:31], v[52:55], a[0:3], 0
 s_mov_b32 m0, s93
 ds_read_b128 v[76:79], v3 offset:0
 v_cvt_pk_bf16_f32 v96, v44, v45
 v_mfma_f32_16x16x32_bf16 v[28:31], v[56:59], a[20:23], v[28:31]
 s_add_u32 s32, s32, 331776
 ds_read_b128 v[80:83], v3 offset:1024
 v_cvt_pk_bf16_f32 v97, v46, v47
 v_mfma_f32_16x16x32_bf16 v[28:31], v[60:63], a[40:43], v[28:31]
 buffer_load_dwordx4 v4, s[16:19], s32 offen lds
 v_mfma_f32_16x16x32_bf16 v[32:35], v[52:55], a[4:7], 0
 s_add_u32 s93, s89, s92
 ds_read_b128 v[84:87], v3 offset:2048
 v_cvt_pk_bf16_f32 v98, v48, v49
 v_mfma_f32_16x16x32_bf16 v[32:35], v[56:59], a[24:27], v[32:35]
 s_add_u32 s91, s91, 1
 ds_read_b64_tr_b16 v[64:65], v15 offset:0
 v_cvt_pk_bf16_f32 v99, v50, v51
 v_mfma_f32_16x16x32_bf16 v[32:35], v[60:63], a[44:47], v[32:35]
 s_and_b32 s91, s91, 3
 ds_read_b64_tr_b16 v[66:67], v15 offset:512
 v_mul_u32_u24 v25, 745, v24
 v_mfma_f32_16x16x32_bf16 v[36:39], v[52:55], a[8:11], 0
 s_mul_i32 s92, s91, 12288
 ds_read_b64_tr_b16 v[68:69], v15 offset:1024
 v_lshrrev_b32 v25, 14, v25
 v_mfma_f32_16x16x32_bf16 v[36:39], v[56:59], a[28:31], v[36:39]
 ds_read_b64_tr_b16 v[70:71], v15 offset:1536
 v_mul_u32_u24 v26, 22, v25
 v_mfma_f32_16x16x32_bf16 v[36:39], v[60:63], a[48:51], v[36:39]
 buffer_load_dwordx4 v5, s[16:19], s32 offen offset:1024 lds
 v_mfma_f32_16x16x32_bf16 v[40:43], v[52:55], a[12:15], 0
 ds_read_b64_tr_b16 v[72:73], v15 offset:2048
 v_sub_u32 v26, v24, v26
 v_mfma_f32_16x16x32_bf16 v[40:43], v[56:59], a[32:35], v[40:43]
 ds_read_b64_tr_b16 v[74:75], v15 offset:2560
 v_add_u32 v15, s92, v2
 v_mfma_f32_16x16x32_bf16 v[40:43], v[60:63], a[52:55], v[40:43]
 v_mul_u32_u24 v27, 37, v25
 v_lshrrev_b32 v27, 8, v27
 v_mfma_f32_16x16x32_bf16 v[44:47], v[52:55], a[16:19], 0
 v_mul_u32_u24 v27, 7, v27
 v_sub_u32 v27, v25, v27
 v_mfma_f32_16x16x32_bf16 v[44:47], v[56:59], a[36:39], v[44:47]
 s_waitcnt lgkmcnt(6)
 v_mul_u32_u24 v27, 40, v27
 v_and_b32 v24, 3, v1
 v_mfma_f32_16x16x32_bf16 v[44:47], v[60:63], a[56:59], v[44:47]
 buffer_load_dwordx4 v6, s[16:19], s32 offen offset:2048 lds
 v_mfma_f32_16x16x32_bf16 v[48:51], v[52:55], v[76:79], 0
 v_lshl_add_u32 v26, v26, 2, v24
 v_mul_u32_u24 v18, 280, v26
 v_mfma_f32_16x16x32_bf16 v[48:51], v[56:59], v[80:83], v[48:51]
 s_waitcnt vmcnt(6) lgkmcnt(0)
 v_add3_u32 v18, v18, v27, s54
 v_xor_b32 v25, s55, v25
 v_mfma_f32_16x16x32_bf16 v[48:51], v[60:63], v[84:87], v[48:51]
 s_barrier
 v_lshlrev_b32 v20, 4, v26
 v_lshl_add_u32 v20, v25, 16, v20
 v_mfma_f32_16x16x32_bf16 v[28:31], v[64:67], a[60:63], v[28:31]
 s_mov_b32 m0, s93
 ds_read_b128 v[76:79], v3 offset:3072
 v_add3_u32 v10, v10, s47, v16
 v_mfma_f32_16x16x32_bf16 v[28:31], v[68:71], a[80:83], v[28:31]
 s_add_u32 s32, s32, 331776
 ds_read_b128 v[80:83], v3 offset:4096
 v_add3_u32 v11, v11, s47, v16
 v_mfma_f32_16x16x32_bf16 v[28:31], v[72:75], a[100:103], v[28:31]
 buffer_load_dwordx4 v4, s[16:19], s32 offen lds
 v_mfma_f32_16x16x32_bf16 v[32:35], v[64:67], a[64:67], v[32:35]
 s_add_u32 s93, s89, s92
 ds_read_b128 v[84:87], v3 offset:5120
 v_lshlrev_b32 v21, 2, v26
 v_mfma_f32_16x16x32_bf16 v[32:35], v[68:71], a[84:87], v[32:35]
 s_add_u32 s91, s91, 1
 ds_read_b64_tr_b16 v[52:53], v15 offset:0
 v_lshl_add_u32 v21, v25, 13, v21
 v_mfma_f32_16x16x32_bf16 v[32:35], v[72:75], a[104:107], v[32:35]
 s_and_b32 s91, s91, 3
 ds_read_b64_tr_b16 v[54:55], v15 offset:512
 v_cmp_gt_u32 vcc, s86, v26
 v_mfma_f32_16x16x32_bf16 v[36:39], v[64:67], a[68:71], v[36:39]
 s_mul_i32 s92, s91, 12288
 ds_read_b64_tr_b16 v[56:57], v15 offset:1024
 v_bfrev_b32 v27, 2
 v_mfma_f32_16x16x32_bf16 v[36:39], v[68:71], a[88:91], v[36:39]
 ds_read_b64_tr_b16 v[58:59], v15 offset:1536
 v_readlane_b32 s90, v12, s34
 v_mfma_f32_16x16x32_bf16 v[36:39], v[72:75], a[108:111], v[36:39]
 buffer_load_dwordx4 v5, s[16:19], s32 offen offset:1024 lds
 v_mfma_f32_16x16x32_bf16 v[40:43], v[64:67], a[72:75], v[40:43]
 ds_read_b64_tr_b16 v[60:61], v15 offset:2048
 v_cndmask_b32 v20, v27, v20, vcc
 v_mfma_f32_16x16x32_bf16 v[40:43], v[68:71], a[92:95], v[40:43]
 s_lshr_b32 s31, s90, 16
 ds_read_b64_tr_b16 v[62:63], v15 offset:2560
 v_add_u32 v15, s92, v2
 v_mfma_f32_16x16x32_bf16 v[40:43], v[72:75], a[112:115], v[40:43]
 ds_write_b32 v10, v88 offset:0
 v_mfma_f32_16x16x32_bf16 v[44:47], v[64:67], a[76:79], v[44:47]
 s_add_u32 s34, s34, 1
 ds_write_b32 v11, v89 offset:0
 v_mfma_f32_16x16x32_bf16 v[44:47], v[68:71], a[96:99], v[44:47]
 s_waitcnt lgkmcnt(8)
 ds_write_b32 v10, v90 offset:4480
 v_mfma_f32_16x16x32_bf16 v[44:47], v[72:75], a[116:119], v[44:47]
 buffer_load_dwordx4 v6, s[16:19], s32 offen offset:2048 lds
 v_mfma_f32_16x16x32_bf16 v[48:51], v[64:67], v[76:79], v[48:51]
 v_cndmask_b32 v21, v27, v21, vcc
 v_lshrrev_b32 v25, 4, v1
 v_mfma_f32_16x16x32_bf16 v[48:51], v[68:71], v[80:83], v[48:51]
 s_waitcnt vmcnt(6) lgkmcnt(3)
 v_mad_u32_u24 v4, v8, s31, v7
 v_lshl_add_u32 v24, v25, 2, v24
 v_mfma_f32_16x16x32_bf16 v[48:51], v[72:75], v[84:87], v[48:51]
 s_barrier
 v_add_u32 v5, 109568, v4
 v_add_u32 v6, 219136, v4
 v_mfma_f32_16x16x32_bf16 v[28:31], v[52:55], a[120:123], v[28:31]
 s_mov_b32 m0, s93
 ds_read_b128 v[76:79], v3 offset:6144
 v_add_u32 v24, s39, v24
 v_mfma_f32_16x16x32_bf16 v[28:31], v[56:59], a[140:143], v[28:31]
 s_and_b32 s32, s90, 0xffff
 ds_read_b128 v[80:83], v3 offset:7168
 v_mul_u32_u24 v25, 745, v24
 v_mfma_f32_16x16x32_bf16 v[28:31], v[60:63], a[160:163], v[28:31]
 buffer_load_dwordx4 v4, s[16:19], s32 offen lds
 v_mfma_f32_16x16x32_bf16 v[32:35], v[52:55], a[124:127], v[32:35]
 s_add_u32 s93, s89, s92
 ds_read_b128 v[84:87], v3 offset:8192
 v_lshrrev_b32 v25, 14, v25
 v_mfma_f32_16x16x32_bf16 v[32:35], v[56:59], a[144:147], v[32:35]
 s_add_u32 s91, s91, 1
 ds_read_b64_tr_b16 v[64:65], v15 offset:0
 v_mul_u32_u24 v26, 22, v25
 v_mfma_f32_16x16x32_bf16 v[32:35], v[60:63], a[164:167], v[32:35]
 s_and_b32 s91, s91, 3
 ds_read_b64_tr_b16 v[66:67], v15 offset:512
 v_sub_u32 v26, v24, v26
 v_mfma_f32_16x16x32_bf16 v[36:39], v[52:55], a[128:131], v[36:39]
 s_mul_i32 s92, s91, 12288
 ds_read_b64_tr_b16 v[68:69], v15 offset:1024
 v_mul_u32_u24 v27, 37, v25
 v_mfma_f32_16x16x32_bf16 v[36:39], v[56:59], a[148:151], v[36:39]
 ds_read_b64_tr_b16 v[70:71], v15 offset:1536
 v_lshrrev_b32 v27, 8, v27
 v_mfma_f32_16x16x32_bf16 v[36:39], v[60:63], a[168:171], v[36:39]
 buffer_load_dwordx4 v5, s[16:19], s32 offen offset:1024 lds
 v_mfma_f32_16x16x32_bf16 v[40:43], v[52:55], a[132:135], v[40:43]
 ds_read_b64_tr_b16 v[72:73], v15 offset:2048
 v_mul_u32_u24 v27, 7, v27
 v_mfma_f32_16x16x32_bf16 v[40:43], v[56:59], a[152:155], v[40:43]
 ds_read_b64_tr_b16 v[74:75], v15 offset:2560
 v_add_u32 v15, s92, v2
 v_mfma_f32_16x16x32_bf16 v[40:43], v[60:63], a[172:175], v[40:43]
 ds_write_b32 v11, v91 offset:4480
 v_mfma_f32_16x16x32_bf16 v[44:47], v[52:55], a[136:139], v[44:47]
 ds_write_b32 v10, v92 offset:8960
 v_mfma_f32_16x16x32_bf16 v[44:47], v[56:59], a[156:159], v[44:47]
 s_waitcnt lgkmcnt(8)
 ds_write_b32 v11, v93 offset:8960
 v_mfma_f32_16x16x32_bf16 v[44:47], v[60:63], a[176:179], v[44:47]
 buffer_load_dwordx4 v6, s[16:19], s32 offen offset:2048 lds
 v_mfma_f32_16x16x32_bf16 v[48:51], v[52:55], v[76:79], v[48:51]
 v_sub_u32 v27, v25, v27
 v_mul_u32_u24 v27, 40, v27
 v_mfma_f32_16x16x32_bf16 v[48:51], v[56:59], v[80:83], v[48:51]
 s_waitcnt vmcnt(6) lgkmcnt(3)
 v_bfe_u32 v24, v1, 2, 2
 v_lshl_add_u32 v26, v26, 2, v24
 v_mfma_f32_16x16x32_bf16 v[48:51], v[60:63], v[84:87], v[48:51]
 s_barrier
 v_mul_u32_u24 v19, 280, v26
 v_add3_u32 v19, v19, v27, s54
 v_mfma_f32_16x16x32_bf16 v[28:31], v[64:67], a[180:183], v[28:31]
 s_mov_b32 m0, s93
 ds_read_b128 v[76:79], v3 offset:9216
 v_mfma_f32_16x16x32_bf16 v[28:31], v[68:71], a[200:203], v[28:31]
 s_add_u32 s32, s32, 331776
 ds_read_b128 v[80:83], v3 offset:10240
 v_mfma_f32_16x16x32_bf16 v[28:31], v[72:75], a[220:223], v[28:31]
 buffer_load_dwordx4 v4, s[16:19], s32 offen lds
 v_mfma_f32_16x16x32_bf16 v[32:35], v[64:67], a[184:187], v[32:35]
 s_add_u32 s93, s89, s92
 ds_read_b128 v[84:87], v3 offset:11264
 v_mfma_f32_16x16x32_bf16 v[32:35], v[68:71], a[204:207], v[32:35]
 s_add_u32 s91, s91, 1
 ds_read_b64_tr_b16 v[52:53], v15 offset:0
 v_mfma_f32_16x16x32_bf16 v[32:35], v[72:75], a[224:227], v[32:35]
 s_and_b32 s91, s91, 3
 ds_read_b64_tr_b16 v[54:55], v15 offset:512
 v_mfma_f32_16x16x32_bf16 v[36:39], v[64:67], a[188:191], v[36:39]
 s_mul_i32 s92, s91, 12288
 ds_read_b64_tr_b16 v[56:57], v15 offset:1024
 v_mfma_f32_16x16x32_bf16 v[36:39], v[68:71], a[208:211], v[36:39]
 ds_read_b64_tr_b16 v[58:59], v15 offset:1536
 v_mfma_f32_16x16x32_bf16 v[36:39], v[72:75], a[228:231], v[36:39]
 buffer_load_dwordx4 v5, s[16:19], s32 offen offset:1024 lds
 v_mfma_f32_16x16x32_bf16 v[40:43], v[64:67], a[192:195], v[40:43]
 ds_read_b64_tr_b16 v[60:61], v15 offset:2048
 v_mfma_f32_16x16x32_bf16 v[40:43], v[68:71], a[212:215], v[40:43]
 ds_read_b64_tr_b16 v[62:63], v15 offset:2560
 v_add_u32 v15, s92, v2
 v_mfma_f32_16x16x32_bf16 v[40:43], v[72:75], a[232:235], v[40:43]
 ds_write_b32 v10, v94 offset:13440
 v_mfma_f32_16x16x32_bf16 v[44:47], v[64:67], a[196:199], v[44:47]
 ds_write_b32 v11, v95 offset:13440
 v_mfma_f32_16x16x32_bf16 v[44:47], v[68:71], a[216:219], v[44:47]
 s_waitcnt lgkmcnt(8)
 ds_write_b32 v10, v96 offset:17920
 v_mfma_f32_16x16x32_bf16 v[44:47], v[72:75], a[236:239], v[44:47]
 buffer_load_dwordx4 v6, s[16:19], s32 offen offset:2048 lds
 v_mfma_f32_16x16x32_bf16 v[48:51], v[64:67], v[76:79], v[48:51]
 v_mfma_f32_16x16x32_bf16 v[48:51], v[68:71], v[80:83], v[48:51]
 s_waitcnt vmcnt(6) lgkmcnt(3)
 v_mfma_f32_16x16x32_bf16 v[48:51], v[72:75], v[84:87], v[48:51]
 s_barrier
 v_mfma_f32_16x16x32_bf16 v[28:31], v[52:55], a[240:243], v[28:31]
 s_mov_b32 m0, s93
 ds_read_b128 v[76:79], v3 offset:12288
 v_mfma_f32_16x16x32_bf16 v[28:31], v[56:59], v[156:159], v[28:31]
 s_add_u32 s32, s32, 331776
 ds_read_b128 v[80:83], v3 offset:13312
 v_mfma_f32_16x16x32_bf16 v[28:31], v[60:63], v[176:179], v[28:31]
 buffer_load_dwordx4 v4, s[16:19], s32 offen lds
 v_mfma_f32_16x16x32_bf16 v[32:35], v[52:55], a[244:247], v[32:35]
 s_add_u32 s93, s89, s92
 ds_read_b128 v[84:87], v3 offset:14336
 v_mfma_f32_16x16x32_bf16 v[32:35], v[56:59], v[160:163], v[32:35]
 s_add_u32 s91, s91, 1
 ds_read_b64_tr_b16 v[64:65], v15 offset:0
 v_mfma_f32_16x16x32_bf16 v[32:35], v[60:63], v[180:183], v[32:35]
 s_and_b32 s91, s91, 3
 ds_read_b64_tr_b16 v[66:67], v15 offset:512
 v_mfma_f32_16x16x32_bf16 v[36:39], v[52:55], a[248:251], v[36:39]
 s_mul_i32 s92, s91, 12288
 ds_read_b64_tr_b16 v[68:69], v15 offset:1024
 v_mfma_f32_16x16x32_bf16 v[36:39], v[56:59], v[164:167], v[36:39]
 ds_read_b64_tr_b16 v[70:71], v15 offset:1536
 v_mfma_f32_16x16x32_bf16 v[36:39], v[60:63], v[184:187], v[36:39]
 buffer_load_dwordx4 v5, s[16:19], s32 offen offset:1024 lds
 v_mfma_f32_16x16x32_bf16 v[40:43], v[52:55], a[252:255], v[40:43]
 ds_read_b64_tr_b16 v[72:73], v15 offset:2048
 v_mfma_f32_16x16x32_bf16 v[40:43], v[56:59], v[168:171], v[40:43]
 ds_read_b64_tr_b16 v[74:75], v15 offset:2560
 v_add_u32 v15, s92, v2
 v_mfma_f32_16x16x32_bf16 v[40:43], v[60:63], v[188:191], v[40:43]
 ds_write_b32 v11, v97 offset:17920
 v_mfma_f32_16x16x32_bf16 v[44:47], v[52:55], v[152:155], v[44:47]
 ds_write_b32 v10, v98 offset:22400
 v_mfma_f32_16x16x32_bf16 v[44:47], v[56:59], v[172:175], v[44:47]
 s_waitcnt lgkmcnt(8)
 ds_write_b32 v11, v99 offset:22400
 v_mfma_f32_16x16x32_bf16 v[44:47], v[60:63], v[192:195], v[44:47]
 buffer_load_dwordx4 v6, s[16:19], s32 offen offset:2048 lds
 v_mfma_f32_16x16x32_bf16 v[48:51], v[52:55], v[76:79], v[48:51]
 v_mfma_f32_16x16x32_bf16 v[48:51], v[56:59], v[80:83], v[48:51]
 s_waitcnt vmcnt(6) lgkmcnt(3)
 v_mfma_f32_16x16x32_bf16 v[48:51], v[60:63], v[84:87], v[48:51]
 s_barrier
 v_mfma_f32_16x16x32_bf16 v[28:31], v[64:67], v[196:199], v[28:31]
 s_mov_b32 m0, s93
 ds_read_b128 v[76:79], v3 offset:15360
 v_mfma_f32_16x16x32_bf16 v[28:31], v[68:71], v[216:219], v[28:31]
 s_add_u32 s32, s32, 331776
 ds_read_b128 v[80:83], v3 offset:16384
 v_mfma_f32_16x16x32_bf16 v[28:31], v[72:75], v[236:239], v[28:31]
 buffer_load_dwordx4 v4, s[16:19], s32 offen lds
 v_mfma_f32_16x16x32_bf16 v[32:35], v[64:67], v[200:203], v[32:35]
 s_add_u32 s93, s89, s92
 ds_read_b128 v[84:87], v3 offset:17408
 v_mfma_f32_16x16x32_bf16 v[32:35], v[68:71], v[220:223], v[32:35]
 s_add_u32 s91, s91, 1
 ds_read_b64_tr_b16 v[52:53], v15 offset:0
 v_mfma_f32_16x16x32_bf16 v[32:35], v[72:75], v[240:243], v[32:35]
 s_and_b32 s91, s91, 3
 ds_read_b64_tr_b16 v[54:55], v15 offset:512
 v_mfma_f32_16x16x32_bf16 v[36:39], v[64:67], v[204:207], v[36:39]
 s_mul_i32 s92, s91, 12288
 ds_read_b64_tr_b16 v[56:57], v15 offset:1024
 v_mfma_f32_16x16x32_bf16 v[36:39], v[68:71], v[224:227], v[36:39]
 ds_read_b64_tr_b16 v[58:59], v15 offset:1536
 v_mfma_f32_16x16x32_bf16 v[36:39], v[72:75], v[244:247], v[36:39]
 buffer_load_dwordx4 v5, s[16:19], s32 offen offset:1024 lds
 v_mfma_f32_16x16x32_bf16 v[40:43], v[64:67], v[208:211], v[40:43]
 ds_read_b64_tr_b16 v[60:61], v15 offset:2048
 v_readlane_b32 s47, v9, s53
 v_mfma_f32_16x16x32_bf16 v[40:43], v[68:71], v[228:231], v[40:43]
 s_add_u32 s53, s53, 1
 ds_read_b64_tr_b16 v[62:63], v15 offset:2560
 v_add_u32 v15, s92, v2
 v_mfma_f32_16x16x32_bf16 v[40:43], v[72:75], v[248:251], v[40:43]
 s_and_b32 s35, s47, 0xffff
 v_add_u32 v10, s35, v17
 v_cvt_pk_bf16_f32 v88, v28, v29
 v_mfma_f32_16x16x32_bf16 v[44:47], v[64:67], v[212:215], v[44:47]
 s_lshr_b32 s47, s47, 16
 ds_read_b64 v[10:11], v10
 v_cvt_pk_bf16_f32 v89, v30, v31
 v_mfma_f32_16x16x32_bf16 v[44:47], v[68:71], v[232:235], v[44:47]
 s_waitcnt lgkmcnt(7)
 v_cvt_pk_bf16_f32 v90, v32, v33
 v_cvt_pk_bf16_f32 v91, v34, v35
 v_mfma_f32_16x16x32_bf16 v[44:47], v[72:75], v[252:255], v[44:47]
 buffer_load_dwordx4 v6, s[16:19], s32 offen offset:2048 lds
 v_mfma_f32_16x16x32_bf16 v[48:51], v[64:67], v[76:79], v[48:51]
 v_cvt_pk_bf16_f32 v92, v36, v37
 v_cvt_pk_bf16_f32 v93, v38, v39
 v_mfma_f32_16x16x32_bf16 v[48:51], v[68:71], v[80:83], v[48:51]
 s_waitcnt vmcnt(6) lgkmcnt(1)
 v_cvt_pk_bf16_f32 v94, v40, v41
 v_cvt_pk_bf16_f32 v95, v42, v43
 v_mfma_f32_16x16x32_bf16 v[48:51], v[72:75], v[84:87], v[48:51]
 s_barrier
 v_mfma_f32_16x16x32_bf16 v[28:31], v[52:55], a[0:3], 0
 s_mov_b32 m0, s93
 ds_read_b128 v[76:79], v3 offset:0
 ds_read_b64 v[100:101], v18 offset:2240
 v_cvt_pk_bf16_f32 v96, v44, v45
 v_cvt_pk_bf16_f32 v97, v46, v47
 v_mfma_f32_16x16x32_bf16 v[28:31], v[56:59], a[20:23], v[28:31]
 s_add_u32 s32, s32, 331776
 ds_read_b128 v[80:83], v3 offset:1024
 ds_read_b64 v[110:111], v18 offset:26880
 v_mfma_f32_16x16x32_bf16 v[28:31], v[60:63], a[40:43], v[28:31]
 buffer_load_dwordx4 v4, s[16:19], s32 offen lds
 v_mfma_f32_16x16x32_bf16 v[32:35], v[52:55], a[4:7], 0
 s_add_u32 s93, s89, s92
 ds_read_b128 v[84:87], v3 offset:2048
 ds_read_b64 v[120:121], v18 offset:28000
 v_mfma_f32_16x16x32_bf16 v[32:35], v[56:59], a[24:27], v[32:35]
 s_add_u32 s91, s91, 1
 ds_read_b64_tr_b16 v[64:65], v15 offset:0
 ds_read_b64 v[130:131], v18 offset:29120
 v_mfma_f32_16x16x32_bf16 v[32:35], v[60:63], a[44:47], v[32:35]
 s_and_b32 s91, s91, 3
 ds_read_b64_tr_b16 v[66:67], v15 offset:512
 ds_read_b64 v[102:103], v18 offset:2248
 v_mfma_f32_16x16x32_bf16 v[36:39], v[52:55], a[8:11], 0
 s_mul_i32 s92, s91, 12288
 ds_read_b64_tr_b16 v[68:69], v15 offset:1024
 ds_read_b64 v[112:113], v18 offset:26888
 v_mfma_f32_16x16x32_bf16 v[36:39], v[56:59], a[28:31], v[36:39]
 ds_read_b64_tr_b16 v[70:71], v15 offset:1536
 ds_read_b64 v[122:123], v18 offset:28008
 v_mfma_f32_16x16x32_bf16 v[36:39], v[60:63], a[48:51], v[36:39]
 buffer_load_dwordx4 v5, s[16:19], s32 offen offset:1024 lds
 v_mfma_f32_16x16x32_bf16 v[40:43], v[52:55], a[12:15], 0
 ds_read_b64_tr_b16 v[72:73], v15 offset:2048
 ds_read_b64 v[132:133], v18 offset:29128
 v_mfma_f32_16x16x32_bf16 v[40:43], v[56:59], a[32:35], v[40:43]
 ds_read_b64_tr_b16 v[74:75], v15 offset:2560
 ds_read_b64 v[104:105], v18 offset:2256
 v_add_u32 v15, s92, v2
 v_mfma_f32_16x16x32_bf16 v[40:43], v[60:63], a[52:55], v[40:43]
 ds_read_b64 v[114:115], v18 offset:26896
 v_mov_b32 v109, 0x3f80
 v_mfma_f32_16x16x32_bf16 v[44:47], v[52:55], a[16:19], 0
 ds_read_b64 v[124:125], v18 offset:28016
 v_cvt_pk_bf16_f32 v98, v48, v49
 v_mfma_f32_16x16x32_bf16 v[44:47], v[56:59], a[36:39], v[44:47]
 s_waitcnt lgkmcnt(15)
 ds_read_b64 v[134:135], v18 offset:29136
 v_cvt_pk_bf16_f32 v99, v50, v51
 v_mfma_f32_16x16x32_bf16 v[44:47], v[60:63], a[56:59], v[44:47]
 buffer_load_dwordx4 v6, s[16:19], s32 offen offset:2048 lds
 v_mfma_f32_16x16x32_bf16 v[48:51], v[52:55], v[76:79], 0
 ds_read_b64 v[106:107], v18 offset:2264
 v_mfma_f32_16x16x32_bf16 v[48:51], v[56:59], v[80:83], v[48:51]
 s_waitcnt vmcnt(6) lgkmcnt(5)
 ds_read_b64 v[116:117], v18 offset:26904
 v_mfma_f32_16x16x32_bf16 v[48:51], v[60:63], v[84:87], v[48:51]
 s_barrier
 ds_read_b64 v[126:127], v18 offset:28024
 v_mfma_f32_16x16x32_bf16 v[28:31], v[64:67], a[60:63], v[28:31]
 s_mov_b32 m0, s93
 ds_read_b128 v[76:79], v3 offset:3072
 ds_read_b64 v[136:137], v18 offset:29144
 v_add3_u32 v10, v10, s47, v16
 v_add3_u32 v11, v11, s47, v16
 v_mfma_f32_16x16x32_bf16 v[28:31], v[68:71], a[80:83], v[28:31]
 s_add_u32 s32, s32, 331776
 ds_read_b128 v[80:83], v3 offset:4096
 ds_read_b32 v108, v18 offset:2272
 v_mfma_f32_16x16x32_bf16 v[28:31], v[72:75], a[100:103], v[28:31]
 buffer_load_dwordx4 v4, s[16:19], s32 offen lds
 v_mfma_f32_16x16x32_bf16 v[32:35], v[64:67], a[64:67], v[32:35]
 s_add_u32 s93, s89, s92
 ds_read_b128 v[84:87], v3 offset:5120
 v_mfma_f32_16x16x32_bf16 v[32:35], v[68:71], a[84:87], v[32:35]
 s_add_u32 s91, s91, 1
 ds_read_b64_tr_b16 v[52:53], v15 offset:0
 v_mfma_f32_16x16x32_bf16 v[32:35], v[72:75], a[104:107], v[32:35]
 s_and_b32 s91, s91, 3
 ds_read_b64_tr_b16 v[54:55], v15 offset:512
 v_mfma_f32_16x16x32_bf16 v[36:39], v[64:67], a[68:71], v[36:39]
 s_mul_i32 s92, s91, 12288
 ds_read_b64_tr_b16 v[56:57], v15 offset:1024
 v_mfma_f32_16x16x32_bf16 v[36:39], v[68:71], a[88:91], v[36:39]
 ds_read_b64_tr_b16 v[58:59], v15 offset:1536
 v_readlane_b32 s90, v12, s34
 v_mfma_f32_16x16x32_bf16 v[36:39], v[72:75], a[108:111], v[36:39]
 buffer_load_dwordx4 v5, s[16:19], s32 offen offset:1024 lds
 v_mfma_f32_16x16x32_bf16 v[40:43], v[64:67], a[72:75], v[40:43]
 ds_read_b64_tr_b16 v[60:61], v15 offset:2048
 v_mfma_f32_16x16x32_bf16 v[40:43], v[68:71], a[92:95], v[40:43]
 s_lshr_b32 s31, s90, 16
 ds_read_b64_tr_b16 v[62:63], v15 offset:2560
 v_add_u32 v15, s92, v2
 v_mfma_f32_16x16x32_bf16 v[40:43], v[72:75], a[112:115], v[40:43]
 ds_write_b32 v10, v88 offset:0
 v_mfma_f32_16x16x32_bf16 v[44:47], v[64:67], a[76:79], v[44:47]
 s_add_u32 s34, s34, 1
 ds_write_b32 v11, v89 offset:0
 v_mfma_f32_16x16x32_bf16 v[44:47], v[68:71], a[96:99], v[44:47]
 s_waitcnt lgkmcnt(8)
 ds_write_b32 v10, v90 offset:4480
 v_mfma_f32_16x16x32_bf16 v[44:47], v[72:75], a[116:119], v[44:47]
 buffer_load_dwordx4 v6, s[16:19], s32 offen offset:2048 lds
 v_mfma_f32_16x16x32_bf16 v[48:51], v[64:67], v[76:79], v[48:51]
 ds_read_b64 v[118:119], v18 offset:26912
 v_mfma_f32_16x16x32_bf16 v[48:51], v[68:71], v[80:83], v[48:51]
 s_waitcnt vmcnt(6) lgkmcnt(4)
 ds_read_b64 v[128:129], v18 offset:28032
 v_mad_u32_u24 v4, v8, s31, v7
 v_mfma_f32_16x16x32_bf16 v[48:51], v[72:75], v[84:87], v[48:51]
 s_barrier
 ds_read_b64 v[138:139], v18 offset:29152
 v_add_u32 v5, 109568, v4
 v_add_u32 v6, 219136, v4
 v_mfma_f32_16x16x32_bf16 v[28:31], v[52:55], a[120:123], v[28:31]
 s_mov_b32 m0, s93
 ds_read_b128 v[76:79], v3 offset:6144
 v_mfma_f32_16x16x32_bf16 v[28:31], v[56:59], a[140:143], v[28:31]
 s_and_b32 s32, s90, 0xffff
 ds_read_b128 v[80:83], v3 offset:7168
 v_mfma_f32_16x16x32_bf16 v[28:31], v[60:63], a[160:163], v[28:31]
 buffer_load_dwordx4 v4, s[16:19], s32 offen lds
 v_mfma_f32_16x16x32_bf16 v[32:35], v[52:55], a[124:127], v[32:35]
 s_add_u32 s93, s89, s92
 ds_read_b128 v[84:87], v3 offset:8192
 v_mfma_f32_16x16x32_bf16 v[32:35], v[56:59], a[144:147], v[32:35]
 s_add_u32 s91, s91, 1
 ds_read_b64_tr_b16 v[64:65], v15 offset:0
 v_mfma_f32_16x16x32_bf16 v[32:35], v[60:63], a[164:167], v[32:35]
 s_and_b32 s91, s91, 3
 ds_read_b64_tr_b16 v[66:67], v15 offset:512
 v_mfma_f32_16x16x32_bf16 v[36:39], v[52:55], a[128:131], v[36:39]
 s_mul_i32 s92, s91, 12288
 ds_read_b64_tr_b16 v[68:69], v15 offset:1024
 v_mfma_f32_16x16x32_bf16 v[36:39], v[56:59], a[148:151], v[36:39]
 ds_read_b64_tr_b16 v[70:71], v15 offset:1536
 v_mfma_f32_16x16x32_bf16 v[36:39], v[60:63], a[168:171], v[36:39]
 buffer_load_dwordx4 v5, s[16:19], s32 offen offset:1024 lds
 v_mfma_f32_16x16x32_bf16 v[40:43], v[52:55], a[132:135], v[40:43]
 ds_read_b64_tr_b16 v[72:73], v15 offset:2048
 v_mfma_f32_16x16x32_bf16 v[40:43], v[56:59], a[152:155], v[40:43]
 ds_read_b64_tr_b16 v[74:75], v15 offset:2560
 v_add_u32 v15, s92, v2
 v_mfma_f32_16x16x32_bf16 v[40:43], v[60:63], a[172:175], v[40:43]
 ds_write_b32 v11, v91 offset:4480
 v_mfma_f32_16x16x32_bf16 v[44:47], v[52:55], a[136:139], v[44:47]
 ds_write_b32 v10, v92 offset:8960
 v_mfma_f32_16x16x32_bf16 v[44:47], v[56:59], a[156:159], v[44:47]
 s_waitcnt lgkmcnt(8)
 ds_write_b32 v11, v93 offset:8960
 v_mfma_f32_16x16x32_bf16 v[44:47], v[60:63], a[176:179], v[44:47]
 buffer_load_dwordx4 v6, s[16:19], s32 offen offset:2048 lds
 v_mfma_f32_16x16x32_bf16 v[48:51], v[52:55], v[76:79], v[48:51]
 s_nop 0
 v_mfma_f32_4x4x4_16b_bf16 v[140:143], v[110:111], v[100:101], 0
 v_mfma_f32_4x4x4_16b_bf16 v[144:147], v[120:121], v[100:101], 0
 v_mfma_f32_4x4x4_16b_bf16 v[148:151], v[130:131], v[100:101], 0
 v_mfma_f32_4x4x4_16b_bf16 v[140:143], v[112:113], v[102:103], v[140:143]
 v_mfma_f32_4x4x4_16b_bf16 v[144:147], v[122:123], v[102:103], v[144:147]
 v_mfma_f32_4x4x4_16b_bf16 v[148:151], v[132:133], v[102:103], v[148:151]
 v_mfma_f32_4x4x4_16b_bf16 v[140:143], v[114:115], v[104:105], v[140:143]
 v_mfma_f32_4x4x4_16b_bf16 v[144:147], v[124:125], v[104:105], v[144:147]
 v_mfma_f32_4x4x4_16b_bf16 v[148:151], v[134:135], v[104:105], v[148:151]
 v_mfma_f32_4x4x4_16b_bf16 v[140:143], v[116:117], v[106:107], v[140:143]
 v_mfma_f32_4x4x4_16b_bf16 v[144:147], v[126:127], v[106:107], v[144:147]
 v_mfma_f32_4x4x4_16b_bf16 v[148:151], v[136:137], v[106:107], v[148:151]
 v_mfma_f32_4x4x4_16b_bf16 v[140:143], v[118:119], v[108:109], v[140:143]
 v_mfma_f32_4x4x4_16b_bf16 v[144:147], v[128:129], v[108:109], v[144:147]
 v_mfma_f32_4x4x4_16b_bf16 v[148:151], v[138:139], v[108:109], v[148:151]
 v_mfma_f32_16x16x32_bf16 v[48:51], v[56:59], v[80:83], v[48:51]
 s_waitcnt vmcnt(6) lgkmcnt(3)
 v_mfma_f32_16x16x32_bf16 v[48:51], v[60:63], v[84:87], v[48:51]
 s_barrier
 v_mfma_f32_16x16x32_bf16 v[28:31], v[64:67], a[180:183], v[28:31]
 s_mov_b32 m0, s93
 ds_read_b128 v[76:79], v3 offset:9216
 v_cndmask_b32 v141, v149, v141, s[40:41]
 v_mfma_f32_16x16x32_bf16 v[28:31], v[68:71], a[200:203], v[28:31]
 s_add_u32 s32, s32, 331776
 ds_read_b128 v[80:83], v3 offset:10240
 v_cndmask_b32 v142, v150, v142, s[42:43]
 v_mfma_f32_16x16x32_bf16 v[28:31], v[72:75], a[220:223], v[28:31]
 buffer_load_dwordx4 v4, s[16:19], s32 offen lds
 v_mfma_f32_16x16x32_bf16 v[32:35], v[64:67], a[184:187], v[32:35]
 s_add_u32 s93, s89, s92
 ds_read_b128 v[84:87], v3 offset:11264
 v_cndmask_b32 v143, v151, v143, s[44:45]
 v_mfma_f32_16x16x32_bf16 v[32:35], v[68:71], a[204:207], v[32:35]
 s_add_u32 s91, s91, 1
 ds_read_b64_tr_b16 v[52:53], v15 offset:0
 v_max3_f32 v24, v144, v145, v146
 v_mfma_f32_16x16x32_bf16 v[32:35], v[72:75], a[224:227], v[32:35]
 s_and_b32 s91, s91, 3
 ds_read_b64_tr_b16 v[54:55], v15 offset:512
 v_max3_f32 v25, v147, v148, v141
 v_mfma_f32_16x16x32_bf16 v[36:39], v[64:67], a[188:191], v[36:39]
 s_mul_i32 s92, s91, 12288
 ds_read_b64_tr_b16 v[56:57], v15 offset:1024
 v_max3_f32 v24, v24, v142, v143
 v_max_f32 v24, v24, v25
 v_mfma_f32_16x16x32_bf16 v[36:39], v[68:71], a[208:211], v[36:39]
 ds_read_b64_tr_b16 v[58:59], v15 offset:1536
 v_mul_f32 v24, s50, v24
 v_mfma_f32_16x16x32_bf16 v[36:39], v[72:75], a[228:231], v[36:39]
 buffer_load_dwordx4 v5, s[16:19], s32 offen offset:1024 lds
 v_mfma_f32_16x16x32_bf16 v[40:43], v[64:67], a[192:195], v[40:43]
 ds_read_b64_tr_b16 v[60:61], v15 offset:2048
 v_fma_f32 v148, v148, s50, -v24
 v_mfma_f32_16x16x32_bf16 v[40:43], v[68:71], a[212:215], v[40:43]
 ds_read_b64_tr_b16 v[62:63], v15 offset:2560
 v_add_u32 v15, s92, v2
 v_mfma_f32_16x16x32_bf16 v[40:43], v[72:75], a[232:235], v[40:43]
 ds_write_b32 v10, v94 offset:13440
 v_mfma_f32_16x16x32_bf16 v[44:47], v[64:67], a[196:199], v[44:47]
 ds_write_b32 v11, v95 offset:13440
 v_mfma_f32_16x16x32_bf16 v[44:47], v[68:71], a[216:219], v[44:47]
 s_waitcnt lgkmcnt(8)
 ds_write_b32 v10, v96 offset:17920
 v_mfma_f32_16x16x32_bf16 v[44:47], v[72:75], a[236:239], v[44:47]
 buffer_load_dwordx4 v6, s[16:19], s32 offen offset:2048 lds
 v_mfma_f32_16x16x32_bf16 v[48:51], v[64:67], v[76:79], v[48:51]
 v_exp_f32 v148, v148
 v_mfma_f32_16x16x32_bf16 v[48:51], v[68:71], v[80:83], v[48:51]
 s_waitcnt vmcnt(6) lgkmcnt(3)
 v_fma_f32 v141, v141, s50, -v24
 v_fma_f32 v142, v142, s50, -v24
 v_fma_f32 v143, v143, s50, -v24
 v_mfma_f32_16x16x32_bf16 v[48:51], v[72:75], v[84:87], v[48:51]
 s_barrier
 v_exp_f32 v141, v141
 v_mfma_f32_16x16x32_bf16 v[28:31], v[52:55], a[240:243], v[28:31]
 s_mov_b32 m0, s93
 ds_read_b128 v[76:79], v3 offset:12288
 v_fma_f32 v144, v144, s50, -v24
 v_mfma_f32_16x16x32_bf16 v[28:31], v[56:59], v[156:159], v[28:31]
 s_add_u32 s32, s32, 331776
 ds_read_b128 v[80:83], v3 offset:13312
 v_fma_f32 v145, v145, s50, -v24
 v_fma_f32 v146, v146, s50, -v24
 v_mfma_f32_16x16x32_bf16 v[28:31], v[60:63], v[176:179], v[28:31]
 buffer_load_dwordx4 v4, s[16:19], s32 offen lds
 v_mfma_f32_16x16x32_bf16 v[32:35], v[52:55], a[244:247], v[32:35]
 s_add_u32 s93, s89, s92
 ds_read_b128 v[84:87], v3 offset:14336
 v_fma_f32 v147, v147, s50, -v24
 v_mfma_f32_16x16x32_bf16 v[32:35], v[56:59], v[160:163], v[32:35]
 s_add_u32 s91, s91, 1
 ds_read_b64_tr_b16 v[64:65], v15 offset:0
 v_add_f32 v24, v148, v141
 v_mfma_f32_16x16x32_bf16 v[32:35], v[60:63], v[180:183], v[32:35]
 s_and_b32 s91, s91, 3
 ds_read_b64_tr_b16 v[66:67], v15 offset:512
 v_mfma_f32_16x16x32_bf16 v[36:39], v[52:55], a[248:251], v[36:39]
 s_mul_i32 s92, s91, 12288
 ds_read_b64_tr_b16 v[68:69], v15 offset:1024
 v_exp_f32 v142, v142
 v_mfma_f32_16x16x32_bf16 v[36:39], v[56:59], v[164:167], v[36:39]
 ds_read_b64_tr_b16 v[70:71], v15 offset:1536
 v_exp_f32 v143, v143
 v_mfma_f32_16x16x32_bf16 v[36:39], v[60:63], v[184:187], v[36:39]
 buffer_load_dwordx4 v5, s[16:19], s32 offen offset:1024 lds
 v_mfma_f32_16x16x32_bf16 v[40:43], v[52:55], a[252:255], v[40:43]
 ds_read_b64_tr_b16 v[72:73], v15 offset:2048
 v_add_f32 v25, v142, v143
 v_mfma_f32_16x16x32_bf16 v[40:43], v[56:59], v[168:171], v[40:43]
 ds_read_b64_tr_b16 v[74:75], v15 offset:2560
 v_add_u32 v15, s92, v2
 v_mfma_f32_16x16x32_bf16 v[40:43], v[60:63], v[188:191], v[40:43]
 ds_write_b32 v11, v97 offset:17920
 v_mfma_f32_16x16x32_bf16 v[44:47], v[52:55], v[152:155], v[44:47]
 ds_write_b32 v10, v98 offset:22400
 v_mfma_f32_16x16x32_bf16 v[44:47], v[56:59], v[172:175], v[44:47]
 s_waitcnt lgkmcnt(8)
 ds_write_b32 v11, v99 offset:22400
 v_mfma_f32_16x16x32_bf16 v[44:47], v[60:63], v[192:195], v[44:47]
 buffer_load_dwordx4 v6, s[16:19], s32 offen offset:2048 lds
 v_mfma_f32_16x16x32_bf16 v[48:51], v[52:55], v[76:79], v[48:51]
 v_exp_f32 v144, v144
 v_mfma_f32_16x16x32_bf16 v[48:51], v[56:59], v[80:83], v[48:51]
 s_waitcnt vmcnt(6) lgkmcnt(3)
 v_exp_f32 v145, v145
 v_add_f32 v24, v24, v25
 v_mfma_f32_16x16x32_bf16 v[48:51], v[60:63], v[84:87], v[48:51]
 s_barrier
 v_exp_f32 v146, v146
 v_mfma_f32_16x16x32_bf16 v[28:31], v[64:67], v[196:199], v[28:31]
 s_mov_b32 m0, s93
 ds_read_b128 v[76:79], v3 offset:15360
 v_add_f32 v26, v144, v145
 v_mfma_f32_16x16x32_bf16 v[28:31], v[68:71], v[216:219], v[28:31]
 s_add_u32 s32, s32, 331776
 ds_read_b128 v[80:83], v3 offset:16384
 v_mfma_f32_16x16x32_bf16 v[28:31], v[72:75], v[236:239], v[28:31]
 buffer_load_dwordx4 v4, s[16:19], s32 offen lds
 v_mfma_f32_16x16x32_bf16 v[32:35], v[64:67], v[200:203], v[32:35]
 s_add_u32 s93, s89, s92
 ds_read_b128 v[84:87], v3 offset:17408
 v_exp_f32 v147, v147
 v_mfma_f32_16x16x32_bf16 v[32:35], v[68:71], v[220:223], v[32:35]
 s_add_u32 s91, s91, 1
 ds_read_b64_tr_b16 v[52:53], v15 offset:0
 v_add_f32 v27, v146, v147
 v_add_f32 v26, v26, v27
 v_mfma_f32_16x16x32_bf16 v[32:35], v[72:75], v[240:243], v[32:35]
 s_and_b32 s91, s91, 3
 ds_read_b64_tr_b16 v[54:55], v15 offset:512
 v_add_f32 v24, v24, v26
 v_mfma_f32_16x16x32_bf16 v[36:39], v[64:67], v[204:207], v[36:39]
 s_mul_i32 s92, s91, 12288
 ds_read_b64_tr_b16 v[56:57], v15 offset:1024
 v_mfma_f32_16x16x32_bf16 v[36:39], v[68:71], v[224:227], v[36:39]
 ds_read_b64_tr_b16 v[58:59], v15 offset:1536
 v_rcp_f32 v24, v24
 v_mfma_f32_16x16x32_bf16 v[36:39], v[72:75], v[244:247], v[36:39]
 buffer_load_dwordx4 v5, s[16:19], s32 offen offset:1024 lds
 v_mfma_f32_16x16x32_bf16 v[40:43], v[64:67], v[208:211], v[40:43]
 ds_read_b64_tr_b16 v[60:61], v15 offset:2048
 v_readlane_b32 s47, v9, s53
 v_mfma_f32_16x16x32_bf16 v[40:43], v[68:71], v[228:231], v[40:43]
 s_add_u32 s53, s53, 1
 ds_read_b64_tr_b16 v[62:63], v15 offset:2560
 v_add_u32 v15, s92, v2
 v_mfma_f32_16x16x32_bf16 v[40:43], v[72:75], v[248:251], v[40:43]
 s_and_b32 s35, s47, 0xffff
 v_add_u32 v10, s35, v17
 v_cvt_pk_bf16_f32 v88, v28, v29
 v_mfma_f32_16x16x32_bf16 v[44:47], v[64:67], v[212:215], v[44:47]
 s_lshr_b32 s47, s47, 16
 ds_read_b64 v[10:11], v10
 v_cvt_pk_bf16_f32 v89, v30, v31
 v_mfma_f32_16x16x32_bf16 v[44:47], v[68:71], v[232:235], v[44:47]
 s_waitcnt lgkmcnt(7)
 v_cvt_pk_bf16_f32 v90, v32, v33
 v_cvt_pk_bf16_f32 v91, v34, v35
 v_mfma_f32_16x16x32_bf16 v[44:47], v[72:75], v[252:255], v[44:47]
 buffer_load_dwordx4 v6, s[16:19], s32 offen offset:2048 lds
 v_mfma_f32_16x16x32_bf16 v[48:51], v[64:67], v[76:79], v[48:51]
 v_cvt_pk_bf16_f32 v92, v36, v37
 v_cvt_pk_bf16_f32 v93, v38, v39
 v_mfma_f32_16x16x32_bf16 v[48:51], v[68:71], v[80:83], v[48:51]
 s_waitcnt vmcnt(6) lgkmcnt(1)
 v_cvt_pk_bf16_f32 v94, v40, v41
 v_cvt_pk_bf16_f32 v95, v42, v43
 v_mfma_f32_16x16x32_bf16 v[48:51], v[72:75], v[84:87], v[48:51]
 s_barrier
 v_mul_f32 v148, v148, v24
 v_mul_f32 v141, v141, v24
 v_mul_f32 v142, v142, v24
 v_mfma_f32_16x16x32_bf16 v[28:31], v[52:55], a[0:3], 0
 s_mov_b32 m0, s93
 ds_read_b128 v[76:79], v3 offset:0
 ds_read_b64_tr_b16 v[120:121], v19 offset:54880
 v_cvt_pk_bf16_f32 v96, v44, v45
 v_cvt_pk_bf16_f32 v97, v46, v47
 v_mfma_f32_16x16x32_bf16 v[28:31], v[56:59], a[20:23], v[28:31]
 s_add_u32 s32, s32, 331776
 ds_read_b128 v[80:83], v3 offset:1024
 ds_read_b64_tr_b16 v[122:123], v19 offset:54888
 v_mfma_f32_16x16x32_bf16 v[28:31], v[60:63], a[40:43], v[28:31]
 buffer_load_dwordx4 v4, s[16:19], s32 offen lds
 v_mfma_f32_16x16x32_bf16 v[32:35], v[52:55], a[4:7], 0
 s_add_u32 s93, s89, s92
 ds_read_b128 v[84:87], v3 offset:2048
 ds_read_b64_tr_b16 v[124:125], v19 offset:54896
 v_mfma_f32_16x16x32_bf16 v[32:35], v[56:59], a[24:27], v[32:35]
 s_add_u32 s91, s91, 1
 ds_read_b64_tr_b16 v[64:65], v15 offset:0
 ds_read_b64_tr_b16 v[126:127], v19 offset:54904
 v_mfma_f32_16x16x32_bf16 v[32:35], v[60:63], a[44:47], v[32:35]
 s_and_b32 s91, s91, 3
 ds_read_b64_tr_b16 v[66:67], v15 offset:512
 ds_read_b64_tr_b16 v[128:129], v19 offset:54912
 v_mfma_f32_16x16x32_bf16 v[36:39], v[52:55], a[8:11], 0
 s_mul_i32 s92, s91, 12288
 ds_read_b64_tr_b16 v[68:69], v15 offset:1024
 ds_read_b64_tr_b16 v[130:131], v19 offset:56000
 v_mfma_f32_16x16x32_bf16 v[36:39], v[56:59], a[28:31], v[36:39]
 ds_read_b64_tr_b16 v[70:71], v15 offset:1536
 v_cvt_pk_bf16_f32 v98, v48, v49
 v_mfma_f32_16x16x32_bf16 v[36:39], v[60:63], a[48:51], v[36:39]
 buffer_load_dwordx4 v5, s[16:19], s32 offen offset:1024 lds
 v_mfma_f32_16x16x32_bf16 v[40:43], v[52:55], a[12:15], 0
 ds_read_b64_tr_b16 v[72:73], v15 offset:2048
 v_cvt_pk_bf16_f32 v99, v50, v51
 v_mfma_f32_16x16x32_bf16 v[40:43], v[56:59], a[32:35], v[40:43]
 ds_read_b64_tr_b16 v[74:75], v15 offset:2560
 v_add_u32 v15, s92, v2
 v_mfma_f32_16x16x32_bf16 v[40:43], v[60:63], a[52:55], v[40:43]
 ds_read_b64_tr_b16 v[132:133], v19 offset:56008
 v_mul_f32 v143, v143, v24
 v_mfma_f32_16x16x32_bf16 v[44:47], v[52:55], a[16:19], 0
 ds_read_b64_tr_b16 v[134:135], v19 offset:56016
 v_mul_f32 v144, v144, v24
 v_mfma_f32_16x16x32_bf16 v[44:47], v[56:59], a[36:39], v[44:47]
 s_waitcnt lgkmcnt(12)
 ds_read_b64_tr_b16 v[136:137], v19 offset:56024
 v_mul_f32 v145, v145, v24
 v_mfma_f32_16x16x32_bf16 v[44:47], v[60:63], a[56:59], v[44:47]
 buffer_load_dwordx4 v6, s[16:19], s32 offen offset:2048 lds
 v_mfma_f32_16x16x32_bf16 v[48:51], v[52:55], v[76:79], 0
 ds_read_b64_tr_b16 v[138:139], v19 offset:56032
 v_mul_f32 v146, v146, v24
 v_mul_f32 v147, v147, v24
 v_mfma_f32_16x16x32_bf16 v[48:51], v[56:59], v[80:83], v[48:51]
 s_waitcnt vmcnt(6) lgkmcnt(4)
 ds_read_b64_tr_b16 v[110:111], v19 offset:53760
 v_cvt_pk_bf16_f32 v102, v144, v145
 v_mfma_f32_16x16x32_bf16 v[48:51], v[60:63], v[84:87], v[48:51]
 s_barrier
 ds_read_b64_tr_b16 v[112:113], v19 offset:53768
 v_cvt_pk_bf16_f32 v103, v146, v147
 v_mfma_f32_16x16x32_bf16 v[28:31], v[64:67], a[60:63], v[28:31]
 s_mov_b32 m0, s93
 ds_read_b128 v[76:79], v3 offset:3072
 v_add3_u32 v10, v10, s47, v16
 v_add3_u32 v11, v11, s47, v16
 v_mfma_f32_16x16x32_bf16 v[28:31], v[68:71], a[80:83], v[28:31]
 s_add_u32 s32, s32, 331776
 ds_read_b128 v[80:83], v3 offset:4096
 v_cndmask_b32 v149, v141, 0, s[40:41]
 v_mfma_f32_16x16x32_bf16 v[28:31], v[72:75], a[100:103], v[28:31]
 buffer_load_dwordx4 v4, s[16:19], s32 offen lds
 v_mfma_f32_16x16x32_bf16 v[32:35], v[64:67], a[64:67], v[32:35]
 s_add_u32 s93, s89, s92
 ds_read_b128 v[84:87], v3 offset:5120
 v_cndmask_b32 v150, v142, 0, s[42:43]
 v_mfma_f32_16x16x32_bf16 v[32:35], v[68:71], a[84:87], v[32:35]
 s_add_u32 s91, s91, 1
 ds_read_b64_tr_b16 v[52:53], v15 offset:0
 v_cndmask_b32 v151, v143, 0, s[44:45]
 v_cndmask_b32 v141, 0, v141, s[40:41]
 v_mfma_f32_16x16x32_bf16 v[32:35], v[72:75], a[104:107], v[32:35]
 s_and_b32 s91, s91, 3
 ds_read_b64_tr_b16 v[54:55], v15 offset:512
 v_cndmask_b32 v142, 0, v142, s[42:43]
 v_mfma_f32_16x16x32_bf16 v[36:39], v[64:67], a[68:71], v[36:39]
 s_mul_i32 s92, s91, 12288
 ds_read_b64_tr_b16 v[56:57], v15 offset:1024
 v_cndmask_b32 v143, 0, v143, s[44:45]
 v_mfma_f32_16x16x32_bf16 v[36:39], v[68:71], a[88:91], v[36:39]
 ds_read_b64_tr_b16 v[58:59], v15 offset:1536
 v_readlane_b32 s90, v12, s34
 v_mfma_f32_16x16x32_bf16 v[36:39], v[72:75], a[108:111], v[36:39]
 buffer_load_dwordx4 v5, s[16:19], s32 offen offset:1024 lds
 v_mfma_f32_16x16x32_bf16 v[40:43], v[64:67], a[72:75], v[40:43]
 ds_read_b64_tr_b16 v[60:61], v15 offset:2048
 v_cvt_pk_bf16_f32 v104, v148, v149
 v_mfma_f32_16x16x32_bf16 v[40:43], v[68:71], a[92:95], v[40:43]
 s_lshr_b32 s31, s90, 16
 ds_read_b64_tr_b16 v[62:63], v15 offset:2560
 v_add_u32 v15, s92, v2
 v_mfma_f32_16x16x32_bf16 v[40:43], v[72:75], a[112:115], v[40:43]
 ds_write_b32 v10, v88 offset:0
 v_mfma_f32_16x16x32_bf16 v[44:47], v[64:67], a[76:79], v[44:47]
 s_add_u32 s34, s34, 1
 ds_write_b32 v11, v89 offset:0
 v_mfma_f32_16x16x32_bf16 v[44:47], v[68:71], a[96:99], v[44:47]
 s_waitcnt lgkmcnt(8)
 ds_write_b32 v10, v90 offset:4480
 v_mfma_f32_16x16x32_bf16 v[44:47], v[72:75], a[116:119], v[44:47]
 buffer_load_dwordx4 v6, s[16:19], s32 offen offset:2048 lds
 v_mfma_f32_16x16x32_bf16 v[48:51], v[64:67], v[76:79], v[48:51]
 ds_read_b64_tr_b16 v[114:115], v19 offset:53776
 v_cvt_pk_bf16_f32 v105, v150, v151
 v_mfma_f32_16x16x32_bf16 v[48:51], v[68:71], v[80:83], v[48:51]
 s_waitcnt vmcnt(6) lgkmcnt(4)
 ds_read_b64_tr_b16 v[116:117], v19 offset:53784
 v_mad_u32_u24 v4, v8, s31, v7
 v_mfma_f32_16x16x32_bf16 v[48:51], v[72:75], v[84:87], v[48:51]
 s_barrier
 ds_read_b64_tr_b16 v[118:119], v19 offset:53792
 v_add_u32 v5, 109568, v4
 v_add_u32 v6, 219136, v4
 v_mfma_f32_16x16x32_bf16 v[28:31], v[52:55], a[120:123], v[28:31]
 s_mov_b32 m0, s93
 ds_read_b128 v[76:79], v3 offset:6144
 v_cvt_pk_bf16_f32 v100, 0, v141
 v_cvt_pk_bf16_f32 v101, v142, v143
 v_mfma_f32_16x16x32_bf16 v[28:31], v[56:59], a[140:143], v[28:31]
 s_and_b32 s32, s90, 0xffff
 ds_read_b128 v[80:83], v3 offset:7168
 v_mfma_f32_16x16x32_bf16 v[28:31], v[60:63], a[160:163], v[28:31]
 buffer_load_dwordx4 v4, s[16:19], s32 offen lds
 v_mfma_f32_16x16x32_bf16 v[32:35], v[52:55], a[124:127], v[32:35]
 s_add_u32 s93, s89, s92
 ds_read_b128 v[84:87], v3 offset:8192
 v_mfma_f32_16x16x32_bf16 v[32:35], v[56:59], a[144:147], v[32:35]
 s_add_u32 s91, s91, 1
 ds_read_b64_tr_b16 v[64:65], v15 offset:0
 v_mfma_f32_16x16x32_bf16 v[32:35], v[60:63], a[164:167], v[32:35]
 s_and_b32 s91, s91, 3
 ds_read_b64_tr_b16 v[66:67], v15 offset:512
 v_mfma_f32_16x16x32_bf16 v[36:39], v[52:55], a[128:131], v[36:39]
 s_mul_i32 s92, s91, 12288
 ds_read_b64_tr_b16 v[68:69], v15 offset:1024
 v_mfma_f32_16x16x32_bf16 v[36:39], v[56:59], a[148:151], v[36:39]
 ds_read_b64_tr_b16 v[70:71], v15 offset:1536
 v_mfma_f32_16x16x32_bf16 v[36:39], v[60:63], a[168:171], v[36:39]
 buffer_load_dwordx4 v5, s[16:19], s32 offen offset:1024 lds
 v_mfma_f32_16x16x32_bf16 v[40:43], v[52:55], a[132:135], v[40:43]
 ds_read_b64_tr_b16 v[72:73], v15 offset:2048
 v_mfma_f32_16x16x32_bf16 v[40:43], v[56:59], a[152:155], v[40:43]
 ds_read_b64_tr_b16 v[74:75], v15 offset:2560
 v_add_u32 v15, s92, v2
 v_mfma_f32_16x16x32_bf16 v[40:43], v[60:63], a[172:175], v[40:43]
 ds_write_b32 v11, v91 offset:4480
 v_mfma_f32_16x16x32_bf16 v[44:47], v[52:55], a[136:139], v[44:47]
 ds_write_b32 v10, v92 offset:8960
 v_mfma_f32_16x16x32_bf16 v[44:47], v[56:59], a[156:159], v[44:47]
 s_waitcnt lgkmcnt(8)
 ds_write_b32 v11, v93 offset:8960
 v_mfma_f32_16x16x32_bf16 v[44:47], v[60:63], a[176:179], v[44:47]
 buffer_load_dwordx4 v6, s[16:19], s32 offen offset:2048 lds
 v_mfma_f32_16x16x32_bf16 v[48:51], v[52:55], v[76:79], v[48:51]
 s_nop 0
 v_mfma_f32_4x4x4_16b_bf16 v[140:143], v[120:121], v[102:103], 0
 v_mfma_f32_4x4x4_16b_bf16 v[144:147], v[122:123], v[102:103], 0
 v_mfma_f32_4x4x4_16b_bf16 v[148:151], v[124:125], v[102:103], 0
 v_mfma_f32_4x4x4_16b_bf16 v[106:109], v[126:127], v[102:103], 0
 v_mfma_f32_4x4x4_16b_bf16 v[24:27], v[128:129], v[102:103], 0
 v_mfma_f32_4x4x4_16b_bf16 v[140:143], v[130:131], v[104:105], v[140:143]
 v_mfma_f32_4x4x4_16b_bf16 v[144:147], v[132:133], v[104:105], v[144:147]
 v_mfma_f32_4x4x4_16b_bf16 v[148:151], v[134:135], v[104:105], v[148:151]
 v_mfma_f32_4x4x4_16b_bf16 v[106:109], v[136:137], v[104:105], v[106:109]
 v_mfma_f32_4x4x4_16b_bf16 v[24:27], v[138:139], v[104:105], v[24:27]
 v_mfma_f32_4x4x4_16b_bf16 v[140:143], v[110:111], v[100:101], v[140:143]
 v_mfma_f32_4x4x4_16b_bf16 v[144:147], v[112:113], v[100:101], v[144:147]
 v_mfma_f32_4x4x4_16b_bf16 v[148:151], v[114:115], v[100:101], v[148:151]
 v_mfma_f32_4x4x4_16b_bf16 v[106:109], v[116:117], v[100:101], v[106:109]
 v_mfma_f32_4x4x4_16b_bf16 v[24:27], v[118:119], v[100:101], v[24:27]
 v_mfma_f32_16x16x32_bf16 v[48:51], v[56:59], v[80:83], v[48:51]
 s_waitcnt vmcnt(6) lgkmcnt(3)
 v_mfma_f32_16x16x32_bf16 v[48:51], v[60:63], v[84:87], v[48:51]
 s_barrier
 v_mfma_f32_16x16x32_bf16 v[28:31], v[64:67], a[180:183], v[28:31]
 s_mov_b32 m0, s93
 ds_read_b128 v[76:79], v3 offset:9216
 v_cvt_pk_bf16_f32 v112, v140, v141
 v_cvt_pk_bf16_f32 v113, v142, v143
 v_cvt_pk_bf16_f32 v114, v144, v145
 v_cvt_pk_bf16_f32 v115, v146, v147
 v_cvt_pk_bf16_f32 v116, v148, v149
 v_cvt_pk_bf16_f32 v117, v150, v151
 v_cvt_pk_bf16_f32 v118, v106, v107
 v_cvt_pk_bf16_f32 v119, v108, v109
 v_cvt_pk_bf16_f32 v120, v24, v25
 v_mfma_f32_16x16x32_bf16 v[28:31], v[68:71], a[200:203], v[28:31]
 s_add_u32 s32, s32, 331776
 ds_read_b128 v[80:83], v3 offset:10240
 v_mfma_f32_16x16x32_bf16 v[28:31], v[72:75], a[220:223], v[28:31]
 buffer_load_dwordx4 v4, s[16:19], s32 offen lds
 v_mfma_f32_16x16x32_bf16 v[32:35], v[64:67], a[184:187], v[32:35]
 s_add_u32 s93, s89, s92
 ds_read_b128 v[84:87], v3 offset:11264
 v_mfma_f32_16x16x32_bf16 v[32:35], v[68:71], a[204:207], v[32:35]
 s_add_u32 s91, s91, 1
 ds_read_b64_tr_b16 v[52:53], v15 offset:0
 v_mfma_f32_16x16x32_bf16 v[32:35], v[72:75], a[224:227], v[32:35]
 s_and_b32 s91, s91, 3
 ds_read_b64_tr_b16 v[54:55], v15 offset:512
 v_mfma_f32_16x16x32_bf16 v[36:39], v[64:67], a[188:191], v[36:39]
 s_mul_i32 s92, s91, 12288
 ds_read_b64_tr_b16 v[56:57], v15 offset:1024
 v_mfma_f32_16x16x32_bf16 v[36:39], v[68:71], a[208:211], v[36:39]
 s_add_u32 s39, s39, 64
 ds_read_b64_tr_b16 v[58:59], v15 offset:1536
 v_mfma_f32_16x16x32_bf16 v[36:39], v[72:75], a[228:231], v[36:39]
 buffer_load_dwordx4 v5, s[16:19], s32 offen offset:1024 lds
 v_mfma_f32_16x16x32_bf16 v[40:43], v[64:67], a[192:195], v[40:43]
 ds_read_b64_tr_b16 v[60:61], v15 offset:2048
 v_mfma_f32_16x16x32_bf16 v[40:43], v[68:71], a[212:215], v[40:43]
 ds_read_b64_tr_b16 v[62:63], v15 offset:2560
 v_add_u32 v15, s92, v2
 v_mfma_f32_16x16x32_bf16 v[40:43], v[72:75], a[232:235], v[40:43]
 ds_write_b32 v10, v94 offset:13440
 v_mfma_f32_16x16x32_bf16 v[44:47], v[64:67], a[196:199], v[44:47]
 ds_write_b32 v11, v95 offset:13440
 v_mfma_f32_16x16x32_bf16 v[44:47], v[68:71], a[216:219], v[44:47]
 s_waitcnt lgkmcnt(8)
 ds_write_b32 v10, v96 offset:17920
 v_mfma_f32_16x16x32_bf16 v[44:47], v[72:75], a[236:239], v[44:47]
 buffer_load_dwordx4 v6, s[16:19], s32 offen offset:2048 lds
 v_mfma_f32_16x16x32_bf16 v[48:51], v[64:67], v[76:79], v[48:51]
 buffer_store_dwordx4 v[112:115], v20, s[24:27], s52 offen
 v_mfma_f32_16x16x32_bf16 v[48:51], v[68:71], v[80:83], v[48:51]
 s_waitcnt vmcnt(7) lgkmcnt(3)
 buffer_store_dwordx4 v[116:119], v20, s[24:27], s84 offen
 v_mfma_f32_16x16x32_bf16 v[48:51], v[72:75], v[84:87], v[48:51]
 s_barrier
 buffer_store_dword v120, v21, s[24:27], s85 offen
 v_mfma_f32_16x16x32_bf16 v[28:31], v[52:55], a[240:243], v[28:31]
 s_mov_b32 m0, s93
 ds_read_b128 v[76:79], v3 offset:12288
 v_mfma_f32_16x16x32_bf16 v[28:31], v[56:59], v[156:159], v[28:31]
 s_add_u32 s32, s32, 331776
 ds_read_b128 v[80:83], v3 offset:13312
 v_mfma_f32_16x16x32_bf16 v[28:31], v[60:63], v[176:179], v[28:31]
 buffer_load_dwordx4 v4, s[16:19], s32 offen lds
 v_mfma_f32_16x16x32_bf16 v[32:35], v[52:55], a[244:247], v[32:35]
 s_add_u32 s93, s89, s92
 ds_read_b128 v[84:87], v3 offset:14336
 v_mfma_f32_16x16x32_bf16 v[32:35], v[56:59], v[160:163], v[32:35]
 s_add_u32 s91, s91, 1
 ds_read_b64_tr_b16 v[64:65], v15 offset:0
 v_mfma_f32_16x16x32_bf16 v[32:35], v[60:63], v[180:183], v[32:35]
 s_and_b32 s91, s91, 3
 ds_read_b64_tr_b16 v[66:67], v15 offset:512
 v_mfma_f32_16x16x32_bf16 v[36:39], v[52:55], a[248:251], v[36:39]
 s_mul_i32 s92, s91, 12288
 ds_read_b64_tr_b16 v[68:69], v15 offset:1024
 v_mfma_f32_16x16x32_bf16 v[36:39], v[56:59], v[164:167], v[36:39]
 ds_read_b64_tr_b16 v[70:71], v15 offset:1536
 v_mfma_f32_16x16x32_bf16 v[36:39], v[60:63], v[184:187], v[36:39]
 buffer_load_dwordx4 v5, s[16:19], s32 offen offset:1024 lds
 v_mfma_f32_16x16x32_bf16 v[40:43], v[52:55], a[252:255], v[40:43]
 ds_read_b64_tr_b16 v[72:73], v15 offset:2048
 v_mfma_f32_16x16x32_bf16 v[40:43], v[56:59], v[168:171], v[40:43]
 ds_read_b64_tr_b16 v[74:75], v15 offset:2560
 v_add_u32 v15, s92, v2
 v_mfma_f32_16x16x32_bf16 v[40:43], v[60:63], v[188:191], v[40:43]
 ds_write_b32 v11, v97 offset:17920
 v_mfma_f32_16x16x32_bf16 v[44:47], v[52:55], v[152:155], v[44:47]
 ds_write_b32 v10, v98 offset:22400
 v_mfma_f32_16x16x32_bf16 v[44:47], v[56:59], v[172:175], v[44:47]
 s_waitcnt lgkmcnt(8)
 ds_write_b32 v11, v99 offset:22400
 v_mfma_f32_16x16x32_bf16 v[44:47], v[60:63], v[192:195], v[44:47]
 buffer_load_dwordx4 v6, s[16:19], s32 offen offset:2048 lds
 v_mfma_f32_16x16x32_bf16 v[48:51], v[52:55], v[76:79], v[48:51]
 v_mfma_f32_16x16x32_bf16 v[48:51], v[56:59], v[80:83], v[48:51]
 s_waitcnt vmcnt(9) lgkmcnt(3)
 v_mfma_f32_16x16x32_bf16 v[48:51], v[60:63], v[84:87], v[48:51]
 s_barrier
 v_mfma_f32_16x16x32_bf16 v[28:31], v[64:67], v[196:199], v[28:31]
 s_mov_b32 m0, s93
 ds_read_b128 v[76:79], v3 offset:15360
 v_mfma_f32_16x16x32_bf16 v[28:31], v[68:71], v[216:219], v[28:31]
 s_add_u32 s32, s32, 331776
 ds_read_b128 v[80:83], v3 offset:16384
 v_mfma_f32_16x16x32_bf16 v[28:31], v[72:75], v[236:239], v[28:31]
 buffer_load_dwordx4 v4, s[16:19], s32 offen lds
 v_mfma_f32_16x16x32_bf16 v[32:35], v[64:67], v[200:203], v[32:35]
 s_add_u32 s93, s89, s92
 ds_read_b128 v[84:87], v3 offset:17408
 v_mfma_f32_16x16x32_bf16 v[32:35], v[68:71], v[220:223], v[32:35]
 s_add_u32 s91, s91, 1
 ds_read_b64_tr_b16 v[52:53], v15 offset:0
 v_mfma_f32_16x16x32_bf16 v[32:35], v[72:75], v[240:243], v[32:35]
 s_and_b32 s91, s91, 3
 ds_read_b64_tr_b16 v[54:55], v15 offset:512
 v_mfma_f32_16x16x32_bf16 v[36:39], v[64:67], v[204:207], v[36:39]
 s_mul_i32 s92, s91, 12288
 ds_read_b64_tr_b16 v[56:57], v15 offset:1024
 v_mfma_f32_16x16x32_bf16 v[36:39], v[68:71], v[224:227], v[36:39]
 ds_read_b64_tr_b16 v[58:59], v15 offset:1536
 s_add_u32 s33, s33, 1
 s_cbranch_scc0 L_q
 v_mfma_f32_16x16x32_bf16 v[36:39], v[72:75], v[244:247], v[36:39]
 v_mfma_f32_16x16x32_bf16 v[40:43], v[64:67], v[208:211], v[40:43]
 v_mfma_f32_16x16x32_bf16 v[40:43], v[68:71], v[228:231], v[40:43]
 v_mfma_f32_16x16x32_bf16 v[40:43], v[72:75], v[248:251], v[40:43]
 v_mfma_f32_16x16x32_bf16 v[44:47], v[64:67], v[212:215], v[44:47]
 v_mfma_f32_16x16x32_bf16 v[44:47], v[68:71], v[232:235], v[44:47]
 s_waitcnt lgkmcnt(4)
 v_mfma_f32_16x16x32_bf16 v[44:47], v[72:75], v[252:255], v[44:47]
 v_mfma_f32_16x16x32_bf16 v[48:51], v[64:67], v[76:79], v[48:51]
 v_mfma_f32_16x16x32_bf16 v[48:51], v[68:71], v[80:83], v[48:51]
 v_mfma_f32_16x16x32_bf16 v[48:51], v[72:75], v[84:87], v[48:51]
 v_readlane_b32 s47, v9, s53
 v_lshrrev_b32 v24, 2, v1
 s_add_u32 s53, s53, 1
 v_add_u32 v24, s39, v24
 s_and_b32 s35, s47, 0xffff
 v_mul_u32_u24 v25, 745, v24
 s_lshr_b32 s47, s47, 16
 v_lshrrev_b32 v25, 14, v25
 v_add_u32 v10, s35, v17
 v_mul_u32_u24 v26, 22, v25
 ds_read_b64 v[10:11], v10
 v_sub_u32 v26, v24, v26
 v_cvt_pk_bf16_f32 v88, v28, v29
 v_mul_u32_u24 v27, 37, v25
 v_cvt_pk_bf16_f32 v89, v30, v31
 v_lshrrev_b32 v27, 8, v27
 v_cvt_pk_bf16_f32 v90, v32, v33
 v_mul_u32_u24 v27, 7, v27
 v_cvt_pk_bf16_f32 v91, v34, v35
 v_sub_u32 v27, v25, v27
 v_cvt_pk_bf16_f32 v92, v36, v37
 v_mul_u32_u24 v27, 40, v27
 v_cvt_pk_bf16_f32 v93, v38, v39
 v_and_b32 v24, 3, v1
 v_cvt_pk_bf16_f32 v94, v40, v41
 v_lshl_add_u32 v26, v26, 2, v24
 v_cvt_pk_bf16_f32 v95, v42, v43
 v_mul_u32_u24 v18, 280, v26
 v_cvt_pk_bf16_f32 v96, v44, v45
 v_add3_u32 v18, v18, v27, s54
 v_cvt_pk_bf16_f32 v97, v46, v47
 v_xor_b32 v25, s55, v25
 v_cvt_pk_bf16_f32 v98, v48, v49
 v_lshlrev_b32 v20, 4, v26
 v_cvt_pk_bf16_f32 v99, v50, v51
 v_lshl_add_u32 v20, v25, 16, v20
 s_waitcnt lgkmcnt(0)
 v_add3_u32 v10, v10, s47, v16
 v_lshlrev_b32 v21, 2, v26
 v_add3_u32 v11, v11, s47, v16
 v_lshl_add_u32 v21, v25, 13, v21
 ds_write_b32 v10, v88 offset:0
 v_cmp_gt_u32 vcc, s86, v26
 ds_write_b32 v11, v89 offset:0
 v_bfrev_b32 v27, 2
 ds_write_b32 v10, v90 offset:4480
 v_cndmask_b32 v20, v27, v20, vcc
 ds_write_b32 v11, v91 offset:4480
 v_cndmask_b32 v21, v27, v21, vcc
 ds_write_b32 v10, v92 offset:8960
 v_lshrrev_b32 v25, 4, v1
 ds_write_b32 v11, v93 offset:8960
 v_lshl_add_u32 v24, v25, 2, v24
 ds_write_b32 v10, v94 offset:13440
 v_add_u32 v24, s39, v24
 ds_write_b32 v11, v95 offset:13440
 v_mul_u32_u24 v25, 745, v24
 ds_write_b32 v10, v96 offset:17920
 v_lshrrev_b32 v25, 14, v25
 ds_write_b32 v11, v97 offset:17920
 v_mul_u32_u24 v26, 22, v25
 ds_write_b32 v10, v98 offset:22400
 v_sub_u32 v26, v24, v26
 ds_write_b32 v11, v99 offset:22400
 v_mul_u32_u24 v27, 37, v25
 v_lshrrev_b32 v27, 8, v27
 v_mul_u32_u24 v27, 7, v27
 v_sub_u32 v27, v25, v27
 v_mul_u32_u24 v27, 40, v27
 v_bfe_u32 v24, v1, 2, 2
 v_lshl_add_u32 v26, v26, 2, v24
 v_mul_u32_u24 v19, 280, v26
 v_add3_u32 v19, v19, v27, s54
 s_waitcnt lgkmcnt(0)
 s_barrier
 ds_read_b64 v[100:101], v18 offset:2240
 ds_read_b64 v[110:111], v18 offset:26880
 ds_read_b64 v[120:121], v18 offset:28000
 ds_read_b64 v[130:131], v18 offset:29120
 ds_read_b64 v[102:103], v18 offset:2248
 ds_read_b64 v[112:113], v18 offset:26888
 ds_read_b64 v[122:123], v18 offset:28008
 ds_read_b64 v[132:133], v18 offset:29128
 ds_read_b64 v[104:105], v18 offset:2256
 ds_read_b64 v[114:115], v18 offset:26896
 ds_read_b64 v[124:125], v18 offset:28016
 ds_read_b64 v[134:135], v18 offset:29136
 ds_read_b64 v[106:107], v18 offset:2264
 ds_read_b64 v[116:117], v18 offset:26904
 ds_read_b64 v[126:127], v18 offset:28024
 ds_read_b64 v[136:137], v18 offset:29144
 ds_read_b32 v108, v18 offset:2272
 ds_read_b64 v[118:119], v18 offset:26912
 ds_read_b64 v[128:129], v18 offset:28032
 ds_read_b64 v[138:139], v18 offset:29152
 v_mov_b32 v109, 0x3f80
 s_waitcnt lgkmcnt(15)
 v_mfma_f32_4x4x4_16b_bf16 v[140:143], v[110:111], v[100:101], 0
 v_mfma_f32_4x4x4_16b_bf16 v[144:147], v[120:121], v[100:101], 0
 v_mfma_f32_4x4x4_16b_bf16 v[148:151], v[130:131], v[100:101], 0
 ds_read_b64_tr_b16 v[110:111], v19 offset:53760
 ds_read_b64_tr_b16 v[120:121], v19 offset:54880
 ds_read_b64_tr_b16 v[130:131], v19 offset:56000
 s_waitcnt lgkmcnt(15)
 v_mfma_f32_4x4x4_16b_bf16 v[140:143], v[112:113], v[102:103], v[140:143]
 v_mfma_f32_4x4x4_16b_bf16 v[144:147], v[122:123], v[102:103], v[144:147]
 v_mfma_f32_4x4x4_16b_bf16 v[148:151], v[132:133], v[102:103], v[148:151]
 ds_read_b64_tr_b16 v[112:113], v19 offset:53768
 ds_read_b64_tr_b16 v[122:123], v19 offset:54888
 ds_read_b64_tr_b16 v[132:133], v19 offset:56008
 s_waitcnt lgkmcnt(15)
 v_mfma_f32_4x4x4_16b_bf16 v[140:143], v[114:115], v[104:105], v[140:143]
 v_mfma_f32_4x4x4_16b_bf16 v[144:147], v[124:125], v[104:105], v[144:147]
 s_waitcnt lgkmcnt(14)
 v_mfma_f32_4x4x4_16b_bf16 v[148:151], v[134:135], v[104:105], v[148:151]
 ds_read_b64_tr_b16 v[114:115], v19 offset:53776
 ds_read_b64_tr_b16 v[124:125], v19 offset:54896
 ds_read_b64_tr_b16 v[134:135], v19 offset:56016
 s_waitcnt lgkmcnt(15)
 v_mfma_f32_4x4x4_16b_bf16 v[140:143], v[116:117], v[106:107], v[140:143]
 s_waitcnt lgkmcnt(14)
 v_mfma_f32_4x4x4_16b_bf16 v[144:147], v[126:127], v[106:107], v[144:147]
 s_waitcnt lgkmcnt(13)
 v_mfma_f32_4x4x4_16b_bf16 v[148:151], v[136:137], v[106:107], v[148:151]
 ds_read_b64_tr_b16 v[116:117], v19 offset:53784
 ds_read_b64_tr_b16 v[126:127], v19 offset:54904
 ds_read_b64_tr_b16 v[136:137], v19 offset:56024
 s_waitcnt lgkmcnt(14)
 v_mfma_f32_4x4x4_16b_bf16 v[140:143], v[118:119], v[108:109], v[140:143]
 s_waitcnt lgkmcnt(13)
 v_mfma_f32_4x4x4_16b_bf16 v[144:147], v[128:129], v[108:109], v[144:147]
 s_waitcnt lgkmcnt(12)
 v_mfma_f32_4x4x4_16b_bf16 v[148:151], v[138:139], v[108:109], v[148:151]
 ds_read_b64_tr_b16 v[118:119], v19 offset:53792
 ds_read_b64_tr_b16 v[128:129], v19 offset:54912
 ds_read_b64_tr_b16 v[138:139], v19 offset:56032
 s_nop 1
 v_cndmask_b32 v141, v149, v141, s[40:41]
 v_cndmask_b32 v142, v150, v142, s[42:43]
 v_cndmask_b32 v143, v151, v143, s[44:45]
 v_mov_b32 v140, v148
 v_max3_f32 v24, v144, v145, v146
 v_max3_f32 v25, v147, v148, v141
 v_max3_f32 v24, v24, v142, v143
 v_max_f32 v24, v24, v25
 v_mul_f32 v24, s50, v24
 v_pk_fma_f32 v[140:141], v[140:141], s[50:51], v[24:25] op_sel_hi:[1,1,0] neg_lo:[0,0,1] neg_hi:[0,0,1]
 v_pk_fma_f32 v[142:143], v[142:143], s[50:51], v[24:25] op_sel_hi:[1,1,0] neg_lo:[0,0,1] neg_hi:[0,0,1]
 v_pk_fma_f32 v[144:145], v[144:145], s[50:51], v[24:25] op_sel_hi:[1,1,0] neg_lo:[0,0,1] neg_hi:[0,0,1]
 v_pk_fma_f32 v[146:147], v[146:147], s[50:51], v[24:25] op_sel_hi:[1,1,0] neg_lo:[0,0,1] neg_hi:[0,0,1]
 v_exp_f32 v140, v140
 v_exp_f32 v141, v141
 v_exp_f32 v142, v142
 v_exp_f32 v143, v143
 v_exp_f32 v144, v144
 v_exp_f32 v145, v145
 v_exp_f32 v146, v146
 v_exp_f32 v147, v147
 v_pk_add_f32 v[24:25], v[140:141], v[142:143]
 v_pk_add_f32 v[26:27], v[144:145], v[146:147]
 v_pk_add_f32 v[24:25], v[24:25], v[26:27]
 v_add_f32 v24, v24, v25
 v_rcp_f32 v24, v24
 s_nop 0
 v_pk_mul_f32 v[140:141], v[140:141], v[24:25] op_sel_hi:[1,0]
 v_pk_mul_f32 v[142:143], v[142:143], v[24:25] op_sel_hi:[1,0]
 v_pk_mul_f32 v[144:145], v[144:145], v[24:25] op_sel_hi:[1,0]
 v_pk_mul_f32 v[146:147], v[146:147], v[24:25] op_sel_hi:[1,0]
 v_cvt_pk_bf16_f32 v102, v144, v145
 v_cvt_pk_bf16_f32 v103, v146, v147
 v_cndmask_b32 v149, v141, 0, s[40:41]
 v_cndmask_b32 v150, v142, 0, s[42:43]
 v_cndmask_b32 v151, v143, 0, s[44:45]
 v_cndmask_b32 v141, 0, v141, s[40:41]
 v_cndmask_b32 v142, 0, v142, s[42:43]
 v_cndmask_b32 v143, 0, v143, s[44:45]
 v_cvt_pk_bf16_f32 v104, v140, v149
 v_cvt_pk_bf16_f32 v105, v150, v151
 v_cvt_pk_bf16_f32 v100, 0, v141
 v_cvt_pk_bf16_f32 v101, v142, v143
 s_waitcnt lgkmcnt(13)
 v_mfma_f32_4x4x4_16b_bf16 v[140:143], v[120:121], v[102:103], 0
 s_waitcnt lgkmcnt(10)
 v_mfma_f32_4x4x4_16b_bf16 v[144:147], v[122:123], v[102:103], 0
 s_waitcnt lgkmcnt(7)
 v_mfma_f32_4x4x4_16b_bf16 v[148:151], v[124:125], v[102:103], 0
 s_waitcnt lgkmcnt(4)
 v_mfma_f32_4x4x4_16b_bf16 v[106:109], v[126:127], v[102:103], 0
 s_waitcnt lgkmcnt(1)
 v_mfma_f32_4x4x4_16b_bf16 v[24:27], v[128:129], v[102:103], 0
 v_mfma_f32_4x4x4_16b_bf16 v[140:143], v[130:131], v[104:105], v[140:143]
 v_mfma_f32_4x4x4_16b_bf16 v[144:147], v[132:133], v[104:105], v[144:147]
 v_mfma_f32_4x4x4_16b_bf16 v[148:151], v[134:135], v[104:105], v[148:151]
 v_mfma_f32_4x4x4_16b_bf16 v[106:109], v[136:137], v[104:105], v[106:109]
 s_waitcnt lgkmcnt(0)
 v_mfma_f32_4x4x4_16b_bf16 v[24:27], v[138:139], v[104:105], v[24:27]
 v_mfma_f32_4x4x4_16b_bf16 v[140:143], v[110:111], v[100:101], v[140:143]
 v_mfma_f32_4x4x4_16b_bf16 v[144:147], v[112:113], v[100:101], v[144:147]
 v_mfma_f32_4x4x4_16b_bf16 v[148:151], v[114:115], v[100:101], v[148:151]
 v_mfma_f32_4x4x4_16b_bf16 v[106:109], v[116:117], v[100:101], v[106:109]
 v_mfma_f32_4x4x4_16b_bf16 v[24:27], v[118:119], v[100:101], v[24:27]
 s_nop 0
 v_cvt_pk_bf16_f32 v112, v140, v141
 v_cvt_pk_bf16_f32 v113, v142, v143
 v_cvt_pk_bf16_f32 v114, v144, v145
 v_cvt_pk_bf16_f32 v115, v146, v147
 v_cvt_pk_bf16_f32 v116, v148, v149
 v_cvt_pk_bf16_f32 v117, v150, v151
 v_cvt_pk_bf16_f32 v118, v106, v107
 v_cvt_pk_bf16_f32 v119, v108, v109
 v_cvt_pk_bf16_f32 v120, v24, v25
 buffer_store_dwordx4 v[112:115], v20, s[24:27], s52 offen
 buffer_store_dwordx4 v[116:119], v20, s[24:27], s84 offen
 buffer_store_dword v120, v21, s[24:27], s85 offen
 s_add_u32 s39, s39, 64
 s_cmp_ge_u32 s39, 352
 s_cbranch_scc1 L_q_done
 v_lshrrev_b32 v24, 2, v1
 v_add_u32 v24, s39, v24
 v_mul_u32_u24 v25, 745, v24
 v_lshrrev_b32 v25, 14, v25
 v_mul_u32_u24 v26, 22, v25
 v_sub_u32 v26, v24, v26
 v_mul_u32_u24 v27, 37, v25
 v_lshrrev_b32 v27, 8, v27
 v_mul_u32_u24 v27, 7, v27
 v_sub_u32 v27, v25, v27
 v_mul_u32_u24 v27, 40, v27
 v_and_b32 v24, 3, v1
 v_lshl_add_u32 v26, v26, 2, v24
 v_mul_u32_u24 v18, 280, v26
 v_add3_u32 v18, v18, v27, s54
 v_xor_b32 v25, s55, v25
 v_lshlrev_b32 v20, 4, v26
 v_lshl_add_u32 v20, v25, 16, v20
 v_lshlrev_b32 v21, 2, v26
 v_lshl_add_u32 v21, v25, 13, v21
 v_cmp_gt_u32 vcc, s86, v26
 v_bfrev_b32 v27, 2
 s_nop 0
 v_cndmask_b32 v20, v27, v20, vcc
 v_cndmask_b32 v21, v27, v21, vcc
 v_lshrrev_b32 v25, 4, v1
 v_lshl_add_u32 v24, v25, 2, v24
 v_add_u32 v24, s39, v24
 v_mul_u32_u24 v25, 745, v24
 v_lshrrev_b32 v25, 14, v25
 v_mul_u32_u24 v26, 22, v25
 v_sub_u32 v26, v24, v26
 v_mul_u32_u24 v27, 37, v25
 v_lshrrev_b32 v27, 8, v27
 v_mul_u32_u24 v27, 7, v27
 v_sub_u32 v27, v25, v27
 v_mul_u32_u24 v27, 40, v27
 v_bfe_u32 v24, v1, 2, 2
 v_lshl_add_u32 v26, v26, 2, v24
 v_mul_u32_u24 v19, 280, v26
 v_add3_u32 v19, v19, v27, s54
 ds_read_b64 v[100:101], v18 offset:2240
 ds_read_b64 v[110:111], v18 offset:26880
 ds_read_b64 v[120:121], v18 offset:28000
 ds_read_b64 v[130:131], v18 offset:29120
 ds_read_b64 v[102:103], v18 offset:2248
 ds_read_b64 v[112:113], v18 offset:26888
 ds_read_b64 v[122:123], v18 offset:28008
 ds_read_b64 v[132:133], v18 offset:29128
 ds_read_b64 v[104:105], v18 offset:2256
 ds_read_b64 v[114:115], v18 offset:26896
 ds_read_b64 v[124:125], v18 offset:28016
 ds_read_b64 v[134:135], v18 offset:29136
 ds_read_b64 v[106:107], v18 offset:2264
 ds_read_b64 v[116:117], v18 offset:26904
 ds_read_b64 v[126:127], v18 offset:28024
 ds_read_b64 v[136:137], v18 offset:29144
 ds_read_b32 v108, v18 offset:2272
 ds_read_b64 v[118:119], v18 offset:26912
 ds_read_b64 v[128:129], v18 offset:28032
 ds_read_b64 v[138:139], v18 offset:29152
 v_mov_b32 v109, 0x3f80
 s_waitcnt lgkmcnt(15)
 v_mfma_f32_4x4x4_16b_bf16 v[140:143], v[110:111], v[100:101], 0
 v_mfma_f32_4x4x4_16b_bf16 v[144:147], v[120:121], v[100:101], 0
 v_mfma_f32_4x4x4_16b_bf16 v[148:151], v[130:131], v[100:101], 0
 ds_read_b64_tr_b16 v[110:111], v19 offset:53760
 ds_read_b64_tr_b16 v[120:121], v19 offset:54880
 ds_read_b64_tr_b16 v[130:131], v19 offset:56000
 s_waitcnt lgkmcnt(15)
 v_mfma_f32_4x4x4_16b_bf16 v[140:143], v[112:113], v[102:103], v[140:143]
 v_mfma_f32_4x4x4_16b_bf16 v[144:147], v[122:123], v[102:103], v[144:147]
 v_mfma_f32_4x4x4_16b_bf16 v[148:151], v[132:133], v[102:103], v[148:151]
 ds_read_b64_tr_b16 v[112:113], v19 offset:53768
 ds_read_b64_tr_b16 v[122:123], v19 offset:54888
 ds_read_b64_tr_b16 v[132:133], v19 offset:56008
 s_waitcnt lgkmcnt(15)
 v_mfma_f32_4x4x4_16b_bf16 v[140:143], v[114:115], v[104:105], v[140:143]
 v_mfma_f32_4x4x4_16b_bf16 v[144:147], v[124:125], v[104:105], v[144:147]
 s_waitcnt lgkmcnt(14)
 v_mfma_f32_4x4x4_16b_bf16 v[148:151], v[134:135], v[104:105], v[148:151]
 ds_read_b64_tr_b16 v[114:115], v19 offset:53776
 ds_read_b64_tr_b16 v[124:125], v19 offset:54896
 ds_read_b64_tr_b16 v[134:135], v19 offset:56016
 s_waitcnt lgkmcnt(15)
 v_mfma_f32_4x4x4_16b_bf16 v[140:143], v[116:117], v[106:107], v[140:143]
 s_waitcnt lgkmcnt(14)
 v_mfma_f32_4x4x4_16b_bf16 v[144:147], v[126:127], v[106:107], v[144:147]
 s_waitcnt lgkmcnt(13)
 v_mfma_f32_4x4x4_16b_bf16 v[148:151], v[136:137], v[106:107], v[148:151]
 ds_read_b64_tr_b16 v[116:117], v19 offset:53784
 ds_read_b64_tr_b16 v[126:127], v19 offset:54904
 ds_read_b64_tr_b16 v[136:137], v19 offset:56024
 s_waitcnt lgkmcnt(14)
 v_mfma_f32_4x4x4_16b_bf16 v[140:143], v[118:119], v[108:109], v[140:143]
 s_waitcnt lgkmcnt(13)
 v_mfma_f32_4x4x4_16b_bf16 v[144:147], v[128:129], v[108:109], v[144:147]
 s_waitcnt lgkmcnt(12)
 v_mfma_f32_4x4x4_16b_bf16 v[148:151], v[138:139], v[108:109], v[148:151]
 ds_read_b64_tr_b16 v[118:119], v19 offset:53792
 ds_read_b64_tr_b16 v[128:129], v19 offset:54912
 ds_read_b64_tr_b16 v[138:139], v19 offset:56032
 s_nop 1
 v_cndmask_b32 v141, v149, v141, s[40:41]
 v_cndmask_b32 v142, v150, v142, s[42:43]
 v_cndmask_b32 v143, v151, v143, s[44:45]
 v_mov_b32 v140, v148
 v_max3_f32 v24, v144, v145, v146
 v_max3_f32 v25, v147, v148, v141
 v_max3_f32 v24, v24, v142, v143
 v_max_f32 v24, v24, v25
 v_mul_f32 v24, s50, v24
 v_pk_fma_f32 v[140:141], v[140:141], s[50:51], v[24:25] op_sel_hi:[1,1,0] neg_lo:[0,0,1] neg_hi:[0,0,1]
 v_pk_fma_f32 v[142:143], v[142:143], s[50:51], v[24:25] op_sel_hi:[1,1,0] neg_lo:[0,0,1] neg_hi:[0,0,1]
 v_pk_fma_f32 v[144:145], v[144:145], s[50:51], v[24:25] op_sel_hi:[1,1,0] neg_lo:[0,0,1] neg_hi:[0,0,1]
 v_pk_fma_f32 v[146:147], v[146:147], s[50:51], v[24:25] op_sel_hi:[1,1,0] neg_lo:[0,0,1] neg_hi:[0,0,1]
 v_exp_f32 v140, v140
 v_exp_f32 v141, v141
 v_exp_f32 v142, v142
 v_exp_f32 v143, v143
 v_exp_f32 v144, v144
 v_exp_f32 v145, v145
 v_exp_f32 v146, v146
 v_exp_f32 v147, v147
 v_pk_add_f32 v[24:25], v[140:141], v[142:143]
 v_pk_add_f32 v[26:27], v[144:145], v[146:147]
 v_pk_add_f32 v[24:25], v[24:25], v[26:27]
 v_add_f32 v24, v24, v25
 v_rcp_f32 v24, v24
 s_nop 0
 v_pk_mul_f32 v[140:141], v[140:141], v[24:25] op_sel_hi:[1,0]
 v_pk_mul_f32 v[142:143], v[142:143], v[24:25] op_sel_hi:[1,0]
 v_pk_mul_f32 v[144:145], v[144:145], v[24:25] op_sel_hi:[1,0]
 v_pk_mul_f32 v[146:147], v[146:147], v[24:25] op_sel_hi:[1,0]
 v_cvt_pk_bf16_f32 v102, v144, v145
 v_cvt_pk_bf16_f32 v103, v146, v147
 v_cndmask_b32 v149, v141, 0, s[40:41]
 v_cndmask_b32 v150, v142, 0, s[42:43]
 v_cndmask_b32 v151, v143, 0, s[44:45]
 v_cndmask_b32 v141, 0, v141, s[40:41]
 v_cndmask_b32 v142, 0, v142, s[42:43]
 v_cndmask_b32 v143, 0, v143, s[44:45]
 v_cvt_pk_bf16_f32 v104, v140, v149
 v_cvt_pk_bf16_f32 v105, v150, v151
 v_cvt_pk_bf16_f32 v100, 0, v141
 v_cvt_pk_bf16_f32 v101, v142, v143
 s_waitcnt lgkmcnt(13)
 v_mfma_f32_4x4x4_16b_bf16 v[140:143], v[120:121], v[102:103], 0
 s_waitcnt lgkmcnt(10)
 v_mfma_f32_4x4x4_16b_bf16 v[144:147], v[122:123], v[102:103], 0
 s_waitcnt lgkmcnt(7)
 v_mfma_f32_4x4x4_16b_bf16 v[148:151], v[124:125], v[102:103], 0
 s_waitcnt lgkmcnt(4)
 v_mfma_f32_4x4x4_16b_bf16 v[106:109], v[126:127], v[102:103], 0
 s_waitcnt lgkmcnt(1)
 v_mfma_f32_4x4x4_16b_bf16 v[24:27], v[128:129], v[102:103], 0
 v_mfma_f32_4x4x4_16b_bf16 v[140:143], v[130:131], v[104:105], v[140:143]
 v_mfma_f32_4x4x4_16b_bf16 v[144:147], v[132:133], v[104:105], v[144:147]
 v_mfma_f32_4x4x4_16b_bf16 v[148:151], v[134:135], v[104:105], v[148:151]
 v_mfma_f32_4x4x4_16b_bf16 v[106:109], v[136:137], v[104:105], v[106:109]
 s_waitcnt lgkmcnt(0)
 v_mfma_f32_4x4x4_16b_bf16 v[24:27], v[138:139], v[104:105], v[24:27]
 v_mfma_f32_4x4x4_16b_bf16 v[140:143], v[110:111], v[100:101], v[140:143]
 v_mfma_f32_4x4x4_16b_bf16 v[144:147], v[112:113], v[100:101], v[144:147]
 v_mfma_f32_4x4x4_16b_bf16 v[148:151], v[114:115], v[100:101], v[148:151]
 v_mfma_f32_4x4x4_16b_bf16 v[106:109], v[116:117], v[100:101], v[106:109]
 v_mfma_f32_4x4x4_16b_bf16 v[24:27], v[118:119], v[100:101], v[24:27]
 s_nop 0
 v_cvt_pk_bf16_f32 v112, v140, v141
 v_cvt_pk_bf16_f32 v113, v142, v143
 v_cvt_pk_bf16_f32 v114, v144, v145
 v_cvt_pk_bf16_f32 v115, v146, v147
 v_cvt_pk_bf16_f32 v116, v148, v149
 v_cvt_pk_bf16_f32 v117, v150, v151
 v_cvt_pk_bf16_f32 v118, v106, v107
 v_cvt_pk_bf16_f32 v119, v108, v109
 v_cvt_pk_bf16_f32 v120, v24, v25
 buffer_store_dwordx4 v[112:115], v20, s[24:27], s52 offen
 buffer_store_dwordx4 v[116:119], v20, s[24:27], s84 offen
 buffer_store_dword v120, v21, s[24:27], s85 offen
 s_add_u32 s39, s39, 64
L_q_done:
 s_endpgm
L_exit:
 s_endpgm
.globl fin_kernel
.p2align 8
.type fin_kernel,@function
fin_kernel:
 s_cmp_ge_u32 s2, 240
 s_cbranch_scc1 L_k2end
 s_load_dwordx2 s[36:37], s[0:1], 64
 s_load_dwordx2 s[4:5], s[0:1], 0
 s_load_dwordx2 s[8:9], s[0:1], 16
 s_load_dwordx2 s[10:11], s[0:1], 48
 v_lshrrev_b32 v1, 6, v0
 s_nop 0
 v_readfirstlane_b32 s28, v1
 v_and_b32 v1, 63, v0
 s_and_b32 s31, s2, 1
 s_lshl_b32 s31, s31, 2
 s_bfe_u32 s35, s2, 0x20001
 s_add_u32 s31, s31, s35
 s_mul_i32 s31, s31, 30
 s_lshr_b32 s35, s2, 3
 s_add_u32 s45, s31, s35
 s_cmp_ge_u32 s45, 234
 s_cbranch_scc1 L_k2end
 s_mul_i32 s29, s45, 57
 s_lshr_b32 s29, s29, 9
 s_mul_i32 s31, s29, 9
 s_sub_u32 s30, s45, s31
 s_mul_i32 s38, s29, 640
 v_lshlrev_b32 v12, 4, v1
 v_lshlrev_b32 v13, 3, v1
 s_mul_i32 s34, s45, 81920
 s_mul_i32 s31, s28, 2560
 s_add_u32 s34, s34, s31
 s_waitcnt lgkmcnt(0)
 s_add_u32 s12, s36, 33554432
 s_addc_u32 s13, s37, 0
 s_and_b32 s13, s13, 0xffff
 s_mov_b32 s14, 2359296
 s_mov_b32 s15, 0x20000
 s_mov_b32 s24, s36
 s_and_b32 s25, s37, 0xffff
 s_mov_b32 s26, 19169280
 s_mov_b32 s27, 0x20000
 buffer_load_dwordx4 v[172:175], v12, s[24:27], s34 offen
 buffer_load_dwordx4 v[176:179], v12, s[24:27], s34 offen offset:1024
 buffer_load_dwordx2 v[180:181], v13, s[24:27], s34 offen offset:2048
 s_add_u32 s34, s34, 10240
 s_mov_b32 s16, s8
 s_and_b32 s17, s9, 0xffff
 s_mov_b32 s18, 663552
 s_mov_b32 s19, 0x20000
 s_mov_b32 s20, s4
 s_and_b32 s21, s5, 0xffff
 s_mov_b32 s22, 2359296
 s_mov_b32 s23, 0x20000
 s_mov_b32 s48, s10
 s_and_b32 s49, s11, 0xffff
 s_mov_b32 s50, 2359296
 s_mov_b32 s51, 0x20000
 v_mov_b32 v15, v0
 v_mul_u32_u24 v16, 205, v15
 v_lshrrev_b32 v16, 13, v16
 v_mul_u32_u24 v5, 40, v16
 v_sub_u32 v5, v15, v5
 v_lshlrev_b32 v5, 4, v5
 v_lshl_add_u32 v5, v16, 14, v5
 v_add_u32 v5, s38, v5
 v_mul_u32_u24 v16, 205, v15
 v_lshrrev_b32 v16, 11, v16
 v_mul_u32_u24 v20, 10, v16
 v_sub_u32 v20, v15, v20
 v_lshlrev_b32 v20, 4, v20
 v_lshl_add_u32 v20, v16, 12, v20
 v_add_u32 v15, 256, v1
 v_mul_u32_u24 v16, 205, v15
 v_lshrrev_b32 v16, 13, v16
 v_mul_u32_u24 v6, 40, v16
 v_sub_u32 v6, v15, v6
 v_lshlrev_b32 v6, 4, v6
 v_lshl_add_u32 v6, v16, 14, v6
 v_add_u32 v6, s38, v6
 v_mul_u32_u24 v16, 205, v15
 v_lshrrev_b32 v16, 11, v16
 v_mul_u32_u24 v21, 10, v16
 v_sub_u32 v21, v15, v21
 v_lshlrev_b32 v21, 4, v21
 v_lshl_add_u32 v21, v16, 12, v21
 s_lshr_b32 s55, s38, 2
 s_add_u32 s55, s55, 2097152
 s_and_b32 s31, s28, 1
 s_lshl_b32 s31, s31, 1
 v_bfe_u32 v15, v1, 4, 1
 v_or_b32 v15, s31, v15
 v_bfe_u32 v16, v1, 1, 2
 v_xor_b32 v15, v15, v16
 v_lshlrev_b32 v15, 5, v15
 v_and_b32 v16, 1, v1
 v_lshl_add_u32 v11, v16, 4, v15
 s_lshl_b32 s31, s30, 7
 v_add_u32 v11, s31, v11
 s_lshr_b32 s31, s28, 1
 s_mul_i32 s31, s31, 18
 s_and_b32 s35, s28, 1
 s_lshl_b32 s35, s35, 3
 s_add_u32 s31, s31, s35
 v_lshrrev_b32 v15, 3, v1
 v_add_u32 v16, s31, v15
 v_mul_u32_u24 v16, 1152, v16
 v_add_u32 v7, v16, v11
 v_add_u32 v8, 40448, v7
 v_add_u32 v9, 80896, v7
 v_lshrrev_b32 v16, 1, v15
 v_mul_u32_u24 v16, 18, v16
 v_and_b32 v15, 1, v15
 s_mul_i32 s31, s28, 72
 s_add_u32 s31, s31, 16
 v_add3_u32 v15, v15, v16, s31
 v_mul_u32_u24 v15, 1152, v15
 v_add_u32 v15, v15, v11
 v_subrev_u32 v10, 1024, v15
 v_add_u32 v11, 329728, v15
 s_mul_i32 s33, s28, 3072
 s_lshl_b32 s46, s28, 10
 s_add_u32 s46, s46, 61440
 s_mul_i32 s47, s28, 5120
 s_lshl_b32 s44, s28, 17
 s_movk_i32 s52, 144
 v_bfe_u32 v15, v1, 3, 2
 v_xor_b32 v15, s28, v15
 v_lshlrev_b32 v15, 5, v15
 v_lshrrev_b32 v16, 4, v1
 v_mul_u32_u24 v16, 3072, v16
 v_add_u32 v15, v15, v16
 v_bfe_u32 v16, v1, 2, 2
 v_lshl_add_u32 v15, v16, 7, v15
 v_and_b32 v16, 3, v1
 v_lshl_add_u32 v2, v16, 3, v15
 v_and_b32 v15, 1, v1
 v_mul_u32_u24 v15, 40, v15
 v_bfe_u32 v16, v1, 1, 3
 v_add_u32 v15, v15, v16
 v_lshrrev_b32 v16, 4, v1
 v_mul_u32_u24 v3, 1280, v16
 v_lshl_add_u32 v22, v15, 2, v3
 v_lshl_add_u32 v3, v15, 4, v3
 v_add_u32 v22, 143360, v22
 v_add_u32 v23, 640, v22
 v_add_u32 v24, 5120, v22
 v_add_u32 v25, 5760, v22
 v_and_b32 v15, 15, v1
 v_add_u32 v3, 61440, v3
 v_add_u32 v4, 61440, v3
 v_mul_u32_u24 v15, 144, v15
 v_lshl_add_u32 v18, v16, 3, v15
 s_lshl_b32 s31, s28, 5
 v_add_u32 v18, s31, v18
 v_lshrrev_b32 v15, 3, v0
 v_and_b32 v16, 7, v0
 v_lshlrev_b32 v16, 4, v16
 v_mad_u32_u24 v19, v15, s52, v16
 v_mul_u32_u24 v15, 1152, v15
 v_add_u32 v14, v15, v16
 s_mul_i32 s39, s29, 92160
 s_lshl_b32 s31, s30, 7
 s_add_u32 s39, s39, s31
 s_add_u32 s53, s39, 36864
 s_add_u32 s54, s39, 73728
 s_cmp_ge_u32 s28, 2
 s_cselect_b32 s54, 0x7f000000, s54
 s_mov_b32 s40, 0x00003f80
 s_mov_b32 s41, 0x3f800000
 s_bitcmp1_b32 s2, 3
 s_cbranch_scc1 L_k2b
 s_add_u32 m0, s47, 65536
 s_add_u32 s31, s44, 0
 buffer_load_dwordx4 v6, s[12:15], s31 offen lds
 s_add_u32 m0, s46, 0
 s_mov_b32 s31, 0
 buffer_load_dwordx4 v5, s[12:15], s31 offen lds
 s_add_u32 m0, s46, 5120
 s_mov_b32 s31, 131072
 buffer_load_dwordx4 v5, s[12:15], s31 offen lds
 s_add_u32 m0, s46, 10240
 s_mov_b32 s31, 262144
 buffer_load_dwordx4 v5, s[12:15], s31 offen lds
 s_add_u32 m0, s33, 0
 s_mov_b32 s31, 0
 buffer_load_dwordx4 v7, s[16:19], s31 offen lds
 buffer_load_dwordx4 v8, s[16:19], s31 offen offset:1024 lds
 buffer_load_dwordx4 v9, s[16:19], s31 offen offset:2048 lds
 s_add_u32 m0, s47, 86016
 s_add_u32 s31, s44, 524288
 buffer_load_dwordx4 v6, s[12:15], s31 offen lds
 s_add_u32 m0, s46, 15360
 s_mov_b32 s31, 393216
 buffer_load_dwordx4 v5, s[12:15], s31 offen lds
 s_add_u32 m0, s46, 20480
 s_mov_b32 s31, 524288
 buffer_load_dwordx4 v5, s[12:15], s31 offen lds
 s_add_u32 m0, s46, 25600
 s_mov_b32 s31, 655360
 buffer_load_dwordx4 v5, s[12:15], s31 offen lds
 s_add_u32 m0, s33, 12288
 s_mov_b32 s31, 124416
 buffer_load_dwordx4 v7, s[16:19], s31 offen lds
 s_waitcnt vmcnt(14)
 v_lshlrev_b32 v72, 16, v172
 v_and_b32 v73, 0xffff0000, v172
 v_lshlrev_b32 v74, 16, v173
 v_and_b32 v75, 0xffff0000, v173
 v_lshlrev_b32 v76, 16, v174
 v_and_b32 v77, 0xffff0000, v174
 v_lshlrev_b32 v78, 16, v175
 v_and_b32 v79, 0xffff0000, v175
 s_waitcnt vmcnt(13)
 v_lshlrev_b32 v80, 16, v176
 v_and_b32 v81, 0xffff0000, v176
 v_lshlrev_b32 v82, 16, v177
 v_and_b32 v83, 0xffff0000, v177
 v_lshlrev_b32 v84, 16, v178
 v_and_b32 v85, 0xffff0000, v178
 v_lshlrev_b32 v86, 16, v179
 v_and_b32 v87, 0xffff0000, v179
 s_waitcnt vmcnt(12)
 v_lshlrev_b32 v88, 16, v180
 v_and_b32 v89, 0xffff0000, v180
 v_lshlrev_b32 v90, 16, v181
 v_and_b32 v91, 0xffff0000, v181
 buffer_load_dwordx4 v8, s[16:19], s31 offen offset:1024 lds
 buffer_load_dwordx4 v9, s[16:19], s31 offen offset:2048 lds
 s_add_u32 m0, s47, 106496
 s_add_u32 s31, s44, 1048576
 buffer_load_dwordx4 v6, s[12:15], s31 offen lds
 s_add_u32 m0, s46, 30720
 s_mov_b32 s31, 786432
 buffer_load_dwordx4 v5, s[12:15], s31 offen lds
 s_add_u32 m0, s46, 35840
 s_mov_b32 s31, 917504
 buffer_load_dwordx4 v5, s[12:15], s31 offen lds
 s_add_u32 m0, s46, 40960
 s_mov_b32 s31, 1048576
 buffer_load_dwordx4 v5, s[12:15], s31 offen lds
 s_add_u32 m0, s33, 24576
 s_mov_b32 s31, 248832
 buffer_load_dwordx4 v7, s[16:19], s31 offen lds
 s_waitcnt vmcnt(12)
 s_barrier
 ds_read_b64_tr_b16 v[48:49], v2 offset:0
 ds_read_b64_tr_b16 v[50:51], v2 offset:512
 ds_read_b64_tr_b16 v[52:53], v2 offset:1024
 ds_read_b64_tr_b16 v[54:55], v2 offset:1536
 ds_read_b64_tr_b16 v[56:57], v2 offset:2048
 ds_read_b64_tr_b16 v[58:59], v2 offset:2560
 ds_read_b128 a[0:3], v3 offset:512
 ds_read_b128 a[4:7], v3 offset:5632
 ds_read_b128 a[8:11], v3 offset:10752
 ds_read_b128 a[12:15], v3 offset:0
 ds_read_b128 a[16:19], v3 offset:5120
 ds_read_b128 a[20:23], v3 offset:10240
 ds_read_b128 a[24:27], v3 offset:128
 ds_read_b128 a[28:31], v3 offset:5248
 ds_read_b128 a[32:35], v3 offset:10368
 ds_read_b128 a[36:39], v3 offset:256
 ds_read_b128 a[40:43], v3 offset:5376
 ds_read_b128 a[44:47], v3 offset:10496
 ds_read_b128 a[48:51], v3 offset:384
 ds_read_b128 a[52:55], v3 offset:5504
 ds_read_b128 a[56:59], v3 offset:10624
 buffer_load_dwordx4 v8, s[16:19], s31 offen offset:1024 lds
 buffer_load_dwordx4 v9, s[16:19], s31 offen offset:2048 lds
 s_add_u32 m0, s46, 46080
 s_mov_b32 s31, 1179648
 buffer_load_dwordx4 v5, s[12:15], s31 offen lds
 s_add_u32 m0, s46, 51200
 s_mov_b32 s31, 1310720
 buffer_load_dwordx4 v5, s[12:15], s31 offen lds
 s_add_u32 m0, s46, 56320
 s_mov_b32 s31, 1441792
 buffer_load_dwordx4 v5, s[12:15], s31 offen lds
 s_add_u32 m0, s33, 36864
 s_mov_b32 s31, 373248
 buffer_load_dwordx4 v7, s[16:19], s31 offen lds
 buffer_load_dwordx4 v8, s[16:19], s31 offen offset:1024 lds
 s_waitcnt vmcnt(12) lgkmcnt(0)
 s_barrier
 v_mfma_f32_16x16x32_bf16 v[44:47], v[48:51], a[0:3], 0
 ds_read_b64_tr_b16 v[60:61], v2 offset:12288
 v_mfma_f32_16x16x32_bf16 v[44:47], v[52:55], a[4:7], v[44:47]
 ds_read_b64_tr_b16 v[62:63], v2 offset:12800
 ds_read_b64_tr_b16 v[64:65], v2 offset:13312
 v_mfma_f32_16x16x32_bf16 v[44:47], v[56:59], a[8:11], v[44:47]
 ds_read_b64_tr_b16 v[66:67], v2 offset:13824
 ds_read_b64_tr_b16 v[68:69], v2 offset:14336
 v_mfma_f32_16x16x32_bf16 v[28:31], v[48:51], a[12:15], 0
 ds_read_b64_tr_b16 v[70:71], v2 offset:14848
 ds_read_b128 a[60:63], v3 offset:15872
 v_mfma_f32_16x16x32_bf16 v[28:31], v[52:55], a[16:19], v[28:31]
 ds_read_b128 a[64:67], v3 offset:20992
 v_mfma_f32_16x16x32_bf16 v[28:31], v[56:59], a[20:23], v[28:31]
 ds_read_b128 a[68:71], v3 offset:26112
 ds_read_b128 a[72:75], v3 offset:15360
 v_mfma_f32_16x16x32_bf16 v[32:35], v[48:51], a[24:27], 0
 ds_read_b128 a[76:79], v3 offset:20480
 ds_read_b128 a[80:83], v3 offset:25600
 v_mfma_f32_16x16x32_bf16 v[32:35], v[52:55], a[28:31], v[32:35]
 ds_read_b128 a[84:87], v3 offset:15488
 ds_read_b128 a[88:91], v3 offset:20608
 v_mfma_f32_16x16x32_bf16 v[32:35], v[56:59], a[32:35], v[32:35]
 ds_read_b128 a[92:95], v3 offset:25728
 v_mfma_f32_16x16x32_bf16 v[36:39], v[48:51], a[36:39], 0
 ds_read_b128 a[96:99], v3 offset:15616
 ds_read_b128 a[100:103], v3 offset:20736
 v_mfma_f32_16x16x32_bf16 v[36:39], v[52:55], a[40:43], v[36:39]
 ds_read_b128 a[104:107], v3 offset:25856
 ds_read_b128 a[108:111], v3 offset:15744
 v_mfma_f32_16x16x32_bf16 v[36:39], v[56:59], a[44:47], v[36:39]
 ds_read_b128 a[112:115], v3 offset:20864
 ds_read_b128 a[116:119], v3 offset:25984
 v_mfma_f32_16x16x32_bf16 v[40:43], v[48:51], a[48:51], 0
 v_mfma_f32_16x16x32_bf16 v[40:43], v[52:55], a[52:55], v[40:43]
 v_mfma_f32_16x16x32_bf16 v[40:43], v[56:59], a[56:59], v[40:43]
 buffer_load_dwordx4 v9, s[16:19], s31 offen offset:2048 lds
 s_add_u32 m0, s47, 126976
 s_add_u32 s31, s44, 1572864
 buffer_load_dwordx4 v6, s[12:15], s31 offen lds
 s_add_u32 m0, s46, 61440
 s_mov_b32 s31, 1572864
 buffer_load_dwordx4 v5, s[12:15], s31 offen lds
 s_add_u32 m0, s46, 66560
 s_mov_b32 s31, 1703936
 buffer_load_dwordx4 v5, s[12:15], s31 offen lds
 s_add_u32 m0, s46, 71680
 s_mov_b32 s31, 1835008
 buffer_load_dwordx4 v5, s[12:15], s31 offen lds
 s_add_u32 m0, s33, 49152
 s_mov_b32 s31, 497664
 buffer_load_dwordx4 v7, s[16:19], s31 offen lds
 buffer_load_dwordx4 v8, s[16:19], s31 offen offset:1024 lds
 s_waitcnt vmcnt(12) lgkmcnt(0)
 s_barrier
 v_mfma_f32_16x16x32_bf16 v[44:47], v[60:63], a[60:63], v[44:47]
 ds_read_b64_tr_b16 v[48:49], v2 offset:24576
 v_mfma_f32_16x16x32_bf16 v[44:47], v[64:67], a[64:67], v[44:47]
 ds_read_b64_tr_b16 v[50:51], v2 offset:25088
 ds_read_b64_tr_b16 v[52:53], v2 offset:25600
 v_mfma_f32_16x16x32_bf16 v[44:47], v[68:71], a[68:71], v[44:47]
 ds_read_b64_tr_b16 v[54:55], v2 offset:26112
 ds_read_b64_tr_b16 v[56:57], v2 offset:26624
 v_mfma_f32_16x16x32_bf16 v[28:31], v[60:63], a[72:75], v[28:31]
 ds_read_b64_tr_b16 v[58:59], v2 offset:27136
 ds_read_b128 a[0:3], v3 offset:31232
 v_mfma_f32_16x16x32_bf16 v[28:31], v[64:67], a[76:79], v[28:31]
 ds_read_b128 a[4:7], v3 offset:36352
 v_mfma_f32_16x16x32_bf16 v[28:31], v[68:71], a[80:83], v[28:31]
 ds_read_b128 a[8:11], v3 offset:41472
 ds_read_b128 a[12:15], v3 offset:30720
 v_mfma_f32_16x16x32_bf16 v[32:35], v[60:63], a[84:87], v[32:35]
 ds_read_b128 a[16:19], v3 offset:35840
 ds_read_b128 a[20:23], v3 offset:40960
 v_mfma_f32_16x16x32_bf16 v[32:35], v[64:67], a[88:91], v[32:35]
 ds_read_b128 a[24:27], v3 offset:30848
 ds_read_b128 a[28:31], v3 offset:35968
 v_mfma_f32_16x16x32_bf16 v[32:35], v[68:71], a[92:95], v[32:35]
 ds_read_b128 a[32:35], v3 offset:41088
 v_mfma_f32_16x16x32_bf16 v[36:39], v[60:63], a[96:99], v[36:39]
 ds_read_b128 a[36:39], v3 offset:30976
 ds_read_b128 a[40:43], v3 offset:36096
 v_mfma_f32_16x16x32_bf16 v[36:39], v[64:67], a[100:103], v[36:39]
 ds_read_b128 a[44:47], v3 offset:41216
 ds_read_b128 a[48:51], v3 offset:31104
 v_mfma_f32_16x16x32_bf16 v[36:39], v[68:71], a[104:107], v[36:39]
 ds_read_b128 a[52:55], v3 offset:36224
 ds_read_b128 a[56:59], v3 offset:41344
 v_mfma_f32_16x16x32_bf16 v[40:43], v[60:63], a[108:111], v[40:43]
 v_mfma_f32_16x16x32_bf16 v[40:43], v[64:67], a[112:115], v[40:43]
 v_mfma_f32_16x16x32_bf16 v[40:43], v[68:71], a[116:119], v[40:43]
 buffer_load_dwordx4 v9, s[16:19], s31 offen offset:2048 lds
 buffer_load_dwordx4 v[182:185], v12, s[24:27], s34 offen
 buffer_load_dwordx4 v[186:189], v12, s[24:27], s34 offen offset:1024
 buffer_load_dwordx2 v[190:191], v13, s[24:27], s34 offen offset:2048
 s_add_u32 s34, s34, 10240
 buffer_load_dwordx4 v[192:195], v12, s[24:27], s34 offen
 buffer_load_dwordx4 v[196:199], v12, s[24:27], s34 offen offset:1024
 s_waitcnt vmcnt(12) lgkmcnt(0)
 s_barrier
 v_mfma_f32_16x16x32_bf16 v[44:47], v[48:51], a[0:3], v[44:47]
 ds_read_b64_tr_b16 v[60:61], v2 offset:36864
 v_mfma_f32_16x16x32_bf16 v[44:47], v[52:55], a[4:7], v[44:47]
 ds_read_b64_tr_b16 v[62:63], v2 offset:37376
 ds_read_b64_tr_b16 v[64:65], v2 offset:37888
 v_mfma_f32_16x16x32_bf16 v[44:47], v[56:59], a[8:11], v[44:47]
 ds_read_b64_tr_b16 v[66:67], v2 offset:38400
 ds_read_b64_tr_b16 v[68:69], v2 offset:38912
 v_mfma_f32_16x16x32_bf16 v[28:31], v[48:51], a[12:15], v[28:31]
 ds_read_b64_tr_b16 v[70:71], v2 offset:39424
 ds_read_b128 a[60:63], v3 offset:46592
 v_mfma_f32_16x16x32_bf16 v[28:31], v[52:55], a[16:19], v[28:31]
 ds_read_b128 a[64:67], v3 offset:51712
 v_mfma_f32_16x16x32_bf16 v[28:31], v[56:59], a[20:23], v[28:31]
 ds_read_b128 a[68:71], v3 offset:56832
 ds_read_b128 a[72:75], v3 offset:46080
 v_mfma_f32_16x16x32_bf16 v[32:35], v[48:51], a[24:27], v[32:35]
 ds_read_b128 a[76:79], v3 offset:51200
 ds_read_b128 a[80:83], v3 offset:56320
 v_mfma_f32_16x16x32_bf16 v[32:35], v[52:55], a[28:31], v[32:35]
 ds_read_b128 a[84:87], v3 offset:46208
 ds_read_b128 a[88:91], v3 offset:51328
 v_mfma_f32_16x16x32_bf16 v[32:35], v[56:59], a[32:35], v[32:35]
 ds_read_b128 a[92:95], v3 offset:56448
 v_mfma_f32_16x16x32_bf16 v[36:39], v[48:51], a[36:39], v[36:39]
 ds_read_b128 a[96:99], v3 offset:46336
 ds_read_b128 a[100:103], v3 offset:51456
 v_mfma_f32_16x16x32_bf16 v[36:39], v[52:55], a[40:43], v[36:39]
 ds_read_b128 a[104:107], v3 offset:56576
 ds_read_b128 a[108:111], v3 offset:46464
 v_mfma_f32_16x16x32_bf16 v[36:39], v[56:59], a[44:47], v[36:39]
 ds_read_b128 a[112:115], v3 offset:51584
 ds_read_b128 a[116:119], v3 offset:56704
 v_mfma_f32_16x16x32_bf16 v[40:43], v[48:51], a[48:51], v[40:43]
 v_mfma_f32_16x16x32_bf16 v[40:43], v[52:55], a[52:55], v[40:43]
 v_mfma_f32_16x16x32_bf16 v[40:43], v[56:59], a[56:59], v[40:43]
 buffer_load_dwordx2 v[200:201], v13, s[24:27], s34 offen offset:2048
 s_add_u32 s34, s34, 10240
 buffer_load_dwordx4 v[202:205], v12, s[24:27], s34 offen
 buffer_load_dwordx4 v[206:209], v12, s[24:27], s34 offen offset:1024
 buffer_load_dwordx2 v[210:211], v13, s[24:27], s34 offen offset:2048
 s_add_u32 s34, s34, 10240
 buffer_load_dwordx4 v[212:215], v12, s[24:27], s34 offen
 buffer_load_dwordx4 v[216:219], v12, s[24:27], s34 offen offset:1024
 buffer_load_dwordx2 v[220:221], v13, s[24:27], s34 offen offset:2048
 s_add_u32 s34, s34, 10240
 s_waitcnt vmcnt(12) lgkmcnt(0)
 s_barrier
 v_mfma_f32_16x16x32_bf16 v[44:47], v[60:63], a[60:63], v[44:47]
 ds_read_b64_tr_b16 v[48:49], v2 offset:49152
 v_mfma_f32_16x16x32_bf16 v[44:47], v[64:67], a[64:67], v[44:47]
 ds_read_b64_tr_b16 v[50:51], v2 offset:49664
 ds_read_b64_tr_b16 v[52:53], v2 offset:50176
 v_mfma_f32_16x16x32_bf16 v[44:47], v[68:71], a[68:71], v[44:47]
 ds_read_b64_tr_b16 v[54:55], v2 offset:50688
 ds_read_b64_tr_b16 v[56:57], v2 offset:51200
 v_mfma_f32_16x16x32_bf16 v[28:31], v[60:63], a[72:75], v[28:31]
 ds_read_b64_tr_b16 v[58:59], v2 offset:51712
 ds_read_b128 a[0:3], v4 offset:512
 v_mfma_f32_16x16x32_bf16 v[28:31], v[64:67], a[76:79], v[28:31]
 ds_read_b128 a[4:7], v4 offset:5632
 v_mfma_f32_16x16x32_bf16 v[28:31], v[68:71], a[80:83], v[28:31]
 ds_read_b128 a[8:11], v4 offset:10752
 ds_read_b128 a[12:15], v4 offset:0
 v_mfma_f32_16x16x32_bf16 v[32:35], v[60:63], a[84:87], v[32:35]
 ds_read_b128 a[16:19], v4 offset:5120
 ds_read_b128 a[20:23], v4 offset:10240
 v_mfma_f32_16x16x32_bf16 v[32:35], v[64:67], a[88:91], v[32:35]
 ds_read_b128 a[24:27], v4 offset:128
 ds_read_b128 a[28:31], v4 offset:5248
 v_mfma_f32_16x16x32_bf16 v[32:35], v[68:71], a[92:95], v[32:35]
 ds_read_b128 a[32:35], v4 offset:10368
 v_mfma_f32_16x16x32_bf16 v[36:39], v[60:63], a[96:99], v[36:39]
 ds_read_b128 a[36:39], v4 offset:256
 ds_read_b128 a[40:43], v4 offset:5376
 v_mfma_f32_16x16x32_bf16 v[36:39], v[64:67], a[100:103], v[36:39]
 ds_read_b128 a[44:47], v4 offset:10496
 ds_read_b128 a[48:51], v4 offset:384
 v_mfma_f32_16x16x32_bf16 v[36:39], v[68:71], a[104:107], v[36:39]
 ds_read_b128 a[52:55], v4 offset:5504
 ds_read_b128 a[56:59], v4 offset:10624
 v_mfma_f32_16x16x32_bf16 v[40:43], v[60:63], a[108:111], v[40:43]
 v_mfma_f32_16x16x32_bf16 v[40:43], v[64:67], a[112:115], v[40:43]
 v_mfma_f32_16x16x32_bf16 v[40:43], v[68:71], a[116:119], v[40:43]
 buffer_load_dwordx4 v[222:225], v12, s[24:27], s34 offen
 buffer_load_dwordx4 v[226:229], v12, s[24:27], s34 offen offset:1024
 buffer_load_dwordx2 v[230:231], v13, s[24:27], s34 offen offset:2048
 s_add_u32 s34, s34, 10240
 s_waitcnt vmcnt(14)
 v_dot2c_f32_bf16 v72, s40, v182
 v_dot2c_f32_bf16 v73, s41, v182
 v_dot2c_f32_bf16 v74, s40, v183
 v_dot2c_f32_bf16 v75, s41, v183
 v_dot2c_f32_bf16 v76, s40, v184
 v_dot2c_f32_bf16 v77, s41, v184
 v_dot2c_f32_bf16 v78, s40, v185
 v_dot2c_f32_bf16 v79, s41, v185
 s_waitcnt vmcnt(13)
 v_dot2c_f32_bf16 v80, s40, v186
 v_dot2c_f32_bf16 v81, s41, v186
 v_dot2c_f32_bf16 v82, s40, v187
 v_dot2c_f32_bf16 v83, s41, v187
 v_dot2c_f32_bf16 v84, s40, v188
 v_dot2c_f32_bf16 v85, s41, v188
 v_dot2c_f32_bf16 v86, s40, v189
 v_dot2c_f32_bf16 v87, s41, v189
 s_waitcnt vmcnt(12)
 v_dot2c_f32_bf16 v88, s40, v190
 v_dot2c_f32_bf16 v89, s41, v190
 v_dot2c_f32_bf16 v90, s40, v191
 v_dot2c_f32_bf16 v91, s41, v191
 buffer_load_dwordx4 v[232:235], v12, s[24:27], s34 offen
 buffer_load_dwordx4 v[236:239], v12, s[24:27], s34 offen offset:1024
 buffer_load_dwordx2 v[240:241], v13, s[24:27], s34 offen offset:2048
 s_add_u32 s34, s34, 10240
 s_waitcnt vmcnt(14)
 v_dot2c_f32_bf16 v72, s40, v192
 v_dot2c_f32_bf16 v73, s41, v192
 v_dot2c_f32_bf16 v74, s40, v193
 v_dot2c_f32_bf16 v75, s41, v193
 v_dot2c_f32_bf16 v76, s40, v194
 v_dot2c_f32_bf16 v77, s41, v194
 v_dot2c_f32_bf16 v78, s40, v195
 v_dot2c_f32_bf16 v79, s41, v195
 s_waitcnt vmcnt(13)
 v_dot2c_f32_bf16 v80, s40, v196
 v_dot2c_f32_bf16 v81, s41, v196
 v_dot2c_f32_bf16 v82, s40, v197
 v_dot2c_f32_bf16 v83, s41, v197
 v_dot2c_f32_bf16 v84, s40, v198
 v_dot2c_f32_bf16 v85, s41, v198
 v_dot2c_f32_bf16 v86, s40, v199
 v_dot2c_f32_bf16 v87, s41, v199
 s_waitcnt vmcnt(12)
 v_dot2c_f32_bf16 v88, s40, v200
 v_dot2c_f32_bf16 v89, s41, v200
 v_dot2c_f32_bf16 v90, s40, v201
 v_dot2c_f32_bf16 v91, s41, v201
 buffer_load_dwordx4 v[242:245], v12, s[24:27], s34 offen
 buffer_load_dwordx4 v[246:249], v12, s[24:27], s34 offen offset:1024
 buffer_load_dwordx2 v[250:251], v13, s[24:27], s34 offen offset:2048
 s_waitcnt vmcnt(14)
 v_dot2c_f32_bf16 v72, s40, v202
 v_dot2c_f32_bf16 v73, s41, v202
 v_dot2c_f32_bf16 v74, s40, v203
 v_dot2c_f32_bf16 v75, s41, v203
 v_dot2c_f32_bf16 v76, s40, v204
 v_dot2c_f32_bf16 v77, s41, v204
 v_dot2c_f32_bf16 v78, s40, v205
 v_dot2c_f32_bf16 v79, s41, v205
 s_waitcnt vmcnt(13)
 v_dot2c_f32_bf16 v80, s40, v206
 v_dot2c_f32_bf16 v81, s41, v206
 v_dot2c_f32_bf16 v82, s40, v207
 v_dot2c_f32_bf16 v83, s41, v207
 v_dot2c_f32_bf16 v84, s40, v208
 v_dot2c_f32_bf16 v85, s41, v208
 v_dot2c_f32_bf16 v86, s40, v209
 v_dot2c_f32_bf16 v87, s41, v209
 s_waitcnt vmcnt(12)
 v_dot2c_f32_bf16 v88, s40, v210
 v_dot2c_f32_bf16 v89, s41, v210
 v_dot2c_f32_bf16 v90, s40, v211
 v_dot2c_f32_bf16 v91, s41, v211
 buffer_load_dwordx4 v[112:115], v14, s[20:23], s39 offen
 buffer_load_dwordx4 v[116:119], v14, s[20:23], s53 offen
 buffer_load_dwordx4 v[120:123], v14, s[20:23], s54 offen
 s_waitcnt vmcnt(14)
 v_dot2c_f32_bf16 v72, s40, v212
 v_dot2c_f32_bf16 v73, s41, v212
 v_dot2c_f32_bf16 v74, s40, v213
 v_dot2c_f32_bf16 v75, s41, v213
 v_dot2c_f32_bf16 v76, s40, v214
 v_dot2c_f32_bf16 v77, s41, v214
 v_dot2c_f32_bf16 v78, s40, v215
 v_dot2c_f32_bf16 v79, s41, v215
 s_waitcnt vmcnt(13)
 v_dot2c_f32_bf16 v80, s40, v216
 v_dot2c_f32_bf16 v81, s41, v216
 v_dot2c_f32_bf16 v82, s40, v217
 v_dot2c_f32_bf16 v83, s41, v217
 v_dot2c_f32_bf16 v84, s40, v218
 v_dot2c_f32_bf16 v85, s41, v218
 v_dot2c_f32_bf16 v86, s40, v219
 v_dot2c_f32_bf16 v87, s41, v219
 s_waitcnt vmcnt(12)
 v_dot2c_f32_bf16 v88, s40, v220
 v_dot2c_f32_bf16 v89, s41, v220
 v_dot2c_f32_bf16 v90, s40, v221
 v_dot2c_f32_bf16 v91, s41, v221
 s_add_u32 m0, s46, 76800
 s_mov_b32 s31, 1966080
 buffer_load_dwordx4 v5, s[12:15], s31 offen lds
 s_add_u32 m0, s46, 81920
 s_add_u32 s31, s55, 0
 buffer_load_dwordx4 v20, s[12:15], s31 offen lds
 s_add_u32 m0, s46, 87040
 s_add_u32 s31, s55, 131072
 buffer_load_dwordx4 v20, s[12:15], s31 offen lds
 s_waitcnt vmcnt(14)
 v_dot2c_f32_bf16 v72, s40, v222
 v_dot2c_f32_bf16 v73, s41, v222
 v_dot2c_f32_bf16 v74, s40, v223
 v_dot2c_f32_bf16 v75, s41, v223
 v_dot2c_f32_bf16 v76, s40, v224
 v_dot2c_f32_bf16 v77, s41, v224
 v_dot2c_f32_bf16 v78, s40, v225
 v_dot2c_f32_bf16 v79, s41, v225
 s_waitcnt vmcnt(13)
 v_dot2c_f32_bf16 v80, s40, v226
 v_dot2c_f32_bf16 v81, s41, v226
 v_dot2c_f32_bf16 v82, s40, v227
 v_dot2c_f32_bf16 v83, s41, v227
 v_dot2c_f32_bf16 v84, s40, v228
 v_dot2c_f32_bf16 v85, s41, v228
 v_dot2c_f32_bf16 v86, s40, v229
 v_dot2c_f32_bf16 v87, s41, v229
 s_waitcnt vmcnt(12)
 v_dot2c_f32_bf16 v88, s40, v230
 v_dot2c_f32_bf16 v89, s41, v230
 v_dot2c_f32_bf16 v90, s40, v231
 v_dot2c_f32_bf16 v91, s41, v231
 s_and_b32 s31, s28, 1
 s_mul_i32 s35, s31, 5120
 s_add_u32 m0, s35, 147456
 s_lshl_b32 s31, s31, 17
 s_add_u32 s31, s31, s55
 buffer_load_dwordx4 v21, s[12:15], s31 offen lds
 s_add_u32 m0, s33, 0
 s_mov_b32 s31, 622080
 buffer_load_dwordx4 v7, s[16:19], s31 offen lds
 buffer_load_dwordx4 v10, s[16:19], 0 offen offset:1024 lds
 s_waitcnt vmcnt(14)
 v_dot2c_f32_bf16 v72, s40, v232
 v_dot2c_f32_bf16 v73, s41, v232
 v_dot2c_f32_bf16 v74, s40, v233
 v_dot2c_f32_bf16 v75, s41, v233
 v_dot2c_f32_bf16 v76, s40, v234
 v_dot2c_f32_bf16 v77, s41, v234
 v_dot2c_f32_bf16 v78, s40, v235
 v_dot2c_f32_bf16 v79, s41, v235
 s_waitcnt vmcnt(13)
 v_dot2c_f32_bf16 v80, s40, v236
 v_dot2c_f32_bf16 v81, s41, v236
 v_dot2c_f32_bf16 v82, s40, v237
 v_dot2c_f32_bf16 v83, s41, v237
 v_dot2c_f32_bf16 v84, s40, v238
 v_dot2c_f32_bf16 v85, s41, v238
 v_dot2c_f32_bf16 v86, s40, v239
 v_dot2c_f32_bf16 v87, s41, v239
 s_waitcnt vmcnt(12)
 v_dot2c_f32_bf16 v88, s40, v240
 v_dot2c_f32_bf16 v89, s41, v240
 v_dot2c_f32_bf16 v90, s40, v241
 v_dot2c_f32_bf16 v91, s41, v241
 buffer_load_dwordx4 v11, s[16:19], 0 offen offset:2048 lds
 s_waitcnt vmcnt(12)
 v_dot2c_f32_bf16 v72, s40, v242
 v_dot2c_f32_bf16 v73, s41, v242
 v_dot2c_f32_bf16 v74, s40, v243
 v_dot2c_f32_bf16 v75, s41, v243
 v_dot2c_f32_bf16 v76, s40, v244
 v_dot2c_f32_bf16 v77, s41, v244
 v_dot2c_f32_bf16 v78, s40, v245
 v_dot2c_f32_bf16 v79, s41, v245
 s_waitcnt vmcnt(11)
 v_dot2c_f32_bf16 v80, s40, v246
 v_dot2c_f32_bf16 v81, s41, v246
 v_dot2c_f32_bf16 v82, s40, v247
 v_dot2c_f32_bf16 v83, s41, v247
 v_dot2c_f32_bf16 v84, s40, v248
 v_dot2c_f32_bf16 v85, s41, v248
 v_dot2c_f32_bf16 v86, s40, v249
 v_dot2c_f32_bf16 v87, s41, v249
 s_waitcnt vmcnt(10)
 v_dot2c_f32_bf16 v88, s40, v250
 v_dot2c_f32_bf16 v89, s41, v250
 v_dot2c_f32_bf16 v90, s40, v251
 v_dot2c_f32_bf16 v91, s41, v251
 v_exp_f32 v92, v72
 v_exp_f32 v93, v73
 v_exp_f32 v94, v74
 v_exp_f32 v95, v75
 v_exp_f32 v96, v76
 v_exp_f32 v97, v77
 v_exp_f32 v98, v78
 v_exp_f32 v99, v79
 v_exp_f32 v100, v80
 v_exp_f32 v101, v81
 v_exp_f32 v102, v82
 v_exp_f32 v103, v83
 v_exp_f32 v104, v84
 v_exp_f32 v105, v85
 v_exp_f32 v106, v86
 v_exp_f32 v107, v87
 v_exp_f32 v108, v88
 v_exp_f32 v109, v89
 v_exp_f32 v110, v90
 v_exp_f32 v111, v91
 v_pk_add_f32 v[92:93], v[92:93], 1.0 op_sel_hi:[1,0]
 v_pk_add_f32 v[94:95], v[94:95], 1.0 op_sel_hi:[1,0]
 v_pk_add_f32 v[96:97], v[96:97], 1.0 op_sel_hi:[1,0]
 v_pk_add_f32 v[98:99], v[98:99], 1.0 op_sel_hi:[1,0]
 v_pk_add_f32 v[100:101], v[100:101], 1.0 op_sel_hi:[1,0]
 v_pk_add_f32 v[102:103], v[102:103], 1.0 op_sel_hi:[1,0]
 v_pk_add_f32 v[104:105], v[104:105], 1.0 op_sel_hi:[1,0]
 v_pk_add_f32 v[106:107], v[106:107], 1.0 op_sel_hi:[1,0]
 v_pk_add_f32 v[108:109], v[108:109], 1.0 op_sel_hi:[1,0]
 v_pk_add_f32 v[110:111], v[110:111], 1.0 op_sel_hi:[1,0]
 v_rcp_f32 v92, v92
 v_rcp_f32 v93, v93
 v_rcp_f32 v94, v94
 v_rcp_f32 v95, v95
 v_rcp_f32 v96, v96
 v_rcp_f32 v97, v97
 v_rcp_f32 v98, v98
 v_rcp_f32 v99, v99
 v_rcp_f32 v100, v100
 v_rcp_f32 v101, v101
 v_rcp_f32 v102, v102
 v_rcp_f32 v103, v103
 v_rcp_f32 v104, v104
 v_rcp_f32 v105, v105
 v_rcp_f32 v106, v106
 v_rcp_f32 v107, v107
 v_rcp_f32 v108, v108
 v_rcp_f32 v109, v109
 v_rcp_f32 v110, v110
 v_rcp_f32 v111, v111
 v_pk_mul_f32 v[92:93], v[92:93], v[72:73]
 v_pk_mul_f32 v[94:95], v[94:95], v[74:75]
 v_pk_mul_f32 v[96:97], v[96:97], v[76:77]
 v_pk_mul_f32 v[98:99], v[98:99], v[78:79]
 v_pk_mul_f32 v[100:101], v[100:101], v[80:81]
 v_pk_mul_f32 v[102:103], v[102:103], v[82:83]
 v_pk_mul_f32 v[104:105], v[104:105], v[84:85]
 v_pk_mul_f32 v[106:107], v[106:107], v[86:87]
 v_pk_mul_f32 v[108:109], v[108:109], v[88:89]
 v_pk_mul_f32 v[110:111], v[110:111], v[90:91]
 s_mov_b32 s42, 0xbf317218
 s_mov_b32 s43, 0xbf317218
 v_pk_mul_f32 v[92:93], v[92:93], s[42:43]
 v_pk_mul_f32 v[94:95], v[94:95], s[42:43]
 v_pk_mul_f32 v[96:97], v[96:97], s[42:43]
 v_pk_mul_f32 v[98:99], v[98:99], s[42:43]
 v_pk_mul_f32 v[100:101], v[100:101], s[42:43]
 v_pk_mul_f32 v[102:103], v[102:103], s[42:43]
 v_pk_mul_f32 v[104:105], v[104:105], s[42:43]
 v_pk_mul_f32 v[106:107], v[106:107], s[42:43]
 v_pk_mul_f32 v[108:109], v[108:109], s[42:43]
 v_pk_mul_f32 v[110:111], v[110:111], s[42:43]
 s_waitcnt vmcnt(9)
 v_lshlrev_b32 v136, 16, v112
 v_and_b32 v137, 0xffff0000, v112
 v_lshlrev_b32 v138, 16, v113
 v_and_b32 v139, 0xffff0000, v113
 v_lshlrev_b32 v140, 16, v114
 v_and_b32 v141, 0xffff0000, v114
 v_lshlrev_b32 v142, 16, v115
 v_and_b32 v143, 0xffff0000, v115
 s_waitcnt vmcnt(8)
 v_lshlrev_b32 v144, 16, v116
 v_and_b32 v145, 0xffff0000, v116
 v_lshlrev_b32 v146, 16, v117
 v_and_b32 v147, 0xffff0000, v117
 v_lshlrev_b32 v148, 16, v118
 v_and_b32 v149, 0xffff0000, v118
 v_lshlrev_b32 v150, 16, v119
 v_and_b32 v151, 0xffff0000, v119
 s_waitcnt vmcnt(7)
 v_lshlrev_b32 v152, 16, v120
 v_and_b32 v153, 0xffff0000, v120
 v_lshlrev_b32 v154, 16, v121
 v_and_b32 v155, 0xffff0000, v121
 v_lshlrev_b32 v156, 16, v122
 v_and_b32 v157, 0xffff0000, v122
 v_lshlrev_b32 v158, 16, v123
 v_and_b32 v159, 0xffff0000, v123
 s_waitcnt vmcnt(0) lgkmcnt(0)
 s_barrier
 v_mfma_f32_16x16x32_bf16 v[44:47], v[48:51], a[0:3], v[44:47]
 ds_read_b64_tr_b16 v[60:61], v2 offset:0
 ds_read_b64_tr_b16 v[62:63], v2 offset:512
 v_mfma_f32_16x16x32_bf16 v[44:47], v[52:55], a[4:7], v[44:47]
 ds_read_b64_tr_b16 v[64:65], v2 offset:1024
 ds_read_b64_tr_b16 v[66:67], v2 offset:1536
 ds_read_b64_tr_b16 v[68:69], v2 offset:2048
 v_mfma_f32_16x16x32_bf16 v[44:47], v[56:59], a[8:11], v[44:47]
 ds_read_b64_tr_b16 v[70:71], v2 offset:2560
 ds_read_b128 a[60:63], v4 offset:15872
 v_mfma_f32_16x16x32_bf16 v[28:31], v[48:51], a[12:15], v[28:31]
 ds_read2_b32 a[64:65], v22 offset0:32 offset1:112
 ds_read2_b32 a[66:67], v23 offset0:32 offset1:112
 ds_read2_b32 a[68:69], v24 offset0:32 offset1:112
 v_mfma_f32_16x16x32_bf16 v[28:31], v[52:55], a[16:19], v[28:31]
 ds_read2_b32 a[70:71], v25 offset0:32 offset1:112
 ds_read_b128 a[72:75], v4 offset:15360
 v_mfma_f32_16x16x32_bf16 v[28:31], v[56:59], a[20:23], v[28:31]
 ds_read2_b32 a[76:77], v22 offset0:0 offset1:80
 ds_read2_b32 a[78:79], v23 offset0:0 offset1:80
 ds_read2_b32 a[80:81], v24 offset0:0 offset1:80
 v_mfma_f32_16x16x32_bf16 v[32:35], v[48:51], a[24:27], v[32:35]
 ds_read2_b32 a[82:83], v25 offset0:0 offset1:80
 ds_read_b128 a[84:87], v4 offset:15488
 ds_read2_b32 a[88:89], v22 offset0:8 offset1:88
 v_mfma_f32_16x16x32_bf16 v[32:35], v[52:55], a[28:31], v[32:35]
 ds_read2_b32 a[90:91], v23 offset0:8 offset1:88
 ds_read2_b32 a[92:93], v24 offset0:8 offset1:88
 v_mfma_f32_16x16x32_bf16 v[32:35], v[56:59], a[32:35], v[32:35]
 ds_read2_b32 a[94:95], v25 offset0:8 offset1:88
 ds_read_b128 a[96:99], v4 offset:15616
 ds_read2_b32 a[100:101], v22 offset0:16 offset1:96
 v_mfma_f32_16x16x32_bf16 v[36:39], v[48:51], a[36:39], v[36:39]
 ds_read2_b32 a[102:103], v23 offset0:16 offset1:96
 ds_read2_b32 a[104:105], v24 offset0:16 offset1:96
 v_mfma_f32_16x16x32_bf16 v[36:39], v[52:55], a[40:43], v[36:39]
 ds_read2_b32 a[106:107], v25 offset0:16 offset1:96
 ds_read_b128 a[108:111], v4 offset:15744
 ds_read2_b32 a[112:113], v22 offset0:24 offset1:104
 v_mfma_f32_16x16x32_bf16 v[36:39], v[56:59], a[44:47], v[36:39]
 ds_read2_b32 a[114:115], v23 offset0:24 offset1:104
 ds_read2_b32 a[116:117], v24 offset0:24 offset1:104
 ds_read2_b32 a[118:119], v25 offset0:24 offset1:104
 v_mfma_f32_16x16x32_bf16 v[40:43], v[48:51], a[48:51], v[40:43]
 v_mfma_f32_16x16x32_bf16 v[40:43], v[52:55], a[52:55], v[40:43]
 v_mfma_f32_16x16x32_bf16 v[40:43], v[56:59], a[56:59], v[40:43]
 s_waitcnt lgkmcnt(15)
 v_mfma_f32_16x16x32_bf16 v[44:47], v[60:63], a[60:63], v[44:47]
 v_mfma_f32_16x16x32_bf16 v[44:47], v[64:67], a[64:67], v[44:47]
 v_mfma_f32_16x16x32_bf16 v[44:47], v[68:71], a[68:71], v[44:47]
 v_mfma_f32_16x16x32_bf16 v[28:31], v[60:63], a[72:75], v[28:31]
 v_mfma_f32_16x16x32_bf16 v[28:31], v[64:67], a[76:79], v[28:31]
 v_mfma_f32_16x16x32_bf16 v[28:31], v[68:71], a[80:83], v[28:31]
 s_waitcnt lgkmcnt(14)
 v_mfma_f32_16x16x32_bf16 v[32:35], v[60:63], a[84:87], v[32:35]
 s_waitcnt lgkmcnt(12)
 v_mfma_f32_16x16x32_bf16 v[32:35], v[64:67], a[88:91], v[32:35]
 s_waitcnt lgkmcnt(10)
 v_mfma_f32_16x16x32_bf16 v[32:35], v[68:71], a[92:95], v[32:35]
 s_waitcnt lgkmcnt(9)
 v_mfma_f32_16x16x32_bf16 v[36:39], v[60:63], a[96:99], v[36:39]
 s_waitcnt lgkmcnt(7)
 v_mfma_f32_16x16x32_bf16 v[36:39], v[64:67], a[100:103], v[36:39]
 s_waitcnt lgkmcnt(5)
 v_mfma_f32_16x16x32_bf16 v[36:39], v[68:71], a[104:107], v[36:39]
 s_waitcnt lgkmcnt(4)
 v_mfma_f32_16x16x32_bf16 v[40:43], v[60:63], a[108:111], v[40:43]
 s_waitcnt lgkmcnt(2)
 v_mfma_f32_16x16x32_bf16 v[40:43], v[64:67], a[112:115], v[40:43]
 s_waitcnt lgkmcnt(0)
 v_mfma_f32_16x16x32_bf16 v[40:43], v[68:71], a[116:119], v[40:43]
 v_pk_mul_f32 v[92:93], v[44:45], v[92:93]
 v_pk_mul_f32 v[94:95], v[46:47], v[94:95]
 v_cvt_pk_bf16_f32 v72, v92, v93
 v_cvt_pk_bf16_f32 v73, v94, v95
 ds_write_b64 v18, v[72:73] offset:21504
 v_pk_mul_f32 v[96:97], v[28:29], v[96:97]
 v_pk_mul_f32 v[98:99], v[30:31], v[98:99]
 v_cvt_pk_bf16_f32 v74, v96, v97
 v_cvt_pk_bf16_f32 v75, v98, v99
 ds_write_b64 v18, v[74:75] offset:12288
 v_pk_mul_f32 v[100:101], v[32:33], v[100:101]
 v_pk_mul_f32 v[102:103], v[34:35], v[102:103]
 v_cvt_pk_bf16_f32 v76, v100, v101
 v_cvt_pk_bf16_f32 v77, v102, v103
 ds_write_b64 v18, v[76:77] offset:14592
 v_pk_mul_f32 v[104:105], v[36:37], v[104:105]
 v_pk_mul_f32 v[106:107], v[38:39], v[106:107]
 v_cvt_pk_bf16_f32 v78, v104, v105
 v_cvt_pk_bf16_f32 v79, v106, v107
 ds_write_b64 v18, v[78:79] offset:16896
 v_pk_mul_f32 v[108:109], v[40:41], v[108:109]
 v_pk_mul_f32 v[110:111], v[42:43], v[110:111]
 v_cvt_pk_bf16_f32 v80, v108, v109
 v_cvt_pk_bf16_f32 v81, v110, v111
 ds_write_b64 v18, v[80:81] offset:19200
 s_waitcnt lgkmcnt(0)
 s_barrier
 ds_read_b128 v[124:127], v19 offset:12288
 ds_read_b128 v[128:131], v19 offset:16896
 ds_read_b128 v[132:135], v19 offset:21504
 s_waitcnt lgkmcnt(2)
 v_dot2c_f32_bf16 v136, s40, v124
 v_dot2c_f32_bf16 v137, s41, v124
 v_dot2c_f32_bf16 v138, s40, v125
 v_dot2c_f32_bf16 v139, s41, v125
 v_dot2c_f32_bf16 v140, s40, v126
 v_dot2c_f32_bf16 v141, s41, v126
 v_dot2c_f32_bf16 v142, s40, v127
 v_dot2c_f32_bf16 v143, s41, v127
 v_cvt_pk_bf16_f32 v112, v136, v137
 v_cvt_pk_bf16_f32 v113, v138, v139
 v_cvt_pk_bf16_f32 v114, v140, v141
 v_cvt_pk_bf16_f32 v115, v142, v143
 buffer_store_dwordx4 v[112:115], v14, s[48:51], s39 offen
 s_waitcnt lgkmcnt(1)
 v_dot2c_f32_bf16 v144, s40, v128
 v_dot2c_f32_bf16 v145, s41, v128
 v_dot2c_f32_bf16 v146, s40, v129
 v_dot2c_f32_bf16 v147, s41, v129
 v_dot2c_f32_bf16 v148, s40, v130
 v_dot2c_f32_bf16 v149, s41, v130
 v_dot2c_f32_bf16 v150, s40, v131
 v_dot2c_f32_bf16 v151, s41, v131
 v_cvt_pk_bf16_f32 v116, v144, v145
 v_cvt_pk_bf16_f32 v117, v146, v147
 v_cvt_pk_bf16_f32 v118, v148, v149
 v_cvt_pk_bf16_f32 v119, v150, v151
 buffer_store_dwordx4 v[116:119], v14, s[48:51], s53 offen
 s_waitcnt lgkmcnt(0)
 v_dot2c_f32_bf16 v152, s40, v132
 v_dot2c_f32_bf16 v153, s41, v132
 v_dot2c_f32_bf16 v154, s40, v133
 v_dot2c_f32_bf16 v155, s41, v133
 v_dot2c_f32_bf16 v156, s40, v134
 v_dot2c_f32_bf16 v157, s41, v134
 v_dot2c_f32_bf16 v158, s40, v135
 v_dot2c_f32_bf16 v159, s41, v135
 v_cvt_pk_bf16_f32 v120, v152, v153
 v_cvt_pk_bf16_f32 v121, v154, v155
 v_cvt_pk_bf16_f32 v122, v156, v157
 v_cvt_pk_bf16_f32 v123, v158, v159
 buffer_store_dwordx4 v[120:123], v14, s[48:51], s54 offen
 s_endpgm
L_k2b:
 buffer_load_dwordx4 v[182:185], v12, s[24:27], s34 offen
 buffer_load_dwordx4 v[186:189], v12, s[24:27], s34 offen offset:1024
 buffer_load_dwordx2 v[190:191], v13, s[24:27], s34 offen offset:2048
 s_add_u32 s34, s34, 10240
 buffer_load_dwordx4 v[192:195], v12, s[24:27], s34 offen
 buffer_load_dwordx4 v[196:199], v12, s[24:27], s34 offen offset:1024
 buffer_load_dwordx2 v[200:201], v13, s[24:27], s34 offen offset:2048
 s_add_u32 s34, s34, 10240
 buffer_load_dwordx4 v[202:205], v12, s[24:27], s34 offen
 buffer_load_dwordx4 v[206:209], v12, s[24:27], s34 offen offset:1024
 buffer_load_dwordx2 v[210:211], v13, s[24:27], s34 offen offset:2048
 s_add_u32 s34, s34, 10240
 buffer_load_dwordx4 v[212:215], v12, s[24:27], s34 offen
 buffer_load_dwordx4 v[216:219], v12, s[24:27], s34 offen offset:1024
 buffer_load_dwordx2 v[220:221], v13, s[24:27], s34 offen offset:2048
 s_add_u32 s34, s34, 10240
 s_waitcnt vmcnt(14)
 v_lshlrev_b32 v72, 16, v172
 v_and_b32 v73, 0xffff0000, v172
 v_lshlrev_b32 v74, 16, v173
 v_and_b32 v75, 0xffff0000, v173
 v_lshlrev_b32 v76, 16, v174
 v_and_b32 v77, 0xffff0000, v174
 v_lshlrev_b32 v78, 16, v175
 v_and_b32 v79, 0xffff0000, v175
 s_waitcnt vmcnt(13)
 v_lshlrev_b32 v80, 16, v176
 v_and_b32 v81, 0xffff0000, v176
 v_lshlrev_b32 v82, 16, v177
 v_and_b32 v83, 0xffff0000, v177
 v_lshlrev_b32 v84, 16, v178
 v_and_b32 v85, 0xffff0000, v178
 v_lshlrev_b32 v86, 16, v179
 v_and_b32 v87, 0xffff0000, v179
 s_waitcnt vmcnt(12)
 v_lshlrev_b32 v88, 16, v180
 v_and_b32 v89, 0xffff0000, v180
 v_lshlrev_b32 v90, 16, v181
 v_and_b32 v91, 0xffff0000, v181
 buffer_load_dwordx4 v[222:225], v12, s[24:27], s34 offen
 buffer_load_dwordx4 v[226:229], v12, s[24:27], s34 offen offset:1024
 buffer_load_dwordx2 v[230:231], v13, s[24:27], s34 offen offset:2048
 s_add_u32 s34, s34, 10240
 s_waitcnt vmcnt(14)
 v_dot2c_f32_bf16 v72, s40, v182
 v_dot2c_f32_bf16 v73, s41, v182
 v_dot2c_f32_bf16 v74, s40, v183
 v_dot2c_f32_bf16 v75, s41, v183
 v_dot2c_f32_bf16 v76, s40, v184
 v_dot2c_f32_bf16 v77, s41, v184
 v_dot2c_f32_bf16 v78, s40, v185
 v_dot2c_f32_bf16 v79, s41, v185
 s_waitcnt vmcnt(13)
 v_dot2c_f32_bf16 v80, s40, v186
 v_dot2c_f32_bf16 v81, s41, v186
 v_dot2c_f32_bf16 v82, s40, v187
 v_dot2c_f32_bf16 v83, s41, v187
 v_dot2c_f32_bf16 v84, s40, v188
 v_dot2c_f32_bf16 v85, s41, v188
 v_dot2c_f32_bf16 v86, s40, v189
 v_dot2c_f32_bf16 v87, s41, v189
 s_waitcnt vmcnt(12)
 v_dot2c_f32_bf16 v88, s40, v190
 v_dot2c_f32_bf16 v89, s41, v190
 v_dot2c_f32_bf16 v90, s40, v191
 v_dot2c_f32_bf16 v91, s41, v191
 buffer_load_dwordx4 v[232:235], v12, s[24:27], s34 offen
 buffer_load_dwordx4 v[236:239], v12, s[24:27], s34 offen offset:1024
 buffer_load_dwordx2 v[240:241], v13, s[24:27], s34 offen offset:2048
 s_add_u32 s34, s34, 10240
 s_waitcnt vmcnt(14)
 v_dot2c_f32_bf16 v72, s40, v192
 v_dot2c_f32_bf16 v73, s41, v192
 v_dot2c_f32_bf16 v74, s40, v193
 v_dot2c_f32_bf16 v75, s41, v193
 v_dot2c_f32_bf16 v76, s40, v194
 v_dot2c_f32_bf16 v77, s41, v194
 v_dot2c_f32_bf16 v78, s40, v195
 v_dot2c_f32_bf16 v79, s41, v195
 s_waitcnt vmcnt(13)
 v_dot2c_f32_bf16 v80, s40, v196
 v_dot2c_f32_bf16 v81, s41, v196
 v_dot2c_f32_bf16 v82, s40, v197
 v_dot2c_f32_bf16 v83, s41, v197
 v_dot2c_f32_bf16 v84, s40, v198
 v_dot2c_f32_bf16 v85, s41, v198
 v_dot2c_f32_bf16 v86, s40, v199
 v_dot2c_f32_bf16 v87, s41, v199
 s_waitcnt vmcnt(12)
 v_dot2c_f32_bf16 v88, s40, v200
 v_dot2c_f32_bf16 v89, s41, v200
 v_dot2c_f32_bf16 v90, s40, v201
 v_dot2c_f32_bf16 v91, s41, v201
 buffer_load_dwordx4 v[242:245], v12, s[24:27], s34 offen
 buffer_load_dwordx4 v[246:249], v12, s[24:27], s34 offen offset:1024
 buffer_load_dwordx2 v[250:251], v13, s[24:27], s34 offen offset:2048
 s_waitcnt vmcnt(14)
 v_dot2c_f32_bf16 v72, s40, v202
 v_dot2c_f32_bf16 v73, s41, v202
 v_dot2c_f32_bf16 v74, s40, v203
 v_dot2c_f32_bf16 v75, s41, v203
 v_dot2c_f32_bf16 v76, s40, v204
 v_dot2c_f32_bf16 v77, s41, v204
 v_dot2c_f32_bf16 v78, s40, v205
 v_dot2c_f32_bf16 v79, s41, v205
 s_waitcnt vmcnt(13)
 v_dot2c_f32_bf16 v80, s40, v206
 v_dot2c_f32_bf16 v81, s41, v206
 v_dot2c_f32_bf16 v82, s40, v207
 v_dot2c_f32_bf16 v83, s41, v207
 v_dot2c_f32_bf16 v84, s40, v208
 v_dot2c_f32_bf16 v85, s41, v208
 v_dot2c_f32_bf16 v86, s40, v209
 v_dot2c_f32_bf16 v87, s41, v209
 s_waitcnt vmcnt(12)
 v_dot2c_f32_bf16 v88, s40, v210
 v_dot2c_f32_bf16 v89, s41, v210
 v_dot2c_f32_bf16 v90, s40, v211
 v_dot2c_f32_bf16 v91, s41, v211
 buffer_load_dwordx4 v[112:115], v14, s[20:23], s39 offen
 buffer_load_dwordx4 v[116:119], v14, s[20:23], s53 offen
 buffer_load_dwordx4 v[120:123], v14, s[20:23], s54 offen
 s_waitcnt vmcnt(14)
 v_dot2c_f32_bf16 v72, s40, v212
 v_dot2c_f32_bf16 v73, s41, v212
 v_dot2c_f32_bf16 v74, s40, v213
 v_dot2c_f32_bf16 v75, s41, v213
 v_dot2c_f32_bf16 v76, s40, v214
 v_dot2c_f32_bf16 v77, s41, v214
 v_dot2c_f32_bf16 v78, s40, v215
 v_dot2c_f32_bf16 v79, s41, v215
 s_waitcnt vmcnt(13)
 v_dot2c_f32_bf16 v80, s40, v216
 v_dot2c_f32_bf16 v81, s41, v216
 v_dot2c_f32_bf16 v82, s40, v217
 v_dot2c_f32_bf16 v83, s41, v217
 v_dot2c_f32_bf16 v84, s40, v218
 v_dot2c_f32_bf16 v85, s41, v218
 v_dot2c_f32_bf16 v86, s40, v219
 v_dot2c_f32_bf16 v87, s41, v219
 s_waitcnt vmcnt(12)
 v_dot2c_f32_bf16 v88, s40, v220
 v_dot2c_f32_bf16 v89, s41, v220
 v_dot2c_f32_bf16 v90, s40, v221
 v_dot2c_f32_bf16 v91, s41, v221
 s_add_u32 m0, s47, 65536
 s_add_u32 s31, s44, 0
 buffer_load_dwordx4 v6, s[12:15], s31 offen lds
 s_add_u32 m0, s46, 0
 s_mov_b32 s31, 0
 buffer_load_dwordx4 v5, s[12:15], s31 offen lds
 s_add_u32 m0, s46, 5120
 s_mov_b32 s31, 131072
 buffer_load_dwordx4 v5, s[12:15], s31 offen lds
 s_waitcnt vmcnt(14)
 v_dot2c_f32_bf16 v72, s40, v222
 v_dot2c_f32_bf16 v73, s41, v222
 v_dot2c_f32_bf16 v74, s40, v223
 v_dot2c_f32_bf16 v75, s41, v223
 v_dot2c_f32_bf16 v76, s40, v224
 v_dot2c_f32_bf16 v77, s41, v224
 v_dot2c_f32_bf16 v78, s40, v225
 v_dot2c_f32_bf16 v79, s41, v225
 s_waitcnt vmcnt(13)
 v_dot2c_f32_bf16 v80, s40, v226
 v_dot2c_f32_bf16 v81, s41, v226
 v_dot2c_f32_bf16 v82, s40, v227
 v_dot2c_f32_bf16 v83, s41, v227
 v_dot2c_f32_bf16 v84, s40, v228
 v_dot2c_f32_bf16 v85, s41, v228
 v_dot2c_f32_bf16 v86, s40, v229
 v_dot2c_f32_bf16 v87, s41, v229
 s_waitcnt vmcnt(12)
 v_dot2c_f32_bf16 v88, s40, v230
 v_dot2c_f32_bf16 v89, s41, v230
 v_dot2c_f32_bf16 v90, s40, v231
 v_dot2c_f32_bf16 v91, s41, v231
 s_add_u32 m0, s46, 10240
 s_mov_b32 s31, 262144
 buffer_load_dwordx4 v5, s[12:15], s31 offen lds
 s_add_u32 m0, s33, 0
 s_mov_b32 s31, 0
 buffer_load_dwordx4 v7, s[16:19], s31 offen lds
 buffer_load_dwordx4 v8, s[16:19], s31 offen offset:1024 lds
 s_waitcnt vmcnt(14)
 v_dot2c_f32_bf16 v72, s40, v232
 v_dot2c_f32_bf16 v73, s41, v232
 v_dot2c_f32_bf16 v74, s40, v233
 v_dot2c_f32_bf16 v75, s41, v233
 v_dot2c_f32_bf16 v76, s40, v234
 v_dot2c_f32_bf16 v77, s41, v234
 v_dot2c_f32_bf16 v78, s40, v235
 v_dot2c_f32_bf16 v79, s41, v235
 s_waitcnt vmcnt(13)
 v_dot2c_f32_bf16 v80, s40, v236
 v_dot2c_f32_bf16 v81, s41, v236
 v_dot2c_f32_bf16 v82, s40, v237
 v_dot2c_f32_bf16 v83, s41, v237
 v_dot2c_f32_bf16 v84, s40, v238
 v_dot2c_f32_bf16 v85, s41, v238
 v_dot2c_f32_bf16 v86, s40, v239
 v_dot2c_f32_bf16 v87, s41, v239
 s_waitcnt vmcnt(12)
 v_dot2c_f32_bf16 v88, s40, v240
 v_dot2c_f32_bf16 v89, s41, v240
 v_dot2c_f32_bf16 v90, s40, v241
 v_dot2c_f32_bf16 v91, s41, v241
 buffer_load_dwordx4 v9, s[16:19], s31 offen offset:2048 lds
 s_add_u32 m0, s47, 86016
 s_add_u32 s31, s44, 524288
 buffer_load_dwordx4 v6, s[12:15], s31 offen lds
 s_add_u32 m0, s46, 15360
 s_mov_b32 s31, 393216
 buffer_load_dwordx4 v5, s[12:15], s31 offen lds
 s_waitcnt vmcnt(14)
 v_dot2c_f32_bf16 v72, s40, v242
 v_dot2c_f32_bf16 v73, s41, v242
 v_dot2c_f32_bf16 v74, s40, v243
 v_dot2c_f32_bf16 v75, s41, v243
 v_dot2c_f32_bf16 v76, s40, v244
 v_dot2c_f32_bf16 v77, s41, v244
 v_dot2c_f32_bf16 v78, s40, v245
 v_dot2c_f32_bf16 v79, s41, v245
 s_waitcnt vmcnt(13)
 v_dot2c_f32_bf16 v80, s40, v246
 v_dot2c_f32_bf16 v81, s41, v246
 v_dot2c_f32_bf16 v82, s40, v247
 v_dot2c_f32_bf16 v83, s41, v247
 v_dot2c_f32_bf16 v84, s40, v248
 v_dot2c_f32_bf16 v85, s41, v248
 v_dot2c_f32_bf16 v86, s40, v249
 v_dot2c_f32_bf16 v87, s41, v249
 s_waitcnt vmcnt(12)
 v_dot2c_f32_bf16 v88, s40, v250
 v_dot2c_f32_bf16 v89, s41, v250
 v_dot2c_f32_bf16 v90, s40, v251
 v_dot2c_f32_bf16 v91, s41, v251
 v_exp_f32 v92, v72
 v_exp_f32 v93, v73
 v_exp_f32 v94, v74
 v_exp_f32 v95, v75
 v_exp_f32 v96, v76
 v_exp_f32 v97, v77
 v_exp_f32 v98, v78
 v_exp_f32 v99, v79
 v_exp_f32 v100, v80
 v_exp_f32 v101, v81
 v_exp_f32 v102, v82
 v_exp_f32 v103, v83
 s_add_u32 m0, s46, 20480
 s_mov_b32 s31, 524288
 buffer_load_dwordx4 v5, s[12:15], s31 offen lds
 v_exp_f32 v104, v84
 v_exp_f32 v105, v85
 v_exp_f32 v106, v86
 v_exp_f32 v107, v87
 v_exp_f32 v108, v88
 v_exp_f32 v109, v89
 v_exp_f32 v110, v90
 v_exp_f32 v111, v91
 v_pk_add_f32 v[92:93], v[92:93], 1.0 op_sel_hi:[1,0]
 v_pk_add_f32 v[94:95], v[94:95], 1.0 op_sel_hi:[1,0]
 v_pk_add_f32 v[96:97], v[96:97], 1.0 op_sel_hi:[1,0]
 v_pk_add_f32 v[98:99], v[98:99], 1.0 op_sel_hi:[1,0]
 v_pk_add_f32 v[100:101], v[100:101], 1.0 op_sel_hi:[1,0]
 v_pk_add_f32 v[102:103], v[102:103], 1.0 op_sel_hi:[1,0]
 v_pk_add_f32 v[104:105], v[104:105], 1.0 op_sel_hi:[1,0]
 v_pk_add_f32 v[106:107], v[106:107], 1.0 op_sel_hi:[1,0]
 v_pk_add_f32 v[108:109], v[108:109], 1.0 op_sel_hi:[1,0]
 v_pk_add_f32 v[110:111], v[110:111], 1.0 op_sel_hi:[1,0]
 v_rcp_f32 v92, v92
 v_rcp_f32 v93, v93
 v_rcp_f32 v94, v94
 v_rcp_f32 v95, v95
 v_rcp_f32 v96, v96
 v_rcp_f32 v97, v97
 s_add_u32 m0, s46, 25600
 s_mov_b32 s31, 655360
 buffer_load_dwordx4 v5, s[12:15], s31 offen lds
 v_rcp_f32 v98, v98
 v_rcp_f32 v99, v99
 v_rcp_f32 v100, v100
 v_rcp_f32 v101, v101
 v_rcp_f32 v102, v102
 v_rcp_f32 v103, v103
 v_rcp_f32 v104, v104
 v_rcp_f32 v105, v105
 v_rcp_f32 v106, v106
 v_rcp_f32 v107, v107
 v_rcp_f32 v108, v108
 v_rcp_f32 v109, v109
 v_rcp_f32 v110, v110
 v_rcp_f32 v111, v111
 v_pk_mul_f32 v[92:93], v[92:93], v[72:73]
 v_pk_mul_f32 v[94:95], v[94:95], v[74:75]
 v_pk_mul_f32 v[96:97], v[96:97], v[76:77]
 v_pk_mul_f32 v[98:99], v[98:99], v[78:79]
 v_pk_mul_f32 v[100:101], v[100:101], v[80:81]
 v_pk_mul_f32 v[102:103], v[102:103], v[82:83]
 v_pk_mul_f32 v[104:105], v[104:105], v[84:85]
 v_pk_mul_f32 v[106:107], v[106:107], v[86:87]
 v_pk_mul_f32 v[108:109], v[108:109], v[88:89]
 v_pk_mul_f32 v[110:111], v[110:111], v[90:91]
 s_add_u32 m0, s33, 12288
 s_mov_b32 s31, 124416
 buffer_load_dwordx4 v7, s[16:19], s31 offen lds
 s_mov_b32 s42, 0xbf317218
 s_mov_b32 s43, 0xbf317218
 v_pk_mul_f32 v[92:93], v[92:93], s[42:43]
 v_pk_mul_f32 v[94:95], v[94:95], s[42:43]
 v_pk_mul_f32 v[96:97], v[96:97], s[42:43]
 v_pk_mul_f32 v[98:99], v[98:99], s[42:43]
 v_pk_mul_f32 v[100:101], v[100:101], s[42:43]
 v_pk_mul_f32 v[102:103], v[102:103], s[42:43]
 v_pk_mul_f32 v[104:105], v[104:105], s[42:43]
 v_pk_mul_f32 v[106:107], v[106:107], s[42:43]
 v_pk_mul_f32 v[108:109], v[108:109], s[42:43]
 v_pk_mul_f32 v[110:111], v[110:111], s[42:43]
 s_waitcnt vmcnt(14)
 v_lshlrev_b32 v136, 16, v112
 v_and_b32 v137, 0xffff0000, v112
 v_lshlrev_b32 v138, 16, v113
 v_and_b32 v139, 0xffff0000, v113
 v_lshlrev_b32 v140, 16, v114
 v_and_b32 v141, 0xffff0000, v114
 v_lshlrev_b32 v142, 16, v115
 v_and_b32 v143, 0xffff0000, v115
 s_waitcnt vmcnt(13)
 v_lshlrev_b32 v144, 16, v116
 v_and_b32 v145, 0xffff0000, v116
 v_lshlrev_b32 v146, 16, v117
 v_and_b32 v147, 0xffff0000, v117
 v_lshlrev_b32 v148, 16, v118
 v_and_b32 v149, 0xffff0000, v118
 v_lshlrev_b32 v150, 16, v119
 v_and_b32 v151, 0xffff0000, v119
 s_waitcnt vmcnt(12)
 v_lshlrev_b32 v152, 16, v120
 v_and_b32 v153, 0xffff0000, v120
 v_lshlrev_b32 v154, 16, v121
 v_and_b32 v155, 0xffff0000, v121
 v_lshlrev_b32 v156, 16, v122
 v_and_b32 v157, 0xffff0000, v122
 v_lshlrev_b32 v158, 16, v123
 v_and_b32 v159, 0xffff0000, v123
 buffer_load_dwordx4 v8, s[16:19], s31 offen offset:1024 lds
 buffer_load_dwordx4 v9, s[16:19], s31 offen offset:2048 lds
 s_add_u32 m0, s47, 106496
 s_add_u32 s31, s44, 1048576
 buffer_load_dwordx4 v6, s[12:15], s31 offen lds
 s_add_u32 m0, s46, 30720
 s_mov_b32 s31, 786432
 buffer_load_dwordx4 v5, s[12:15], s31 offen lds
 s_add_u32 m0, s46, 35840
 s_mov_b32 s31, 917504
 buffer_load_dwordx4 v5, s[12:15], s31 offen lds
 s_add_u32 m0, s46, 40960
 s_mov_b32 s31, 1048576
 buffer_load_dwordx4 v5, s[12:15], s31 offen lds
 s_add_u32 m0, s33, 24576
 s_mov_b32 s31, 248832
 buffer_load_dwordx4 v7, s[16:19], s31 offen lds
 s_waitcnt vmcnt(12)
 s_barrier
 ds_read_b64_tr_b16 v[48:49], v2 offset:0
 ds_read_b64_tr_b16 v[50:51], v2 offset:512
 ds_read_b64_tr_b16 v[52:53], v2 offset:1024
 ds_read_b64_tr_b16 v[54:55], v2 offset:1536
 ds_read_b64_tr_b16 v[56:57], v2 offset:2048
 ds_read_b64_tr_b16 v[58:59], v2 offset:2560
 ds_read_b128 a[0:3], v3 offset:512
 ds_read_b128 a[4:7], v3 offset:5632
 ds_read_b128 a[8:11], v3 offset:10752
 ds_read_b128 a[12:15], v3 offset:0
 ds_read_b128 a[16:19], v3 offset:5120
 ds_read_b128 a[20:23], v3 offset:10240
 ds_read_b128 a[24:27], v3 offset:128
 ds_read_b128 a[28:31], v3 offset:5248
 ds_read_b128 a[32:35], v3 offset:10368
 ds_read_b128 a[36:39], v3 offset:256
 ds_read_b128 a[40:43], v3 offset:5376
 ds_read_b128 a[44:47], v3 offset:10496
 ds_read_b128 a[48:51], v3 offset:384
 ds_read_b128 a[52:55], v3 offset:5504
 ds_read_b128 a[56:59], v3 offset:10624
 buffer_load_dwordx4 v8, s[16:19], s31 offen offset:1024 lds
 buffer_load_dwordx4 v9, s[16:19], s31 offen offset:2048 lds
 s_add_u32 m0, s46, 46080
 s_mov_b32 s31, 1179648
 buffer_load_dwordx4 v5, s[12:15], s31 offen lds
 s_add_u32 m0, s46, 51200
 s_mov_b32 s31, 1310720
 buffer_load_dwordx4 v5, s[12:15], s31 offen lds
 s_add_u32 m0, s46, 56320
 s_mov_b32 s31, 1441792
 buffer_load_dwordx4 v5, s[12:15], s31 offen lds
 s_add_u32 m0, s33, 36864
 s_mov_b32 s31, 373248
 buffer_load_dwordx4 v7, s[16:19], s31 offen lds
 buffer_load_dwordx4 v8, s[16:19], s31 offen offset:1024 lds
 s_waitcnt vmcnt(12) lgkmcnt(0)
 s_barrier
 v_mfma_f32_16x16x32_bf16 v[44:47], v[48:51], a[0:3], 0
 ds_read_b64_tr_b16 v[60:61], v2 offset:12288
 v_mfma_f32_16x16x32_bf16 v[44:47], v[52:55], a[4:7], v[44:47]
 ds_read_b64_tr_b16 v[62:63], v2 offset:12800
 ds_read_b64_tr_b16 v[64:65], v2 offset:13312
 v_mfma_f32_16x16x32_bf16 v[44:47], v[56:59], a[8:11], v[44:47]
 ds_read_b64_tr_b16 v[66:67], v2 offset:13824
 ds_read_b64_tr_b16 v[68:69], v2 offset:14336
 v_mfma_f32_16x16x32_bf16 v[28:31], v[48:51], a[12:15], 0
 ds_read_b64_tr_b16 v[70:71], v2 offset:14848
 ds_read_b128 a[60:63], v3 offset:15872
 v_mfma_f32_16x16x32_bf16 v[28:31], v[52:55], a[16:19], v[28:31]
 ds_read_b128 a[64:67], v3 offset:20992
 v_mfma_f32_16x16x32_bf16 v[28:31], v[56:59], a[20:23], v[28:31]
 ds_read_b128 a[68:71], v3 offset:26112
 ds_read_b128 a[72:75], v3 offset:15360
 v_mfma_f32_16x16x32_bf16 v[32:35], v[48:51], a[24:27], 0
 ds_read_b128 a[76:79], v3 offset:20480
 ds_read_b128 a[80:83], v3 offset:25600
 v_mfma_f32_16x16x32_bf16 v[32:35], v[52:55], a[28:31], v[32:35]
 ds_read_b128 a[84:87], v3 offset:15488
 ds_read_b128 a[88:91], v3 offset:20608
 v_mfma_f32_16x16x32_bf16 v[32:35], v[56:59], a[32:35], v[32:35]
 ds_read_b128 a[92:95], v3 offset:25728
 v_mfma_f32_16x16x32_bf16 v[36:39], v[48:51], a[36:39], 0
 ds_read_b128 a[96:99], v3 offset:15616
 ds_read_b128 a[100:103], v3 offset:20736
 v_mfma_f32_16x16x32_bf16 v[36:39], v[52:55], a[40:43], v[36:39]
 ds_read_b128 a[104:107], v3 offset:25856
 ds_read_b128 a[108:111], v3 offset:15744
 v_mfma_f32_16x16x32_bf16 v[36:39], v[56:59], a[44:47], v[36:39]
 ds_read_b128 a[112:115], v3 offset:20864
 ds_read_b128 a[116:119], v3 offset:25984
 v_mfma_f32_16x16x32_bf16 v[40:43], v[48:51], a[48:51], 0
 v_mfma_f32_16x16x32_bf16 v[40:43], v[52:55], a[52:55], v[40:43]
 v_mfma_f32_16x16x32_bf16 v[40:43], v[56:59], a[56:59], v[40:43]
 buffer_load_dwordx4 v9, s[16:19], s31 offen offset:2048 lds
 s_add_u32 m0, s47, 126976
 s_add_u32 s31, s44, 1572864
 buffer_load_dwordx4 v6, s[12:15], s31 offen lds
 s_add_u32 m0, s46, 61440
 s_mov_b32 s31, 1572864
 buffer_load_dwordx4 v5, s[12:15], s31 offen lds
 s_add_u32 m0, s46, 66560
 s_mov_b32 s31, 1703936
 buffer_load_dwordx4 v5, s[12:15], s31 offen lds
 s_add_u32 m0, s46, 71680
 s_mov_b32 s31, 1835008
 buffer_load_dwordx4 v5, s[12:15], s31 offen lds
 s_add_u32 m0, s33, 49152
 s_mov_b32 s31, 497664
 buffer_load_dwordx4 v7, s[16:19], s31 offen lds
 buffer_load_dwordx4 v8, s[16:19], s31 offen offset:1024 lds
 s_waitcnt vmcnt(12) lgkmcnt(0)
 s_barrier
 v_mfma_f32_16x16x32_bf16 v[44:47], v[60:63], a[60:63], v[44:47]
 ds_read_b64_tr_b16 v[48:49], v2 offset:24576
 v_mfma_f32_16x16x32_bf16 v[44:47], v[64:67], a[64:67], v[44:47]
 ds_read_b64_tr_b16 v[50:51], v2 offset:25088
 ds_read_b64_tr_b16 v[52:53], v2 offset:25600
 v_mfma_f32_16x16x32_bf16 v[44:47], v[68:71], a[68:71], v[44:47]
 ds_read_b64_tr_b16 v[54:55], v2 offset:26112
 ds_read_b64_tr_b16 v[56:57], v2 offset:26624
 v_mfma_f32_16x16x32_bf16 v[28:31], v[60:63], a[72:75], v[28:31]
 ds_read_b64_tr_b16 v[58:59], v2 offset:27136
 ds_read_b128 a[0:3], v3 offset:31232
 v_mfma_f32_16x16x32_bf16 v[28:31], v[64:67], a[76:79], v[28:31]
 ds_read_b128 a[4:7], v3 offset:36352
 v_mfma_f32_16x16x32_bf16 v[28:31], v[68:71], a[80:83], v[28:31]
 ds_read_b128 a[8:11], v3 offset:41472
 ds_read_b128 a[12:15], v3 offset:30720
 v_mfma_f32_16x16x32_bf16 v[32:35], v[60:63], a[84:87], v[32:35]
 ds_read_b128 a[16:19], v3 offset:35840
 ds_read_b128 a[20:23], v3 offset:40960
 v_mfma_f32_16x16x32_bf16 v[32:35], v[64:67], a[88:91], v[32:35]
 ds_read_b128 a[24:27], v3 offset:30848
 ds_read_b128 a[28:31], v3 offset:35968
 v_mfma_f32_16x16x32_bf16 v[32:35], v[68:71], a[92:95], v[32:35]
 ds_read_b128 a[32:35], v3 offset:41088
 v_mfma_f32_16x16x32_bf16 v[36:39], v[60:63], a[96:99], v[36:39]
 ds_read_b128 a[36:39], v3 offset:30976
 ds_read_b128 a[40:43], v3 offset:36096
 v_mfma_f32_16x16x32_bf16 v[36:39], v[64:67], a[100:103], v[36:39]
 ds_read_b128 a[44:47], v3 offset:41216
 ds_read_b128 a[48:51], v3 offset:31104
 v_mfma_f32_16x16x32_bf16 v[36:39], v[68:71], a[104:107], v[36:39]
 ds_read_b128 a[52:55], v3 offset:36224
 ds_read_b128 a[56:59], v3 offset:41344
 v_mfma_f32_16x16x32_bf16 v[40:43], v[60:63], a[108:111], v[40:43]
 v_mfma_f32_16x16x32_bf16 v[40:43], v[64:67], a[112:115], v[40:43]
 v_mfma_f32_16x16x32_bf16 v[40:43], v[68:71], a[116:119], v[40:43]
 buffer_load_dwordx4 v9, s[16:19], s31 offen offset:2048 lds
 s_add_u32 m0, s46, 76800
 s_mov_b32 s31, 1966080
 buffer_load_dwordx4 v5, s[12:15], s31 offen lds
 s_add_u32 m0, s46, 81920
 s_add_u32 s31, s55, 0
 buffer_load_dwordx4 v20, s[12:15], s31 offen lds
 s_add_u32 m0, s46, 87040
 s_add_u32 s31, s55, 131072
 buffer_load_dwordx4 v20, s[12:15], s31 offen lds
 s_and_b32 s31, s28, 1
 s_mul_i32 s35, s31, 5120
 s_add_u32 m0, s35, 147456
 s_lshl_b32 s31, s31, 17
 s_add_u32 s31, s31, s55
 buffer_load_dwordx4 v21, s[12:15], s31 offen lds
 s_add_u32 m0, s33, 0
 s_mov_b32 s31, 622080
 buffer_load_dwordx4 v7, s[16:19], s31 offen lds
 s_waitcnt vmcnt(12) lgkmcnt(0)
 s_barrier
 v_mfma_f32_16x16x32_bf16 v[44:47], v[48:51], a[0:3], v[44:47]
 ds_read_b64_tr_b16 v[60:61], v2 offset:36864
 v_mfma_f32_16x16x32_bf16 v[44:47], v[52:55], a[4:7], v[44:47]
 ds_read_b64_tr_b16 v[62:63], v2 offset:37376
 ds_read_b64_tr_b16 v[64:65], v2 offset:37888
 v_mfma_f32_16x16x32_bf16 v[44:47], v[56:59], a[8:11], v[44:47]
 ds_read_b64_tr_b16 v[66:67], v2 offset:38400
 ds_read_b64_tr_b16 v[68:69], v2 offset:38912
 v_mfma_f32_16x16x32_bf16 v[28:31], v[48:51], a[12:15], v[28:31]
 ds_read_b64_tr_b16 v[70:71], v2 offset:39424
 ds_read_b128 a[60:63], v3 offset:46592
 v_mfma_f32_16x16x32_bf16 v[28:31], v[52:55], a[16:19], v[28:31]
 ds_read_b128 a[64:67], v3 offset:51712
 v_mfma_f32_16x16x32_bf16 v[28:31], v[56:59], a[20:23], v[28:31]
 ds_read_b128 a[68:71], v3 offset:56832
 ds_read_b128 a[72:75], v3 offset:46080
 v_mfma_f32_16x16x32_bf16 v[32:35], v[48:51], a[24:27], v[32:35]
 ds_read_b128 a[76:79], v3 offset:51200
 ds_read_b128 a[80:83], v3 offset:56320
 v_mfma_f32_16x16x32_bf16 v[32:35], v[52:55], a[28:31], v[32:35]
 ds_read_b128 a[84:87], v3 offset:46208
 ds_read_b128 a[88:91], v3 offset:51328
 v_mfma_f32_16x16x32_bf16 v[32:35], v[56:59], a[32:35], v[32:35]
 ds_read_b128 a[92:95], v3 offset:56448
 v_mfma_f32_16x16x32_bf16 v[36:39], v[48:51], a[36:39], v[36:39]
 ds_read_b128 a[96:99], v3 offset:46336
 ds_read_b128 a[100:103], v3 offset:51456
 v_mfma_f32_16x16x32_bf16 v[36:39], v[52:55], a[40:43], v[36:39]
 ds_read_b128 a[104:107], v3 offset:56576
 ds_read_b128 a[108:111], v3 offset:46464
 v_mfma_f32_16x16x32_bf16 v[36:39], v[56:59], a[44:47], v[36:39]
 ds_read_b128 a[112:115], v3 offset:51584
 ds_read_b128 a[116:119], v3 offset:56704
 v_mfma_f32_16x16x32_bf16 v[40:43], v[48:51], a[48:51], v[40:43]
 v_mfma_f32_16x16x32_bf16 v[40:43], v[52:55], a[52:55], v[40:43]
 v_mfma_f32_16x16x32_bf16 v[40:43], v[56:59], a[56:59], v[40:43]
 buffer_load_dwordx4 v10, s[16:19], 0 offen offset:1024 lds
 buffer_load_dwordx4 v11, s[16:19], 0 offen offset:2048 lds
 s_waitcnt vmcnt(7) lgkmcnt(0)
 s_barrier
 v_mfma_f32_16x16x32_bf16 v[44:47], v[60:63], a[60:63], v[44:47]
 ds_read_b64_tr_b16 v[48:49], v2 offset:49152
 v_mfma_f32_16x16x32_bf16 v[44:47], v[64:67], a[64:67], v[44:47]
 ds_read_b64_tr_b16 v[50:51], v2 offset:49664
 ds_read_b64_tr_b16 v[52:53], v2 offset:50176
 v_mfma_f32_16x16x32_bf16 v[44:47], v[68:71], a[68:71], v[44:47]
 ds_read_b64_tr_b16 v[54:55], v2 offset:50688
 ds_read_b64_tr_b16 v[56:57], v2 offset:51200
 v_mfma_f32_16x16x32_bf16 v[28:31], v[60:63], a[72:75], v[28:31]
 ds_read_b64_tr_b16 v[58:59], v2 offset:51712
 ds_read_b128 a[0:3], v4 offset:512
 v_mfma_f32_16x16x32_bf16 v[28:31], v[64:67], a[76:79], v[28:31]
 ds_read_b128 a[4:7], v4 offset:5632
 v_mfma_f32_16x16x32_bf16 v[28:31], v[68:71], a[80:83], v[28:31]
 ds_read_b128 a[8:11], v4 offset:10752
 ds_read_b128 a[12:15], v4 offset:0
 v_mfma_f32_16x16x32_bf16 v[32:35], v[60:63], a[84:87], v[32:35]
 ds_read_b128 a[16:19], v4 offset:5120
 ds_read_b128 a[20:23], v4 offset:10240
 v_mfma_f32_16x16x32_bf16 v[32:35], v[64:67], a[88:91], v[32:35]
 ds_read_b128 a[24:27], v4 offset:128
 ds_read_b128 a[28:31], v4 offset:5248
 v_mfma_f32_16x16x32_bf16 v[32:35], v[68:71], a[92:95], v[32:35]
 ds_read_b128 a[32:35], v4 offset:10368
 v_mfma_f32_16x16x32_bf16 v[36:39], v[60:63], a[96:99], v[36:39]
 ds_read_b128 a[36:39], v4 offset:256
 ds_read_b128 a[40:43], v4 offset:5376
 v_mfma_f32_16x16x32_bf16 v[36:39], v[64:67], a[100:103], v[36:39]
 ds_read_b128 a[44:47], v4 offset:10496
 ds_read_b128 a[48:51], v4 offset:384
 v_mfma_f32_16x16x32_bf16 v[36:39], v[68:71], a[104:107], v[36:39]
 ds_read_b128 a[52:55], v4 offset:5504
 ds_read_b128 a[56:59], v4 offset:10624
 v_mfma_f32_16x16x32_bf16 v[40:43], v[60:63], a[108:111], v[40:43]
 v_mfma_f32_16x16x32_bf16 v[40:43], v[64:67], a[112:115], v[40:43]
 v_mfma_f32_16x16x32_bf16 v[40:43], v[68:71], a[116:119], v[40:43]
 s_waitcnt vmcnt(0) lgkmcnt(0)
 s_barrier
 v_mfma_f32_16x16x32_bf16 v[44:47], v[48:51], a[0:3], v[44:47]
 ds_read_b64_tr_b16 v[60:61], v2 offset:0
 ds_read_b64_tr_b16 v[62:63], v2 offset:512
 v_mfma_f32_16x16x32_bf16 v[44:47], v[52:55], a[4:7], v[44:47]
 ds_read_b64_tr_b16 v[64:65], v2 offset:1024
 ds_read_b64_tr_b16 v[66:67], v2 offset:1536
 ds_read_b64_tr_b16 v[68:69], v2 offset:2048
 v_mfma_f32_16x16x32_bf16 v[44:47], v[56:59], a[8:11], v[44:47]
 ds_read_b64_tr_b16 v[70:71], v2 offset:2560
 ds_read_b128 a[60:63], v4 offset:15872
 v_mfma_f32_16x16x32_bf16 v[28:31], v[48:51], a[12:15], v[28:31]
 ds_read2_b32 a[64:65], v22 offset0:32 offset1:112
 ds_read2_b32 a[66:67], v23 offset0:32 offset1:112
 ds_read2_b32 a[68:69], v24 offset0:32 offset1:112
 v_mfma_f32_16x16x32_bf16 v[28:31], v[52:55], a[16:19], v[28:31]
 ds_read2_b32 a[70:71], v25 offset0:32 offset1:112
 ds_read_b128 a[72:75], v4 offset:15360
 v_mfma_f32_16x16x32_bf16 v[28:31], v[56:59], a[20:23], v[28:31]
 ds_read2_b32 a[76:77], v22 offset0:0 offset1:80
 ds_read2_b32 a[78:79], v23 offset0:0 offset1:80
 ds_read2_b32 a[80:81], v24 offset0:0 offset1:80
 v_mfma_f32_16x16x32_bf16 v[32:35], v[48:51], a[24:27], v[32:35]
 ds_read2_b32 a[82:83], v25 offset0:0 offset1:80
 ds_read_b128 a[84:87], v4 offset:15488
 ds_read2_b32 a[88:89], v22 offset0:8 offset1:88
 v_mfma_f32_16x16x32_bf16 v[32:35], v[52:55], a[28:31], v[32:35]
 ds_read2_b32 a[90:91], v23 offset0:8 offset1:88
 ds_read2_b32 a[92:93], v24 offset0:8 offset1:88
 v_mfma_f32_16x16x32_bf16 v[32:35], v[56:59], a[32:35], v[32:35]
 ds_read2_b32 a[94:95], v25 offset0:8 offset1:88
 ds_read_b128 a[96:99], v4 offset:15616
 ds_read2_b32 a[100:101], v22 offset0:16 offset1:96
 v_mfma_f32_16x16x32_bf16 v[36:39], v[48:51], a[36:39], v[36:39]
 ds_read2_b32 a[102:103], v23 offset0:16 offset1:96
 ds_read2_b32 a[104:105], v24 offset0:16 offset1:96
 v_mfma_f32_16x16x32_bf16 v[36:39], v[52:55], a[40:43], v[36:39]
 ds_read2_b32 a[106:107], v25 offset0:16 offset1:96
 ds_read_b128 a[108:111], v4 offset:15744
 ds_read2_b32 a[112:113], v22 offset0:24 offset1:104
 v_mfma_f32_16x16x32_bf16 v[36:39], v[56:59], a[44:47], v[36:39]
 ds_read2_b32 a[114:115], v23 offset0:24 offset1:104
 ds_read2_b32 a[116:117], v24 offset0:24 offset1:104
 ds_read2_b32 a[118:119], v25 offset0:24 offset1:104
 v_mfma_f32_16x16x32_bf16 v[40:43], v[48:51], a[48:51], v[40:43]
 v_mfma_f32_16x16x32_bf16 v[40:43], v[52:55], a[52:55], v[40:43]
 v_mfma_f32_16x16x32_bf16 v[40:43], v[56:59], a[56:59], v[40:43]
 s_waitcnt lgkmcnt(15)
 v_mfma_f32_16x16x32_bf16 v[44:47], v[60:63], a[60:63], v[44:47]
 v_mfma_f32_16x16x32_bf16 v[44:47], v[64:67], a[64:67], v[44:47]
 v_mfma_f32_16x16x32_bf16 v[44:47], v[68:71], a[68:71], v[44:47]
 v_mfma_f32_16x16x32_bf16 v[28:31], v[60:63], a[72:75], v[28:31]
 v_mfma_f32_16x16x32_bf16 v[28:31], v[64:67], a[76:79], v[28:31]
 v_mfma_f32_16x16x32_bf16 v[28:31], v[68:71], a[80:83], v[28:31]
 s_waitcnt lgkmcnt(14)
 v_mfma_f32_16x16x32_bf16 v[32:35], v[60:63], a[84:87], v[32:35]
 s_waitcnt lgkmcnt(12)
 v_mfma_f32_16x16x32_bf16 v[32:35], v[64:67], a[88:91], v[32:35]
 s_waitcnt lgkmcnt(10)
 v_mfma_f32_16x16x32_bf16 v[32:35], v[68:71], a[92:95], v[32:35]
 s_waitcnt lgkmcnt(9)
 v_mfma_f32_16x16x32_bf16 v[36:39], v[60:63], a[96:99], v[36:39]
 s_waitcnt lgkmcnt(7)
 v_mfma_f32_16x16x32_bf16 v[36:39], v[64:67], a[100:103], v[36:39]
 s_waitcnt lgkmcnt(5)
 v_mfma_f32_16x16x32_bf16 v[36:39], v[68:71], a[104:107], v[36:39]
 s_waitcnt lgkmcnt(4)
 v_mfma_f32_16x16x32_bf16 v[40:43], v[60:63], a[108:111], v[40:43]
 s_waitcnt lgkmcnt(2)
 v_mfma_f32_16x16x32_bf16 v[40:43], v[64:67], a[112:115], v[40:43]
 s_waitcnt lgkmcnt(0)
 v_mfma_f32_16x16x32_bf16 v[40:43], v[68:71], a[116:119], v[40:43]
 v_pk_mul_f32 v[92:93], v[44:45], v[92:93]
 v_pk_mul_f32 v[94:95], v[46:47], v[94:95]
 v_cvt_pk_bf16_f32 v72, v92, v93
 v_cvt_pk_bf16_f32 v73, v94, v95
 ds_write_b64 v18, v[72:73] offset:21504
 v_pk_mul_f32 v[96:97], v[28:29], v[96:97]
 v_pk_mul_f32 v[98:99], v[30:31], v[98:99]
 v_cvt_pk_bf16_f32 v74, v96, v97
 v_cvt_pk_bf16_f32 v75, v98, v99
 ds_write_b64 v18, v[74:75] offset:12288
 v_pk_mul_f32 v[100:101], v[32:33], v[100:101]
 v_pk_mul_f32 v[102:103], v[34:35], v[102:103]
 v_cvt_pk_bf16_f32 v76, v100, v101
 v_cvt_pk_bf16_f32 v77, v102, v103
 ds_write_b64 v18, v[76:77] offset:14592
 v_pk_mul_f32 v[104:105], v[36:37], v[104:105]
 v_pk_mul_f32 v[106:107], v[38:39], v[106:107]
 v_cvt_pk_bf16_f32 v78, v104, v105
 v_cvt_pk_bf16_f32 v79, v106, v107
 ds_write_b64 v18, v[78:79] offset:16896
 v_pk_mul_f32 v[108:109], v[40:41], v[108:109]
 v_pk_mul_f32 v[110:111], v[42:43], v[110:111]
 v_cvt_pk_bf16_f32 v80, v108, v109
 v_cvt_pk_bf16_f32 v81, v110, v111
 ds_write_b64 v18, v[80:81] offset:19200
 s_waitcnt lgkmcnt(0)
 s_barrier
 ds_read_b128 v[124:127], v19 offset:12288
 ds_read_b128 v[128:131], v19 offset:16896
 ds_read_b128 v[132:135], v19 offset:21504
 s_waitcnt lgkmcnt(2)
 v_dot2c_f32_bf16 v136, s40, v124
 v_dot2c_f32_bf16 v137, s41, v124
 v_dot2c_f32_bf16 v138, s40, v125
 v_dot2c_f32_bf16 v139, s41, v125
 v_dot2c_f32_bf16 v140, s40, v126
 v_dot2c_f32_bf16 v141, s41, v126
 v_dot2c_f32_bf16 v142, s40, v127
 v_dot2c_f32_bf16 v143, s41, v127
 v_cvt_pk_bf16_f32 v112, v136, v137
 v_cvt_pk_bf16_f32 v113, v138, v139
 v_cvt_pk_bf16_f32 v114, v140, v141
 v_cvt_pk_bf16_f32 v115, v142, v143
 buffer_store_dwordx4 v[112:115], v14, s[48:51], s39 offen
 s_waitcnt lgkmcnt(1)
 v_dot2c_f32_bf16 v144, s40, v128
 v_dot2c_f32_bf16 v145, s41, v128
 v_dot2c_f32_bf16 v146, s40, v129
 v_dot2c_f32_bf16 v147, s41, v129
 v_dot2c_f32_bf16 v148, s40, v130
 v_dot2c_f32_bf16 v149, s41, v130
 v_dot2c_f32_bf16 v150, s40, v131
 v_dot2c_f32_bf16 v151, s41, v131
 v_cvt_pk_bf16_f32 v116, v144, v145
 v_cvt_pk_bf16_f32 v117, v146, v147
 v_cvt_pk_bf16_f32 v118, v148, v149
 v_cvt_pk_bf16_f32 v119, v150, v151
 buffer_store_dwordx4 v[116:119], v14, s[48:51], s53 offen
 s_waitcnt lgkmcnt(0)
 v_dot2c_f32_bf16 v152, s40, v132
 v_dot2c_f32_bf16 v153, s41, v132
 v_dot2c_f32_bf16 v154, s40, v133
 v_dot2c_f32_bf16 v155, s41, v133
 v_dot2c_f32_bf16 v156, s40, v134
 v_dot2c_f32_bf16 v157, s41, v134
 v_dot2c_f32_bf16 v158, s40, v135
 v_dot2c_f32_bf16 v159, s41, v135
 v_cvt_pk_bf16_f32 v120, v152, v153
 v_cvt_pk_bf16_f32 v121, v154, v155
 v_cvt_pk_bf16_f32 v122, v156, v157
 v_cvt_pk_bf16_f32 v123, v158, v159
 buffer_store_dwordx4 v[120:123], v14, s[48:51], s54 offen
 s_endpgm
L_k2end:
 s_endpgm
L_allend:
.section .rodata,"a"
.p2align 6
.amdhsa_kernel recurrent_scan__sliding_local_dilated__dense_activation_silu__prompt_kernel
  .amdhsa_next_free_vgpr 512
  .amdhsa_next_free_sgpr 102
  .amdhsa_accum_offset 256
  .amdhsa_group_segment_fixed_size 0
  .amdhsa_kernarg_size 72
  .amdhsa_user_sgpr_count 2
  .amdhsa_user_sgpr_kernarg_segment_ptr 1
  .amdhsa_system_sgpr_workgroup_id_x 1
.end_amdhsa_kernel

.p2align 6
.amdhsa_kernel fin_kernel
  .amdhsa_next_free_vgpr 384
  .amdhsa_next_free_sgpr 102
  .amdhsa_accum_offset 256
  .amdhsa_group_segment_fixed_size 0
  .amdhsa_kernarg_size 72
  .amdhsa_user_sgpr_count 2
  .amdhsa_user_sgpr_kernarg_segment_ptr 1
  .amdhsa_system_sgpr_workgroup_id_x 1
.end_amdhsa_kernel
```
